```python
import torch

def _softmax(x, axis=-1):
    return torch.softmax(x, dim=axis)
def _gelu(x):
    return torch.nn.functional.gelu(x, approximate="tanh")
def _silu(x):
    return torch.nn.functional.silu(x)
def _sigmoid(x):
    return torch.sigmoid(x)
def _layernorm(x, axis=-1, eps=1e-5):
    m = x.mean(dim=axis, keepdim=True)
    v = x.var(dim=axis, keepdim=True, unbiased=False)
    return (x - m) / torch.sqrt(v + eps)
def _scatter_add(tgt, idx, src, axis=0):
    return tgt.clone().index_add_(axis, idx, src)
def _segment_sum(src, seg, n):
    out = torch.zeros((n,) + src.shape[1:], dtype=src.dtype)
    return out.index_add_(0, seg, src)
def _pad(x, pw):
    flat = tuple(v for pair in reversed(pw) for v in pair)
    return torch.nn.functional.pad(x, flat)

kernel_name = 'standalone__mha_block__prompt'

def setup_inputs():

    _w = (lambda a: (lambda t: t.to(torch.bfloat16) if t.is_floating_point() else t)(torch.as_tensor(a)))
    B, S, D, H = 1, 2048, 576, 32
    return {
        "x": _w((lambda *s: torch.randn(*s, dtype=torch.bfloat16) * 0.2)(B, S, D)),
        "wqkv": _w((lambda *s: torch.randn(*s, dtype=torch.bfloat16) * 0.2)(D, 3 * D)),
        "wo": _w((lambda *s: torch.randn(*s, dtype=torch.bfloat16) * 0.05)(D, D)),
    }

def reference(x, wqkv, wo):
    B, S, D = x.shape
    H = 32
    Dh = D // H
    qkv = (lambda x, *d: x.permute(*d))((x @ wqkv).reshape(B, S, 3, H, Dh), 2, 0, 3, 1, 4)
    q, k, v = qkv[0], qkv[1], qkv[2]
    scores = torch.einsum("bhqd,bhkd->bhqk", q, k) * (Dh ** -0.5)
    p = _softmax(scores, axis=-1)
    o = torch.einsum("bhqk,bhkd->bhqd", p, v)
    return (lambda x, *d: x.permute(*d))(o, 0, 2, 1, 3).reshape(B, S, D) @ wo
```

```asm
; @launch grid=(256,1,1) block=(512,1,1) lds=163840
.amdgcn_target "amdgcn-amd-amdhsa--gfx950"
.text
.globl standalone__mha_block__prompt_kernel
.p2align 12
.p2align 8
.type standalone__mha_block__prompt_kernel,@function
standalone__mha_block__prompt_kernel:
    s_load_dwordx2 s[20:21], s[0:1], 0
    s_load_dwordx2 s[24:25], s[0:1], 8
    s_load_dwordx8 s[52:59], s[0:1], 16
    v_readfirstlane_b32 s10, v0
    v_and_b32 v0, 63, v0
    s_cmp_ge_u32 s2, 256
    s_cbranch_scc1 L_exit
    s_lshr_b32 s10, s10, 6
    s_and_b32 s11, s10, 3
    s_cmp_lg_u32 s10, 0
    s_cbranch_scc1 L_nopf
    s_getpc_b64 s[28:29]
L_pc:
    s_lshr_b32 s30, s2, 3
    v_lshl_add_u32 v1, v0, 5, s30
    v_lshlrev_b32 v1, 7, v1
    v_cmp_gt_u32 vcc, L_exit-L_pc, v1
    s_mov_b64 exec, vcc
    global_load_dword v15, v1, s[28:29]
    s_mov_b64 exec, -1
L_nopf:
    s_cmp_ge_u32 s2, 246
    s_cselect_b32 s28, s2, 0
    s_bitcmp1_b32 s28, 1
    s_cbranch_scc1 L_idle
    s_cmp_lt_u32 s10, 4
    s_cbranch_scc1 A_entry
    s_and_b32 s28, s2, 3
    s_bfe_u32 s29, s2, 0x10002
    s_lshr_b32 s30, s2, 3
    s_sub_u32 s38, 5, s29
    s_mul_i32 s37, s29, 5
    s_cmp_lt_u32 s28, 2
    s_cselect_b32 s34, 28, 21
    s_cselect_b32 s33, 0, 4
    s_cmp_ge_u32 s30, s34
    s_cbranch_scc1 B_spare
    s_lshl_b32 s31, s28, 2
    s_min_u32 s32, s31, 11
    s_mul_i32 s35, s30, 37
    s_lshr_b32 s35, s35, 8
    s_mul_i32 s36, s35, 7
    s_sub_u32 s36, s30, s36
    s_add_u32 s13, s32, s35
    s_cmp_ge_u32 s13, 8
    s_cselect_b32 s35, 2, 0
    s_add_u32 s13, s13, s35
    s_mul_i32 s35, s29, 3
    s_add_u32 s35, s35, s36
    s_lshl_b32 s35, s35, 1
    s_add_u32 s35, s35, 8
    s_add_u32 s37, s37, s36
    s_cmp_lt_u32 s36, s38
    s_cselect_b32 s14, s37, s35
    s_cselect_b32 s35, 9, 1
    s_add_u32 s3, s14, s35
    s_branch B_map
A_entry:
    s_mov_b64 exec, 0
    s_cmp_eq_u32 s10, 1
    s_cbranch_scc1 I_s1
    s_cmp_eq_u32 s10, 2
    s_cbranch_scc1 I_s2
    s_cmp_eq_u32 s10, 3
    s_cbranch_scc1 I_s3
    s_branch A_start
B_spare:
    s_sub_u32 s35, s30, s34
    s_add_u32 s35, s35, s33
    s_and_b32 s13, s28, 1
    s_add_u32 s13, s13, 8
    s_mov_b32 s3, 27
    s_add_u32 s14, s35, s37
    s_add_u32 s36, s29, 4
    s_cmp_ge_u32 s35, s38
    s_cselect_b32 s36, s36, 0
    s_add_u32 s14, s14, s36
    s_lshl_b32 s38, s38, 1
    s_cmp_ge_u32 s35, s38
    s_cselect_b32 s36, 4, 0
    s_add_u32 s14, s14, s36
B_map:
    v_lshrrev_b32 v1, 3, v0
    v_mul_u32_u24 v4, 1152, v1
    v_lshrrev_b32 v2, 4, v0
    v_and_b32 v3, 7, v0
    v_xor_b32 v5, v3, v2
    v_lshl_add_u32 v16, v5, 4, v4
    v_xor_b32 v17, 64, v16
    v_mul_u32_u24 v4, 3, v4
    v_and_b32 v2, 1, v2
    s_and_b32 s29, s11, 1
    s_lshl_b32 s28, s29, 2
    v_lshl_or_b32 v2, v2, 1, s28
    v_xor_b32 v3, v3, v2
    v_lshl_add_u32 v18, v3, 4, v4
    s_lshl_b32 s36, s13, 2
    s_add_u32 s36, s36, s11
    s_mul_i32 s36, s36, 36864
    s_mul_i32 s39, s11, 27648
    s_lshl_b32 s37, s14, 7
    s_add_u32 s37, s37, s39
    s_lshl_b32 s38, s3, 7
    s_add_u32 s39, s39, s38
    s_lshl_b32 s38, s11, 12
    s_lshl_b32 s64, s11, 10
    s_mov_b32 s22, 2359296
    s_mov_b32 s23, 0x00020000
    s_mov_b32 s26, 1990656
    s_mov_b32 s27, s23
    s_mov_b32 s4, 9
    v_lshlrev_b32 v22, 7, v0
    s_lshr_b32 s28, s13, 1
    s_cmp_eq_u32 s28, 4
    s_cselect_b32 s30, 0, s14
    s_cmp_lt_u32 s30, 18
    s_cbranch_scc1 B_nopf
    s_lshr_b32 s29, s14, 1
    s_sub_u32 s30, s29, 7
    s_sub_u32 s4, 9, s30
    s_lshl_b32 s31, s30, 7
    s_add_u32 s36, s36, s31
    s_mul_i32 s31, s30, 221184
    s_add_u32 s37, s37, s31
    s_add_u32 s39, s39, s31
    s_cmp_gt_u32 s28, 4
    s_cselect_b32 s28, 2, 0
    s_sub_u32 s28, s13, s28
    s_mul_i32 s28, s28, 5
    s_add_u32 s28, s28, s29
    s_sub_u32 s28, s28, 9
    s_lshl2_add_u32 s7, s28, s11
B_nopf:
    s_waitcnt lgkmcnt(0)
    s_cmp_eq_u32 s4, 9
    s_cbranch_scc1 B_wp0
    s_mul_i32 s5, s7, 1664
    s_add_u32 s5, s5, 442368
    s_bfm_b64 exec, 13, 0
    buffer_load_dword v23, v22, s[24:27], s5 offen
    s_mov_b64 exec, -1
B_wp0:
    s_add_u32 m0, s38, 73728
    s_add_u32 s72, s36, 0
    buffer_load_dwordx4 v16, s[20:23], s72 offen lds
    s_add_u32 m0, s38, 74752
    s_add_u32 s72, s36, 9216
    buffer_load_dwordx4 v17, s[20:23], s72 offen lds
    s_add_u32 m0, s38, 75776
    s_add_u32 s72, s36, 18432
    buffer_load_dwordx4 v16, s[20:23], s72 offen lds
    s_add_u32 m0, s38, 76800
    s_add_u32 s72, s36, 27648
    buffer_load_dwordx4 v17, s[20:23], s72 offen lds
    s_add_u32 m0, s64, 90112
    s_add_u32 s73, s37, 0
    buffer_load_dwordx4 v18, s[24:27], s73 offen lds
    s_add_u32 m0, s64, 94208
    s_add_u32 s73, s37, 110592
    buffer_load_dwordx4 v18, s[24:27], s73 offen lds
    s_cmp_eq_u32 s4, 9
    s_cbranch_scc1 B_wp1
    s_mul_i32 s5, s7, 3968
    s_add_u32 s5, s5, 884736
    s_bfm_b64 exec, 31, 0
    buffer_load_dword v23, v22, s[24:27], s5 offen
    s_mov_b64 exec, -1
B_wp1:
    s_add_u32 m0, s38, 98304
    s_add_u32 s72, s36, 128
    buffer_load_dwordx4 v16, s[20:23], s72 offen lds
    s_add_u32 m0, s64, 114688
    s_add_u32 s73, s37, 221184
    buffer_load_dwordx4 v18, s[24:27], s73 offen lds
    s_add_u32 m0, s38, 99328
    s_add_u32 s72, s36, 9344
    buffer_load_dwordx4 v17, s[20:23], s72 offen lds
    s_add_u32 m0, s38, 100352
    s_add_u32 s72, s36, 18560
    buffer_load_dwordx4 v16, s[20:23], s72 offen lds
    s_add_u32 m0, s64, 118784
    s_add_u32 s73, s37, 331776
    buffer_load_dwordx4 v18, s[24:27], s73 offen lds
    s_add_u32 m0, s38, 101376
    s_add_u32 s72, s36, 27776
    buffer_load_dwordx4 v17, s[20:23], s72 offen lds
    s_add_u32 m0, s38, 122880
    s_add_u32 s72, s36, 256
    buffer_load_dwordx4 v16, s[20:23], s72 offen lds
    s_add_u32 m0, s64, 139264
    s_add_u32 s73, s37, 442368
    buffer_load_dwordx4 v18, s[24:27], s73 offen lds
    s_add_u32 m0, s38, 123904
    s_add_u32 s72, s36, 9472
    buffer_load_dwordx4 v17, s[20:23], s72 offen lds
    s_add_u32 m0, s38, 124928
I_s2:
    s_cbranch_execz A_start
    s_add_u32 s72, s36, 18688
    buffer_load_dwordx4 v16, s[20:23], s72 offen lds
    s_mov_b32 s16, s58
    s_mov_b32 s17, s59
    s_mov_b32 s18, 9568256
    s_mov_b32 s19, 0x00020000
    s_mov_b32 s60, s56
    s_mov_b32 s61, s57
    s_mov_b32 s62, 256
    s_mov_b32 s63, 0x00020000
    v_mov_b32 v226, 0
    s_and_b32 s28, s2, 7
    s_lshr_b32 s29, s2, 3
    s_lshl_b32 s15, s28, 2
    s_lshr_b32 s30, s29, 3
    s_add_u32 s15, s15, s30
    s_and_b32 s29, s29, 7
    s_and_b32 s49, s15, 1
    s_lshr_b32 s30, s15, 1
    s_mul_i32 s31, s30, 4608
    s_mul_i32 s32, s49, 2560
    s_add_u32 s32, s32, s31
    s_add_u32 s33, s31, 2048
    s_lshl_b32 s46, s29, 2
    s_waitcnt vmcnt(10)
    s_barrier
    s_add_u32 m0, s64, 143360
    s_add_u32 s73, s37, 552960
    buffer_load_dwordx4 v18, s[24:27], s73 offen lds
    s_add_u32 m0, s38, 125952
    s_add_u32 s72, s36, 27904
    buffer_load_dwordx4 v17, s[20:23], s72 offen lds
    s_cmp_eq_u32 s4, 3
    s_cselect_b32 s5, 1152, 0
    s_cselect_b32 s6, s26, 0
    s_sub_u32 s36, s36, s5
    s_sub_u32 s37, s37, s6
    s_add_u32 m0, s38, 0
    s_add_u32 s72, s36, 384
    buffer_load_dwordx4 v16, s[20:23], s72 offen lds
    s_add_u32 m0, s64, 16384
    s_add_u32 s73, s37, 663552
    buffer_load_dwordx4 v18, s[24:27], s73 offen lds
    s_add_u32 m0, s38, 1024
    s_add_u32 s72, s36, 9600
    buffer_load_dwordx4 v17, s[20:23], s72 offen lds
    s_add_u32 m0, s38, 2048
    s_add_u32 s72, s36, 18816
    buffer_load_dwordx4 v16, s[20:23], s72 offen lds
    s_add_u32 s46, s46, s11
    s_mul_i32 s42, s46, 221184
    s_add_u32 s42, s42, 147456
    s_add_u32 s43, s11, 16
    s_mul_i32 s66, s43, 4864
    s_mul_i32 s43, s43, 221184
    s_mul_i32 s67, s11, 2560
    s_add_u32 s67, s67, 116736
    s_xor_b32 s68, s11, 1
    s_mul_i32 s68, s68, 2560
    s_add_u32 s68, s68, 116736
    s_mov_b32 s44, s33
    s_mov_b32 s45, s32
    s_and_b32 s47, s11, 1
    s_mul_i32 s34, s47, 9728
    s_add_u32 s34, s34, 77824
    v_and_b32 v1, 31, v0
    v_lshrrev_b32 v2, 5, v0
    v_lshlrev_b32 v9, 3, v1
    v_lshl_add_u32 v9, v2, 10, v9
    v_lshlrev_b32 v10, 3, v0
    v_lshlrev_b32 v7, 4, v0
    s_waitcnt vmcnt(10)
    s_barrier
    s_add_u32 m0, s64, 20480
    s_add_u32 s73, s37, 774144
    buffer_load_dwordx4 v18, s[24:27], s73 offen lds
    s_add_u32 m0, s38, 3072
    s_add_u32 s72, s36, 28032
    buffer_load_dwordx4 v17, s[20:23], s72 offen lds
    s_cmp_eq_u32 s4, 4
    s_cselect_b32 s5, 1152, 0
    s_cselect_b32 s6, s26, 0
    s_sub_u32 s36, s36, s5
    s_sub_u32 s37, s37, s6
    s_add_u32 m0, s38, 24576
    s_add_u32 s72, s36, 512
    buffer_load_dwordx4 v16, s[20:23], s72 offen lds
    s_add_u32 m0, s64, 40960
    s_add_u32 s73, s37, 884736
    buffer_load_dwordx4 v18, s[24:27], s73 offen lds
    s_add_u32 m0, s38, 25600
    s_add_u32 s72, s36, 9728
    buffer_load_dwordx4 v17, s[20:23], s72 offen lds
    s_add_u32 m0, s38, 26624
    s_add_u32 s72, s36, 18944
    buffer_load_dwordx4 v16, s[20:23], s72 offen lds
    v_add_u32 v3, s34, v9
    v_add_u32 v4, 0x100, v3
    v_mul_u32_u24 v5, 288, v2
    v_lshl_add_u32 v5, v1, 4, v5
    s_addk_i32 s34, 2048
    v_add_u32 v6, s34, v10
    s_addk_i32 s34, 512
    v_add_u32 v5, s34, v5
    v_mul_u32_u24 v225, 9216, v2
    v_lshl_add_u32 v225, v1, 4, v225
    s_mov_b32 s40, 0x3ffff
    s_mov_b32 s41, s40
    s_mul_i32 s34, s11, 4864
    s_xor_b32 s35, s11, 1
    s_mul_i32 s35, s35, 4864
    v_add_u32 v219, s34, v7
    v_add_u32 v220, s34, v10
    v_lshl_add_u32 v221, v0, 2, s34
    v_add_u32 v222, s35, v7
    v_add_u32 v223, s35, v10
    v_lshl_add_u32 v224, v0, 2, s35
    v_lshrrev_b32 v217, 4, v1
    s_waitcnt vmcnt(10)
    s_barrier
    s_add_u32 m0, s64, 45056
    s_add_u32 s73, s37, 995328
    buffer_load_dwordx4 v18, s[24:27], s73 offen lds
    s_add_u32 m0, s38, 27648
    s_add_u32 s72, s36, 28160
    buffer_load_dwordx4 v17, s[20:23], s72 offen lds
    s_cmp_eq_u32 s4, 5
    s_cselect_b32 s5, 1152, 0
    s_cselect_b32 s6, s26, 0
    s_sub_u32 s36, s36, s5
    s_sub_u32 s37, s37, s6
    s_add_u32 m0, s38, 49152
    s_add_u32 s72, s36, 640
    buffer_load_dwordx4 v16, s[20:23], s72 offen lds
    s_add_u32 m0, s64, 65536
    s_add_u32 s73, s37, 1105920
    buffer_load_dwordx4 v18, s[24:27], s73 offen lds
    s_add_u32 m0, s38, 50176
    s_add_u32 s72, s36, 9856
    buffer_load_dwordx4 v17, s[20:23], s72 offen lds
    s_add_u32 m0, s38, 51200
    s_add_u32 s72, s36, 19072
    buffer_load_dwordx4 v16, s[20:23], s72 offen lds
    v_lshlrev_b32 v217, 9, v217
    v_lshl_add_u32 v217, v2, 8, v217
    v_and_b32 v11, 15, v1
    v_lshl_add_u32 v217, v11, 4, v217
    v_lshlrev_b32 v218, 2, v0
    v_lshlrev_b32 v228, 7, v0
    s_lshl_b32 s28, s46, 5
    s_add_u32 s28, s28, s15
    s_mul_i32 s50, s28, 2304
    s_add_u32 s50, s50, 7077888
    s_lshl_b32 s69, s46, 10
    s_add_u32 s69, s69, 9502720
    v_add_u32 v230, s32, v7
    v_mov_b32 v231, v230
    s_mul_i32 s34, s15, 288
    s_add_u32 s34, s34, 71168
    s_movk_i32 s35, 8928
    v_add_u32 v12, s34, v7
    v_add_u32 v11, -32, v0
    v_max_i32 v11, 0, v11
    v_mul_u32_u24 v11, 3641, v11
    v_lshrrev_b32 v11, 16, v11
    s_waitcnt vmcnt(10)
    s_barrier
    s_add_u32 m0, s64, 69632
    s_add_u32 s73, s37, 1216512
    buffer_load_dwordx4 v18, s[24:27], s73 offen lds
    s_add_u32 m0, s38, 52224
    s_add_u32 s72, s36, 28288
    buffer_load_dwordx4 v17, s[20:23], s72 offen lds
    s_cmp_eq_u32 s4, 6
    s_cselect_b32 s5, 1152, 0
    s_cselect_b32 s6, s26, 0
    s_sub_u32 s36, s36, s5
    s_sub_u32 s37, s37, s6
    s_add_u32 m0, s38, 73728
    s_add_u32 s72, s36, 768
    buffer_load_dwordx4 v16, s[20:23], s72 offen lds
    s_add_u32 m0, s64, 90112
    s_add_u32 s73, s37, 1327104
    buffer_load_dwordx4 v18, s[24:27], s73 offen lds
    s_add_u32 m0, s38, 74752
    s_add_u32 s72, s36, 9984
    buffer_load_dwordx4 v17, s[20:23], s72 offen lds
    s_add_u32 m0, s38, 75776
    s_add_u32 s72, s36, 19200
    buffer_load_dwordx4 v16, s[20:23], s72 offen lds
    v_mad_u32_u24 v232, v11, s35, v12
    v_add_u32 v11, 32, v0
    v_max_i32 v11, 0, v11
    v_mul_u32_u24 v11, 3641, v11
    v_lshrrev_b32 v11, 16, v11
    v_mad_u32_u24 v233, v11, s35, v12
    v_add_u32 v11, 80, v0
    v_max_i32 v11, 0, v11
    v_mul_u32_u24 v11, 3641, v11
    v_lshrrev_b32 v11, 16, v11
    v_mad_u32_u24 v234, v11, s35, v12
    v_cmp_gt_u32 vcc, 32, v0
    v_add_u32 v11, s31, v7
    s_nop 0
    v_cndmask_b32 v232, v232, v11, vcc
    s_lshr_b32 s34, s46, 1
    s_lshl_b32 s35, s15, 4
    s_add_u32 s34, s34, s35
    s_lshl_b32 s34, s34, 7
    s_add_u32 s51, s34, 9437188
    v_add_u32 v235, s68, v9
    v_add_u32 v236, 0x100, v235
    s_waitcnt vmcnt(10)
    s_barrier
    s_add_u32 m0, s64, 94208
    s_add_u32 s73, s37, 1437696
    buffer_load_dwordx4 v18, s[24:27], s73 offen lds
    s_add_u32 m0, s38, 76800
    s_add_u32 s72, s36, 28416
    buffer_load_dwordx4 v17, s[20:23], s72 offen lds
    s_cmp_eq_u32 s4, 7
    s_cselect_b32 s5, 1152, 0
    s_cselect_b32 s6, s26, 0
    s_sub_u32 s36, s36, s5
    s_sub_u32 s37, s37, s6
    s_add_u32 m0, s38, 98304
    s_add_u32 s72, s36, 896
    buffer_load_dwordx4 v16, s[20:23], s72 offen lds
    s_add_u32 m0, s64, 114688
    s_add_u32 s73, s37, 1548288
    buffer_load_dwordx4 v18, s[24:27], s73 offen lds
    s_add_u32 m0, s38, 99328
    s_add_u32 s72, s36, 10112
    buffer_load_dwordx4 v17, s[20:23], s72 offen lds
    s_add_u32 m0, s38, 100352
    s_add_u32 s72, s36, 19328
    buffer_load_dwordx4 v16, s[20:23], s72 offen lds
    v_add_u32 v237, s68, v10
    v_add_u32 v238, s67, v9
    v_add_u32 v239, 0x100, v238
    v_add_u32 v240, s67, v10
    v_mov_b32 v229, 163776
    v_cmp_eq_u32 vcc, 0, v0
    v_mov_b32 v11, 0x29000
    s_lshl_b32 s34, s11, 2
    v_cndmask_b32 v241, v11, v229, vcc
    s_xor_b32 s35, s34, 4
    v_add_u32 v243, s34, v241
    v_add_u32 v244, s35, v229
    s_cmp_eq_u32 s49, 0
    s_cselect_b32 s70, -1, 0
    s_cselect_b32 s71, 0, -1
    v_mov_b32 v216, 0xdddddddd
    v_cmp_eq_u32 vcc, 18, v1
    v_mov_b32 v11, 0x3f803f80
    v_mov_b32 v226, 0
    v_cndmask_b32 v184, 0, v11, vcc
    v_cndmask_b32 v185, 0, v11, vcc
    v_mov_b32 v227, 1
    s_waitcnt vmcnt(10)
    s_barrier
    s_add_u32 m0, s64, 118784
    s_add_u32 s73, s37, 1658880
    buffer_load_dwordx4 v18, s[24:27], s73 offen lds
    s_add_u32 m0, s38, 101376
    s_add_u32 s72, s36, 28544
    buffer_load_dwordx4 v17, s[20:23], s72 offen lds
    s_add_u32 m0, s38, 122880
    s_add_u32 s72, s36, 1024
    buffer_load_dwordx4 v16, s[20:23], s72 offen lds
    s_add_u32 m0, s64, 139264
    s_add_u32 s73, s37, 1769472
    buffer_load_dwordx4 v18, s[24:27], s73 offen lds
    s_add_u32 m0, s38, 123904
    s_add_u32 s72, s36, 10240
    buffer_load_dwordx4 v17, s[20:23], s72 offen lds
    s_add_u32 m0, s38, 124928
    s_add_u32 s72, s36, 19456
    buffer_load_dwordx4 v16, s[20:23], s72 offen lds
    s_waitcnt vmcnt(10)
    s_barrier
    s_add_u32 m0, s64, 143360
    s_add_u32 s73, s37, 1880064
    buffer_load_dwordx4 v18, s[24:27], s73 offen lds
    s_add_u32 m0, s38, 125952
    s_add_u32 s72, s36, 28672
    buffer_load_dwordx4 v17, s[20:23], s72 offen lds
    s_mov_b64 exec, 1
    buffer_load_dword v19, v226, s[60:63], 0 offen sc1
    s_mov_b64 exec, -1
    s_cmp_ge_u32 s3, 27
    s_cbranch_scc1 B_single
    s_add_u32 m0, s64, 0
    s_add_u32 s73, s39, 0
    buffer_load_dwordx4 v18, s[24:27], s73 offen lds
    s_add_u32 m0, s64, 4096
    s_add_u32 s73, s39, 110592
    buffer_load_dwordx4 v18, s[24:27], s73 offen lds
    s_add_u32 m0, s64, 8192
    s_add_u32 s73, s39, 221184
    buffer_load_dwordx4 v18, s[24:27], s73 offen lds
    s_add_u32 m0, s64, 12288
    s_add_u32 s73, s39, 331776
    buffer_load_dwordx4 v18, s[24:27], s73 offen lds
    s_waitcnt vmcnt(11)
    s_barrier
    s_add_u32 m0, s64, 16384
    s_add_u32 s73, s39, 442368
    buffer_load_dwordx4 v18, s[24:27], s73 offen lds
    s_add_u32 m0, s64, 20480
    s_add_u32 s73, s39, 552960
    buffer_load_dwordx4 v18, s[24:27], s73 offen lds
    s_cmp_eq_u32 s4, 3
    s_cselect_b32 s6, s26, 0
    s_sub_u32 s39, s39, s6
    s_add_u32 m0, s64, 24576
    s_add_u32 s73, s39, 663552
    buffer_load_dwordx4 v18, s[24:27], s73 offen lds
    s_add_u32 m0, s64, 28672
    s_add_u32 s73, s39, 774144
    buffer_load_dwordx4 v18, s[24:27], s73 offen lds
    s_cmp_eq_u32 s4, 4
    s_cselect_b32 s6, s26, 0
    s_sub_u32 s39, s39, s6
    s_add_u32 m0, s64, 32768
    s_add_u32 s73, s39, 884736
    buffer_load_dwordx4 v18, s[24:27], s73 offen lds
    s_add_u32 m0, s64, 36864
    s_add_u32 s73, s39, 995328
    buffer_load_dwordx4 v18, s[24:27], s73 offen lds
    s_waitcnt vmcnt(11)
    s_barrier
    s_branch B_w2
B_single:
    s_waitcnt vmcnt(7)
    s_barrier
    s_waitcnt vmcnt(1)
    s_barrier
    s_waitcnt vmcnt(0)
    v_readfirstlane_b32 s65, v19
    s_cmp_lg_u32 s65, 0
    s_cbranch_scc1 B_gob
    s_mov_b32 exec_lo, 0x1
    s_mov_b32 exec_hi, 0x0
    s_mov_b32 s29, 0
B_gobp:
    buffer_load_dword v11, v226, s[60:63], 0 offen offset:0 sc1
    s_add_u32 s29, s29, 1
    s_cmp_ge_u32 s29, 262144
    s_cbranch_scc1 L_end
    s_waitcnt vmcnt(0)
    v_cmp_eq_u32 vcc, 0, v11
    s_cbranch_vccnz B_gobp
    s_mov_b64 exec, -1
B_gob:
    s_barrier
    s_branch B_noflag
B_retry2:
    s_mov_b32 s29, 0
B_retryl2:
    ds_read_b32 v242, v229 offset:8
    ds_read_b64 v[164:165], v6 offset:19456
    ds_read2st64_b64 v[168:171], v3 offset0:38 offset1:39
    ds_read2st64_b64 v[172:175], v4 offset0:38 offset1:39
    s_mov_b64 exec, s[40:41]
    ds_read_b128 v[184:187], v5 offset:19456
    ds_read_b128 v[188:191], v5 offset:20032
    ds_read_b128 v[192:195], v5 offset:20608
    ds_read_b128 v[196:199], v5 offset:21184
    s_mov_b64 exec, -1
    s_add_u32 s29, s29, 1
    s_cmp_ge_u32 s29, 2097152
    s_cbranch_scc1 L_end
    s_waitcnt lgkmcnt(0)
    v_cmp_gt_u32 vcc, 4, v242
    s_cbranch_vccnz B_retryl2
    s_branch B_back2
B_retry4:
    s_mov_b32 s29, 0
B_retryl4:
    ds_read_b32 v242, v229 offset:16
    ds_read_b64 v[164:165], v6 offset:38912
    ds_read2st64_b64 v[168:171], v3 offset0:76 offset1:77
    ds_read2st64_b64 v[172:175], v4 offset0:76 offset1:77
    s_mov_b64 exec, s[40:41]
    ds_read_b128 v[184:187], v5 offset:38912
    ds_read_b128 v[188:191], v5 offset:39488
    ds_read_b128 v[192:195], v5 offset:40064
    ds_read_b128 v[196:199], v5 offset:40640
    s_mov_b64 exec, -1
    s_add_u32 s29, s29, 1
    s_cmp_ge_u32 s29, 2097152
    s_cbranch_scc1 L_end
    s_waitcnt lgkmcnt(0)
    v_cmp_gt_u32 vcc, 4, v242
    s_cbranch_vccnz B_retryl4
    s_branch B_back4
B_retry6:
    s_mov_b32 s29, 0
B_retryl6:
    ds_read_b32 v242, v229 offset:20
    ds_read_b64 v[164:165], v6 offset:58368
    ds_read2st64_b64 v[168:171], v3 offset0:114 offset1:115
    ds_read2st64_b64 v[172:175], v4 offset0:114 offset1:115
    s_mov_b64 exec, s[40:41]
    ds_read_b128 v[184:187], v5 offset:58368
    ds_read_b128 v[188:191], v5 offset:58944
    ds_read_b128 v[192:195], v5 offset:59520
    ds_read_b128 v[196:199], v5 offset:60096
    s_mov_b64 exec, -1
    s_add_u32 s29, s29, 1
    s_cmp_ge_u32 s29, 2097152
    s_cbranch_scc1 L_end
    s_waitcnt lgkmcnt(0)
    v_cmp_gt_u32 vcc, 4, v242
    s_cbranch_vccnz B_retryl6
    s_branch B_back6
B_retry8:
    s_mov_b32 s29, 0
B_retryl8:
    ds_read_b32 v242, v229 offset:24
    ds_read_b64 v[164:165], v6 offset:0
    ds_read2st64_b64 v[168:171], v3 offset0:0 offset1:1
    ds_read2st64_b64 v[172:175], v4 offset0:0 offset1:1
    s_mov_b64 exec, s[40:41]
    ds_read_b128 v[184:187], v5 offset:0
    ds_read_b128 v[188:191], v5 offset:576
    ds_read_b128 v[192:195], v5 offset:1152
    ds_read_b128 v[196:199], v5 offset:1728
    s_mov_b64 exec, -1
    s_add_u32 s29, s29, 1
    s_cmp_ge_u32 s29, 2097152
    s_cbranch_scc1 L_end
    s_waitcnt lgkmcnt(0)
    v_cmp_gt_u32 vcc, 4, v242
    s_cbranch_vccnz B_retryl8
    s_branch B_back8
B_retry1:
    s_mov_b32 s29, 0
B_retryl1:
    ds_read_b32 v242, v229 offset:4
    ds_read_b64 v[166:167], v6 offset:4864
    ds_read2st64_b64 v[176:179], v4 offset0:9 offset1:10
    ds_read2st64_b64 v[180:183], v3 offset0:10 offset1:11
    s_mov_b64 exec, s[40:41]
    ds_read_b128 v[200:203], v5 offset:4864
    ds_read_b128 v[204:207], v5 offset:5440
    ds_read_b128 v[208:211], v5 offset:6016
    ds_read_b128 v[212:215], v5 offset:6592
    s_mov_b64 exec, -1
    s_add_u32 s29, s29, 1
    s_cmp_ge_u32 s29, 2097152
    s_cbranch_scc1 L_end
    s_waitcnt lgkmcnt(0)
    v_cmp_gt_u32 vcc, 4, v242
    s_cbranch_vccnz B_retryl1
    s_branch B_back1
B_retry15:
    s_mov_b32 s29, 0
B_retryl15:
    ds_read_b32 v242, v229 offset:28
    ds_read_b64 v[166:167], v6 offset:63232
    ds_read2st64_b64 v[176:179], v4 offset0:123 offset1:124
    ds_read2st64_b64 v[180:183], v3 offset0:124 offset1:125
    s_mov_b64 exec, s[40:41]
    ds_read_b128 v[200:203], v5 offset:63232
    ds_read_b128 v[204:207], v5 offset:63808
    ds_read_b128 v[208:211], v5 offset:64384
    ds_read_b128 v[212:215], v5 offset:64960
    s_mov_b64 exec, -1
    s_add_u32 s29, s29, 1
    s_cmp_ge_u32 s29, 2097152
    s_cbranch_scc1 L_end
    s_waitcnt lgkmcnt(0)
    v_cmp_gt_u32 vcc, 8, v242
    s_cbranch_vccnz B_retryl15
    s_branch B_back15
B_retry12:
    s_mov_b32 s29, 0
B_retryl12:
    ds_read_b32 v242, v229 offset:56
    ds_read_b64 v[164:165], v6 offset:38912
    ds_read2st64_b64 v[168:171], v3 offset0:76 offset1:77
    ds_read2st64_b64 v[172:175], v4 offset0:76 offset1:77
    s_mov_b64 exec, s[40:41]
    ds_read_b128 v[184:187], v5 offset:38912
    ds_read_b128 v[188:191], v5 offset:39488
    ds_read_b128 v[192:195], v5 offset:40064
    ds_read_b128 v[196:199], v5 offset:40640
    s_mov_b64 exec, -1
    s_add_u32 s29, s29, 1
    s_cmp_ge_u32 s29, 2097152
    s_cbranch_scc1 L_end
    s_waitcnt lgkmcnt(0)
    v_cmp_gt_u32 vcc, 4, v242
    s_cbranch_vccnz B_retryl12
    s_branch B_back12
B_retryx:
    s_mov_b32 s29, 0
B_retrylx:
    ds_read_b32 v242, v244 offset:32
    ds_read_b128 v[80:83], v222 offset:0
    ds_read_b128 v[84:87], v222 offset:1024
    ds_read_b128 v[88:91], v222 offset:2048
    ds_read_b128 v[92:95], v222 offset:3072
    ds_read_b64 v[96:97], v223 offset:4096
    ds_read_b32 v98, v224 offset:4608
    s_add_u32 s29, s29, 1
    s_cmp_ge_u32 s29, 2097152
    s_cbranch_scc1 L_end
    s_waitcnt lgkmcnt(0)
    v_cmp_eq_u32 vcc, 0, v242
    s_cbranch_vccnz B_retrylx
    s_branch B_backx
B_slow0:
    s_mov_b64 exec, 0xff
    buffer_atomic_add v227, v228, s[16:19], s69 offen sc1
    s_mov_b64 exec, -1
    s_barrier
B_slow:
    s_mul_i32 s43, s15, 288
    s_add_u32 s43, s43, 73728
    v_mov_b32 v80, 0xff800000
    v_mov_b32 v81, 0xff800000
    s_waitcnt vmcnt(0)
    v_mov_b64 v[112:113], 0
    v_mov_b64 v[114:115], 0
    v_mov_b64 v[116:117], 0
    v_mov_b64 v[118:119], 0
    v_mov_b64 v[120:121], 0
    v_mov_b64 v[122:123], 0
    v_mov_b64 v[124:125], 0
    v_mov_b64 v[126:127], 0
    v_mov_b64 v[128:129], 0
    v_mov_b64 v[130:131], 0
    v_mov_b64 v[132:133], 0
    v_mov_b64 v[134:135], 0
    v_mov_b64 v[136:137], 0
    v_mov_b64 v[138:139], 0
    v_mov_b64 v[140:141], 0
    v_mov_b64 v[142:143], 0
S_pass:
    s_mov_b32 s29, 0
    s_mov_b32 s66, s45
    s_mov_b32 s67, s44
    s_mov_b32 s68, s43
S_loop:
    buffer_load_dwordx2 v[164:165], v10, s[16:19], s67 offen sc1
    buffer_load_dwordx2 v[168:169], v9, s[16:19], s66 offen offset:0 sc1
    buffer_load_dwordx2 v[170:171], v9, s[16:19], s66 offen offset:512 sc1
    buffer_load_dwordx2 v[172:173], v9, s[16:19], s66 offen offset:256 sc1
    buffer_load_dwordx2 v[174:175], v9, s[16:19], s66 offen offset:768 sc1
    s_mov_b64 exec, s[40:41]
    buffer_load_dwordx4 v[184:187], v225, s[16:19], s68 offen sc1
    s_add_u32 s28, s68, 18432
    buffer_load_dwordx4 v[188:191], v225, s[16:19], s28 offen sc1
    s_add_u32 s28, s68, 36864
    buffer_load_dwordx4 v[192:195], v225, s[16:19], s28 offen sc1
    s_add_u32 s28, s68, 55296
    buffer_load_dwordx4 v[196:199], v225, s[16:19], s28 offen sc1
    s_mov_b64 exec, -1
    s_waitcnt vmcnt(0)
    v_mfma_f32_32x32x4_2b_bf16 v[16:47], v[164:165], v[162:163], 0 cbsz:1 abid:0
    v_mfma_f32_32x32x4_2b_bf16 v[48:79], v[164:165], v[162:163], 0 cbsz:1 abid:1
    s_nop 15
    s_nop 1
    v_mfma_f32_32x32x16_bf16 v[16:31], v[168:171], v[152:155], v[16:31]
    v_mfma_f32_32x32x16_bf16 v[32:47], v[168:171], v[156:159], v[32:47]
    v_mfma_f32_32x32x16_bf16 v[48:63], v[172:175], v[152:155], v[48:63]
    v_mfma_f32_32x32x16_bf16 v[64:79], v[172:175], v[156:159], v[64:79]
    s_cmp_lg_u32 s48, 0
    s_nop 11
    s_cbranch_scc1 S_exp
    v_max3_f32 v80, v80, v16, v17
    v_max3_f32 v81, v81, v32, v33
    v_max3_f32 v80, v80, v18, v19
    v_max3_f32 v81, v81, v34, v35
    v_max3_f32 v80, v80, v20, v21
    v_max3_f32 v81, v81, v36, v37
    v_max3_f32 v80, v80, v22, v23
    v_max3_f32 v81, v81, v38, v39
    v_max3_f32 v80, v80, v24, v25
    v_max3_f32 v81, v81, v40, v41
    v_max3_f32 v80, v80, v26, v27
    v_max3_f32 v81, v81, v42, v43
    v_max3_f32 v80, v80, v28, v29
    v_max3_f32 v81, v81, v44, v45
    v_max3_f32 v80, v80, v30, v31
    v_max3_f32 v81, v81, v46, v47
    v_max3_f32 v80, v80, v48, v49
    v_max3_f32 v81, v81, v64, v65
    v_max3_f32 v80, v80, v50, v51
    v_max3_f32 v81, v81, v66, v67
    v_max3_f32 v80, v80, v52, v53
    v_max3_f32 v81, v81, v68, v69
    v_max3_f32 v80, v80, v54, v55
    v_max3_f32 v81, v81, v70, v71
    v_max3_f32 v80, v80, v56, v57
    v_max3_f32 v81, v81, v72, v73
    v_max3_f32 v80, v80, v58, v59
    v_max3_f32 v81, v81, v74, v75
    v_max3_f32 v80, v80, v60, v61
    v_max3_f32 v81, v81, v76, v77
    v_max3_f32 v80, v80, v62, v63
    v_max3_f32 v81, v81, v78, v79
    s_branch S_next
S_exp:
    v_sub_f32 v16, v16, v80
    v_sub_f32 v17, v17, v80
    v_sub_f32 v18, v18, v80
    v_sub_f32 v19, v19, v80
    v_sub_f32 v20, v20, v80
    v_sub_f32 v21, v21, v80
    v_sub_f32 v22, v22, v80
    v_sub_f32 v23, v23, v80
    v_sub_f32 v24, v24, v80
    v_sub_f32 v25, v25, v80
    v_sub_f32 v26, v26, v80
    v_sub_f32 v27, v27, v80
    v_sub_f32 v28, v28, v80
    v_sub_f32 v29, v29, v80
    v_sub_f32 v30, v30, v80
    v_sub_f32 v31, v31, v80
    v_sub_f32 v32, v32, v81
    v_sub_f32 v33, v33, v81
    v_sub_f32 v34, v34, v81
    v_sub_f32 v35, v35, v81
    v_sub_f32 v36, v36, v81
    v_sub_f32 v37, v37, v81
    v_sub_f32 v38, v38, v81
    v_sub_f32 v39, v39, v81
    v_sub_f32 v40, v40, v81
    v_sub_f32 v41, v41, v81
    v_sub_f32 v42, v42, v81
    v_sub_f32 v43, v43, v81
    v_sub_f32 v44, v44, v81
    v_sub_f32 v45, v45, v81
    v_sub_f32 v46, v46, v81
    v_sub_f32 v47, v47, v81
    v_exp_f32 v16, v16
    v_exp_f32 v17, v17
    v_exp_f32 v18, v18
    v_exp_f32 v19, v19
    v_exp_f32 v20, v20
    v_exp_f32 v21, v21
    v_exp_f32 v22, v22
    v_exp_f32 v23, v23
    v_exp_f32 v24, v24
    v_exp_f32 v25, v25
    v_exp_f32 v26, v26
    v_exp_f32 v27, v27
    v_exp_f32 v28, v28
    v_exp_f32 v29, v29
    v_exp_f32 v30, v30
    v_exp_f32 v31, v31
    v_exp_f32 v32, v32
    v_exp_f32 v33, v33
    v_exp_f32 v34, v34
    v_exp_f32 v35, v35
    v_exp_f32 v36, v36
    v_exp_f32 v37, v37
    v_exp_f32 v38, v38
    v_exp_f32 v39, v39
    v_exp_f32 v40, v40
    v_exp_f32 v41, v41
    v_exp_f32 v42, v42
    v_exp_f32 v43, v43
    v_exp_f32 v44, v44
    v_exp_f32 v45, v45
    v_exp_f32 v46, v46
    v_exp_f32 v47, v47
    v_sub_f32 v48, v48, v80
    v_sub_f32 v49, v49, v80
    v_sub_f32 v50, v50, v80
    v_sub_f32 v51, v51, v80
    v_sub_f32 v52, v52, v80
    v_sub_f32 v53, v53, v80
    v_sub_f32 v54, v54, v80
    v_sub_f32 v55, v55, v80
    v_sub_f32 v56, v56, v80
    v_sub_f32 v57, v57, v80
    v_sub_f32 v58, v58, v80
    v_sub_f32 v59, v59, v80
    v_sub_f32 v60, v60, v80
    v_sub_f32 v61, v61, v80
    v_sub_f32 v62, v62, v80
    v_sub_f32 v63, v63, v80
    v_sub_f32 v64, v64, v81
    v_sub_f32 v65, v65, v81
    v_sub_f32 v66, v66, v81
    v_sub_f32 v67, v67, v81
    v_sub_f32 v68, v68, v81
    v_sub_f32 v69, v69, v81
    v_sub_f32 v70, v70, v81
    v_sub_f32 v71, v71, v81
    v_sub_f32 v72, v72, v81
    v_sub_f32 v73, v73, v81
    v_sub_f32 v74, v74, v81
    v_sub_f32 v75, v75, v81
    v_sub_f32 v76, v76, v81
    v_sub_f32 v77, v77, v81
    v_sub_f32 v78, v78, v81
    v_sub_f32 v79, v79, v81
    v_exp_f32 v48, v48
    v_exp_f32 v49, v49
    v_exp_f32 v50, v50
    v_exp_f32 v51, v51
    v_exp_f32 v52, v52
    v_exp_f32 v53, v53
    v_exp_f32 v54, v54
    v_exp_f32 v55, v55
    v_exp_f32 v56, v56
    v_exp_f32 v57, v57
    v_exp_f32 v58, v58
    v_exp_f32 v59, v59
    v_exp_f32 v60, v60
    v_exp_f32 v61, v61
    v_exp_f32 v62, v62
    v_exp_f32 v63, v63
    v_exp_f32 v64, v64
    v_exp_f32 v65, v65
    v_exp_f32 v66, v66
    v_exp_f32 v67, v67
    v_exp_f32 v68, v68
    v_exp_f32 v69, v69
    v_exp_f32 v70, v70
    v_exp_f32 v71, v71
    v_exp_f32 v72, v72
    v_exp_f32 v73, v73
    v_exp_f32 v74, v74
    v_exp_f32 v75, v75
    v_exp_f32 v76, v76
    v_exp_f32 v77, v77
    v_exp_f32 v78, v78
    v_exp_f32 v79, v79
    s_nop 1
    v_smfmac_f32_32x32x32_bf16 v[112:127], v[184:187], v[16:23], v216
    v_smfmac_f32_32x32x32_bf16 v[112:127], v[188:191], v[24:31], v216
    v_smfmac_f32_32x32x32_bf16 v[128:143], v[184:187], v[32:39], v216
    v_smfmac_f32_32x32x32_bf16 v[128:143], v[188:191], v[40:47], v216
    v_smfmac_f32_32x32x32_bf16 v[112:127], v[192:195], v[48:55], v216
    v_smfmac_f32_32x32x32_bf16 v[112:127], v[196:199], v[56:63], v216
    v_smfmac_f32_32x32x32_bf16 v[128:143], v[192:195], v[64:71], v216
    v_smfmac_f32_32x32x32_bf16 v[128:143], v[196:199], v[72:79], v216
S_next:
    s_add_u32 s66, s66, 221184
    s_add_u32 s67, s67, 221184
    s_add_u32 s68, s68, 221184
    s_add_u32 s29, s29, 1
    s_cmp_lt_u32 s29, 32
    s_cbranch_scc1 S_loop
    s_cmp_lg_u32 s48, 0
    s_nop 7
    s_cbranch_scc1 S_done
    v_mov_b32 v14, v80
    v_mov_b32 v13, v81
    s_nop 1
    v_permlane32_swap_b32 v14, v80
    v_permlane32_swap_b32 v13, v81
    s_mov_b32 s48, 1
    v_max_f32 v80, v14, v80
    v_max_f32 v81, v13, v81
    s_branch S_pass
S_done:
    v_permlane32_swap_b32 v120, v136
    v_permlane32_swap_b32 v121, v137
    v_permlane32_swap_b32 v122, v138
    s_branch B_norm
L_idle:
    s_cmp_ge_u32 s2, 252
    s_cbranch_scc1 L_idle1
    s_bfe_u32 s29, s2, 0x10003
    s_and_b32 s30, s2, 1
    s_lshl1_add_u32 s30, s30, s29
    s_add_u32 s30, s30, 16
    s_mul_i32 s30, s30, 73728
    s_lshl_b32 s29, s10, 7
    s_add_u32 s30, s30, s29
    v_mul_u32_u24 v22, 1152, v0
    s_mov_b32 s22, 2359296
    s_mov_b32 s23, 0x00020000
    s_waitcnt lgkmcnt(0)
    buffer_load_dword v255, v22, s[20:23], s30 offen offset:128
L_idle1:
    s_waitcnt lgkmcnt(0)
    s_mov_b32 s16, s58
    s_mov_b32 s17, s59
    s_mov_b32 s18, 9568256
    s_mov_b32 s19, 0x00020000
    s_mov_b32 s60, s56
    s_mov_b32 s61, s57
    s_mov_b32 s62, 256
    s_mov_b32 s63, 0x00020000
    v_mov_b32 v12, 0
    v_mov_b32 v13, 0
    v_and_b32 v14, 15, v0
    v_lshlrev_b32 v14, 2, v14
    v_add_u32 v14, 163776, v14
    ds_write_b32 v14, v12
    s_cmp_lt_u32 s2, 252
    s_cbranch_scc1 L_idle2
    s_lshl_b32 s28, s10, 13
    v_lshrrev_b32 v1, 2, v0
    v_lshlrev_b32 v1, 7, v1
    v_and_b32 v2, 3, v0
    v_lshl_add_u32 v1, v2, 4, v1
    v_add_u32 v1, s28, v1
    v_mov_b64 v[4:5], 0
    v_mov_b64 v[6:7], 0
    s_cmp_eq_u32 s2, 255
    s_cselect_b32 s28, 0, 65536
    s_cselect_b32 s29, 0, 128
    s_add_u32 s28, s28, 9437184
    buffer_store_dwordx4 v[4:7], v1, s[16:19], s28 offen sc1
    s_add_u32 s28, s28, 2048
    buffer_store_dwordx4 v[4:7], v1, s[16:19], s28 offen sc1
    s_add_u32 s28, s28, 2048
    buffer_store_dwordx4 v[4:7], v1, s[16:19], s28 offen sc1
    s_add_u32 s28, s28, 2048
    buffer_store_dwordx4 v[4:7], v1, s[16:19], s28 offen sc1
    s_waitcnt vmcnt(0)
    s_barrier
    s_cmp_lg_u32 s10, 0
    s_cbranch_scc1 L_idle2
    v_mov_b32 v13, 1
    s_mov_b64 exec, 1
    buffer_store_dword v13, v12, s[60:63], s29 offen sc1
    s_mov_b64 exec, -1
L_idle2:
    s_waitcnt lgkmcnt(0)
    s_cmp_lt_u32 s10, 4
    s_cbranch_scc0 L_idleB
    s_and_b32 s28, s2, 7
    s_lshr_b32 s29, s2, 3
    s_lshl_b32 s15, s28, 2
    s_lshr_b32 s30, s29, 3
    s_add_u32 s15, s15, s30
    s_and_b32 s29, s29, 7
    s_and_b32 s49, s15, 1
    s_lshr_b32 s30, s15, 1
    s_mul_i32 s31, s30, 4608
    s_mul_i32 s32, s49, 2560
    s_add_u32 s32, s32, s31
    s_add_u32 s33, s31, 2048
    s_mul_i32 s42, s11, 221184
    s_mul_i32 s43, s11, 4864
    v_lshlrev_b32 v20, 4, v0
    v_add_u32 v1, s32, v20
    v_mov_b32 v2, v1
    s_mul_i32 s34, s15, 288
    s_add_u32 s34, s34, 71168
    s_movk_i32 s35, 8928
    v_add_u32 v22, s34, v20
    v_add_u32 v21, -32, v0
    v_max_i32 v21, 0, v21
    v_mul_u32_u24 v21, 3641, v21
    v_lshrrev_b32 v21, 16, v21
    v_mad_u32_u24 v3, v21, s35, v22
    v_add_u32 v21, 32, v0
    v_max_i32 v21, 0, v21
    v_mul_u32_u24 v21, 3641, v21
    v_lshrrev_b32 v21, 16, v21
    v_mad_u32_u24 v4, v21, s35, v22
    v_add_u32 v21, 80, v0
    v_max_i32 v21, 0, v21
    v_mul_u32_u24 v21, 3641, v21
    v_lshrrev_b32 v21, 16, v21
    v_mad_u32_u24 v5, v21, s35, v22
    v_cmp_gt_u32 vcc, 32, v0
    v_add_u32 v21, s31, v20
    s_nop 0
    v_cndmask_b32 v3, v3, v21, vcc
    v_lshlrev_b32 v6, 8, v0
    s_lshr_b32 s44, s11, 1
    s_lshl_b32 s34, s15, 4
    s_add_u32 s44, s44, s34
    s_lshl_b32 s44, s44, 7
    s_add_u32 s44, s44, 9437184
    s_and_b32 s28, s2, 7
    s_lshr_b32 s29, s2, 3
    s_lshl_b32 s30, s28, 2
    s_and_b32 s31, s29, 3
    s_add_u32 s30, s30, s31
    s_lshr_b32 s31, s29, 2
    s_mul_i32 s33, s31, 144
    s_mul_i32 s45, s11, 8064
    s_add_u32 s45, s45, s33
    s_mul_i32 s46, s11, 1008
    s_add_u32 s46, s46, 77824
    s_mul_i32 s34, s30, 73728
    s_add_u32 s66, s34, 7077888
    s_lshl_b32 s67, s11, 6
    s_add_u32 s67, s67, s66
    s_add_u32 s67, s67, 2048
    s_lshl_b32 s35, s11, 9
    s_add_u32 s66, s66, s35
    s_add_u32 s68, s34, s33
    s_lshr_b32 s35, s11, 1
    s_mul_i32 s35, s35, 36864
    s_add_u32 s68, s68, s35
    s_and_b32 s35, s11, 1
    s_mul_i32 s35, s35, 9216
    s_add_u32 s68, s68, s35
    s_mul_i32 s70, s11, 2560
    s_add_u32 s70, s70, 20480
    s_lshl_b32 s69, s30, 3
    s_add_u32 s69, s69, s31
    s_lshl_b32 s69, s69, 7
    s_add_u32 s69, s69, 9502720
    v_mul_u32_u24 v21, 7282, v0
    v_lshrrev_b32 v21, 16, v21
    v_mul_u32_u24 v7, 1008, v21
    v_add_u32 v7, v20, v7
    v_and_b32 v22, 15, v0
    v_lshrrev_b32 v23, 4, v0
    v_lshrrev_b32 v24, 5, v0
    v_mul_u32_u24 v8, 2304, v24
    v_and_b32 v25, 31, v0
    v_lshl_add_u32 v8, v25, 4, v8
    v_lshlrev_b32 v19, 7, v0
    v_lshrrev_b32 v25, 2, v0
    v_mul_u32_u24 v9, 2240, v25
    v_add_u32 v9, v20, v9
    v_lshrrev_b32 v25, 2, v22
    v_mul_u32_u24 v24, 18, v24
    v_and_b32 v26, 1, v23
    v_lshl_add_u32 v24, v26, 2, v24
    v_and_b32 v26, 1, v25
    v_lshl_add_u32 v24, v26, 1, v24
    v_and_b32 v26, 8, v22
    v_add_u32 v24, v24, v26
    v_lshrrev_b32 v26, 1, v25
    v_lshl_add_u32 v26, v23, 2, v26
    v_mul_u32_u24 v26, 18, v26
    v_and_b32 v25, 1, v25
    v_add3_u32 v26, v26, v25, 16
    v_and_b32 v25, 3, v0
    v_lshlrev_b32 v25, 3, v25
    v_add_u32 v25, 77824, v25
    s_movk_i32 s34, 144
    v_mad_u32_u24 v10, v24, s34, v25
    v_mad_u32_u24 v12, v26, s34, v25
    v_add_u32 v11, 41472, v10
    v_mul_u32_u24 v13, 160, v22
    v_lshl_add_u32 v13, v23, 3, v13
    v_lshl_add_u32 v14, v21, 4, v20
    v_mul_u32_u24 v22, 144, v21
    v_sub_u32 v22, v20, v22
    s_movk_i32 s34, 1152
    v_add_u32 v23, 0, v21
    v_and_b32 v24, 1, v23
    v_lshrrev_b32 v23, 1, v23
    v_lshl_add_u32 v23, v24, 4, v23
    v_mad_u32_u24 v16, v23, s34, v22
    v_add_u32 v23, 7, v21
    v_and_b32 v24, 1, v23
    v_lshrrev_b32 v23, 1, v23
    v_lshl_add_u32 v23, v24, 4, v23
    v_mad_u32_u24 v17, v23, s34, v22
    v_add_u32 v23, 14, v21
    v_and_b32 v24, 1, v23
    v_lshrrev_b32 v23, 1, v23
    v_lshl_add_u32 v23, v24, 4, v23
    v_mad_u32_u24 v18, v23, s34, v22
    s_waitcnt vmcnt(0)
    s_mov_b32 s12, 0
    s_setprio 3
    s_barrier
    s_branch A_post
L_idleB:
    s_and_b32 s28, s2, 7
    s_lshr_b32 s29, s2, 3
    s_lshl_b32 s15, s28, 2
    s_lshr_b32 s30, s29, 3
    s_add_u32 s15, s15, s30
    s_and_b32 s29, s29, 7
    s_and_b32 s49, s15, 1
    s_lshr_b32 s30, s15, 1
    s_mul_i32 s31, s30, 4608
    s_mul_i32 s32, s49, 2560
    s_add_u32 s32, s32, s31
    s_add_u32 s33, s31, 2048
    s_lshl_b32 s46, s29, 2
    s_add_u32 s46, s46, s11
    s_mul_i32 s42, s46, 221184
    s_add_u32 s42, s42, 147456
    s_add_u32 s43, s11, 16
    s_mul_i32 s66, s43, 4864
    s_mul_i32 s43, s43, 221184
    s_mul_i32 s67, s11, 2560
    s_add_u32 s67, s67, 116736
    s_xor_b32 s68, s11, 1
    s_mul_i32 s68, s68, 2560
    s_add_u32 s68, s68, 116736
    s_mov_b32 s44, s33
    s_mov_b32 s45, s32
    s_and_b32 s47, s11, 1
    s_mul_i32 s34, s47, 9728
    s_add_u32 s34, s34, 77824
    v_and_b32 v1, 31, v0
    v_lshrrev_b32 v2, 5, v0
    v_lshlrev_b32 v9, 3, v1
    v_lshl_add_u32 v9, v2, 10, v9
    v_lshlrev_b32 v10, 3, v0
    v_lshlrev_b32 v7, 4, v0
    v_add_u32 v3, s34, v9
    v_add_u32 v4, 0x100, v3
    v_mul_u32_u24 v5, 288, v2
    v_lshl_add_u32 v5, v1, 4, v5
    s_addk_i32 s34, 2048
    v_add_u32 v6, s34, v10
    s_addk_i32 s34, 512
    v_add_u32 v5, s34, v5
    v_mul_u32_u24 v225, 9216, v2
    v_lshl_add_u32 v225, v1, 4, v225
    s_mov_b32 s40, 0x3ffff
    s_mov_b32 s41, s40
    s_mul_i32 s34, s11, 4864
    s_xor_b32 s35, s11, 1
    s_mul_i32 s35, s35, 4864
    v_add_u32 v219, s34, v7
    v_add_u32 v220, s34, v10
    v_lshl_add_u32 v221, v0, 2, s34
    v_add_u32 v222, s35, v7
    v_add_u32 v223, s35, v10
    v_lshl_add_u32 v224, v0, 2, s35
    v_lshrrev_b32 v217, 4, v1
    v_lshlrev_b32 v217, 9, v217
    v_lshl_add_u32 v217, v2, 8, v217
    v_and_b32 v11, 15, v1
    v_lshl_add_u32 v217, v11, 4, v217
    v_lshlrev_b32 v218, 2, v0
    v_lshlrev_b32 v228, 7, v0
    s_lshl_b32 s28, s46, 5
    s_add_u32 s28, s28, s15
    s_mul_i32 s50, s28, 2304
    s_add_u32 s50, s50, 7077888
    s_lshl_b32 s69, s46, 10
    s_add_u32 s69, s69, 9502720
    v_add_u32 v230, s32, v7
    v_mov_b32 v231, v230
    s_mul_i32 s34, s15, 288
    s_add_u32 s34, s34, 71168
    s_movk_i32 s35, 8928
    v_add_u32 v12, s34, v7
    v_add_u32 v11, -32, v0
    v_max_i32 v11, 0, v11
    v_mul_u32_u24 v11, 3641, v11
    v_lshrrev_b32 v11, 16, v11
    v_mad_u32_u24 v232, v11, s35, v12
    v_add_u32 v11, 32, v0
    v_max_i32 v11, 0, v11
    v_mul_u32_u24 v11, 3641, v11
    v_lshrrev_b32 v11, 16, v11
    v_mad_u32_u24 v233, v11, s35, v12
    v_add_u32 v11, 80, v0
    v_max_i32 v11, 0, v11
    v_mul_u32_u24 v11, 3641, v11
    v_lshrrev_b32 v11, 16, v11
    v_mad_u32_u24 v234, v11, s35, v12
    v_cmp_gt_u32 vcc, 32, v0
    v_add_u32 v11, s31, v7
    s_nop 0
    v_cndmask_b32 v232, v232, v11, vcc
    s_lshr_b32 s34, s46, 1
    s_lshl_b32 s35, s15, 4
    s_add_u32 s34, s34, s35
    s_lshl_b32 s34, s34, 7
    s_add_u32 s51, s34, 9437188
    v_add_u32 v235, s68, v9
    v_add_u32 v236, 0x100, v235
    v_add_u32 v237, s68, v10
    v_add_u32 v238, s67, v9
    v_add_u32 v239, 0x100, v238
    v_add_u32 v240, s67, v10
    v_mov_b32 v229, 163776
    v_cmp_eq_u32 vcc, 0, v0
    v_mov_b32 v11, 0x29000
    s_lshl_b32 s34, s11, 2
    v_cndmask_b32 v241, v11, v229, vcc
    s_xor_b32 s35, s34, 4
    v_add_u32 v243, s34, v241
    v_add_u32 v244, s35, v229
    s_cmp_eq_u32 s49, 0
    s_cselect_b32 s70, -1, 0
    s_cselect_b32 s71, 0, -1
    v_mov_b32 v216, 0xdddddddd
    v_cmp_eq_u32 vcc, 18, v1
    v_mov_b32 v11, 0x3f803f80
    v_mov_b32 v226, 0
    v_cndmask_b32 v184, 0, v11, vcc
    v_cndmask_b32 v185, 0, v11, vcc
    v_mov_b32 v227, 1
    s_mov_b32 exec_lo, 0x1
    s_mov_b32 exec_hi, 0x0
    s_mov_b32 s29, 0
B_pollgoi:
    buffer_load_dword v11, v226, s[60:63], 0 offen offset:0 sc1
    s_add_u32 s29, s29, 1
    s_cmp_ge_u32 s29, 262144
    s_cbranch_scc1 L_end
    s_waitcnt vmcnt(0)
    v_cmp_eq_u32 vcc, 0, v11
    s_cbranch_vccnz B_pollgoi
    s_mov_b64 exec, -1
    s_barrier
    s_branch B_noflag
.p2align 12
B_w2:
I_s3:
    s_cbranch_execz A_start
    s_cmp_eq_u32 s4, 5
    s_cselect_b32 s6, s26, 0
    s_sub_u32 s39, s39, s6
    s_add_u32 m0, s64, 40960
    s_add_u32 s73, s39, 1105920
    buffer_load_dwordx4 v18, s[24:27], s73 offen lds
    s_add_u32 m0, s64, 45056
    s_add_u32 s73, s39, 1216512
    buffer_load_dwordx4 v18, s[24:27], s73 offen lds
    s_cmp_eq_u32 s4, 6
    s_cselect_b32 s6, s26, 0
    s_sub_u32 s39, s39, s6
    s_add_u32 m0, s64, 49152
    s_add_u32 s73, s39, 1327104
    buffer_load_dwordx4 v18, s[24:27], s73 offen lds
    s_add_u32 m0, s64, 53248
    s_add_u32 s73, s39, 1437696
    buffer_load_dwordx4 v18, s[24:27], s73 offen lds
    s_cmp_eq_u32 s4, 7
    s_cselect_b32 s6, s26, 0
    s_sub_u32 s39, s39, s6
    s_add_u32 m0, s64, 57344
    s_add_u32 s73, s39, 1548288
    buffer_load_dwordx4 v18, s[24:27], s73 offen lds
    s_add_u32 m0, s64, 61440
    s_add_u32 s73, s39, 1658880
    buffer_load_dwordx4 v18, s[24:27], s73 offen lds
    s_add_u32 m0, s64, 65536
    s_add_u32 s73, s39, 1769472
    buffer_load_dwordx4 v18, s[24:27], s73 offen lds
    s_add_u32 m0, s64, 69632
    s_add_u32 s73, s39, 1880064
    buffer_load_dwordx4 v18, s[24:27], s73 offen lds
    s_waitcnt vmcnt(12)
    v_readfirstlane_b32 s65, v19
    s_cmp_lg_u32 s65, 0
    s_cbranch_scc1 B_goa
    s_mov_b32 exec_lo, 0x1
    s_mov_b32 exec_hi, 0x0
    s_mov_b32 s29, 0
B_goap:
    buffer_load_dword v11, v226, s[60:63], 0 offen offset:0 sc1
    s_add_u32 s29, s29, 1
    s_cmp_ge_u32 s29, 262144
    s_cbranch_scc1 L_end
    s_waitcnt vmcnt(0)
    v_cmp_eq_u32 vcc, 0, v11
    s_cbranch_vccnz B_goap
    s_mov_b64 exec, -1
B_goa:
    s_barrier
    s_waitcnt vmcnt(0)
    s_barrier
B_noflag:
    s_setprio 3
    s_mov_b64 exec, 1
    s_mov_b32 s29, 0
    v_mov_b32 v246, 0
    buffer_atomic_add v246, v226, s[16:19], s51 offen sc0 sc1
    s_mov_b64 exec, -1
    v_mov_b64 v[186:187], v[184:185]
    v_mov_b64 v[188:189], v[184:185]
    v_mov_b64 v[190:191], v[184:185]
    v_mov_b64 v[192:193], v[184:185]
    v_mov_b64 v[194:195], v[184:185]
    v_mov_b64 v[196:197], v[184:185]
    v_mov_b64 v[198:199], v[184:185]
    v_mov_b64 v[200:201], v[184:185]
    v_mov_b64 v[202:203], v[184:185]
    v_mov_b64 v[204:205], v[184:185]
    v_mov_b64 v[206:207], v[184:185]
    v_mov_b64 v[208:209], v[184:185]
    v_mov_b64 v[210:211], v[184:185]
    v_mov_b64 v[212:213], v[184:185]
    v_mov_b64 v[214:215], v[184:185]
    v_mov_b64 v[80:81], 0
    v_mov_b64 v[82:83], 0
    v_mov_b64 v[84:85], 0
    v_mov_b64 v[86:87], 0
    v_mov_b64 v[88:89], 0
    v_mov_b64 v[90:91], 0
    v_mov_b64 v[92:93], 0
    v_mov_b64 v[94:95], 0
    v_mov_b64 v[96:97], 0
    v_mov_b64 v[98:99], 0
    v_mov_b64 v[100:101], 0
    v_mov_b64 v[102:103], 0
    v_mov_b64 v[104:105], 0
    v_mov_b64 v[106:107], 0
    v_mov_b64 v[108:109], 0
    v_mov_b64 v[110:111], 0
    v_mov_b64 v[112:113], 0
    v_mov_b64 v[114:115], 0
    v_mov_b64 v[116:117], 0
    v_mov_b64 v[118:119], 0
    v_mov_b64 v[120:121], 0
    v_mov_b64 v[122:123], 0
    v_mov_b64 v[124:125], 0
    v_mov_b64 v[126:127], 0
    v_mov_b64 v[128:129], 0
    v_mov_b64 v[130:131], 0
    v_mov_b64 v[132:133], 0
    v_mov_b64 v[134:135], 0
    v_mov_b64 v[136:137], 0
    v_mov_b64 v[138:139], 0
    v_mov_b64 v[140:141], 0
    v_mov_b64 v[142:143], 0
    s_mov_b64 exec, 1
B_poll1:
    v_mov_b32 v247, 0
    buffer_atomic_add v247, v226, s[16:19], s51 offen sc0 sc1
    s_waitcnt vmcnt(1)
    v_cmp_gt_u32 vcc, 0xe8, v246
    s_cbranch_vccz B_poll1d
    v_mov_b32 v246, 0
    buffer_atomic_add v246, v226, s[16:19], s51 offen sc0 sc1
    s_waitcnt vmcnt(1)
    v_cmp_gt_u32 vcc, 0xe8, v247
    s_cbranch_vccz B_poll1d
    s_add_u32 s29, s29, 1
    s_cmp_lt_u32 s29, 262144
    s_cbranch_scc1 B_poll1
    s_branch L_end
B_poll1d:
    s_mov_b64 exec, -1
    s_mov_b32 m0, s67
    s_mov_b32 exec_hi, 0
    buffer_load_dwordx4 v232, s[16:19], s42 offen offset:2048 sc1 lds
    s_mov_b32 exec_hi, -1
    buffer_load_dwordx4 v230, s[16:19], s42 offen sc1 lds
    buffer_load_dwordx4 v230, s[16:19], s42 offen offset:1024 sc1 lds
    s_mov_b32 m0, s66
    s_mov_b32 s29, 0
    s_cmp_eq_u32 s47, 0
    s_cbranch_scc1 B_even
    s_waitcnt vmcnt(0)
    ds_add_u32 v241, v227
B_even:
    buffer_load_dwordx4 v230, s[16:19], s43 offen offset:0 sc1 lds
    buffer_load_dwordx4 v231, s[16:19], s43 offen offset:1024 sc1 lds
    buffer_load_dwordx4 v232, s[16:19], s43 offen offset:2048 sc1 lds
    buffer_load_dwordx4 v233, s[16:19], s43 offen offset:3072 sc1 lds
    buffer_load_dwordx4 v234, s[16:19], s43 offen offset:3840 sc1 lds
    s_cbranch_scc0 B_sync
    s_waitcnt vmcnt(0)
    ds_add_u32 v241, v227
B_sync:
    ds_read_b32 v11, v229
    ds_read_b64 v[160:161], v237 offset:2048
    ds_read_b64 v[164:165], v6 offset:0
    ds_read2st64_b64 v[144:147], v235 offset0:0 offset1:1
    ds_read2st64_b64 v[148:151], v236 offset0:0 offset1:1
    ds_read2st64_b64 v[168:171], v3 offset0:0 offset1:1
    s_add_u32 s29, s29, 1
    s_cmp_ge_u32 s29, 2097152
    s_cbranch_scc1 L_end
    s_waitcnt lgkmcnt(5)
    v_cmp_gt_u32 vcc, 4, v11
    s_cbranch_vccnz B_sync
    s_waitcnt lgkmcnt(3)
    v_and_b32 v160, s70, v160
    v_and_b32 v161, s71, v161
    s_nop 1
    v_mfma_f32_32x32x4_2b_bf16 v[16:47], v[164:165], v[160:161], 0 cbsz:1 abid:0
    ds_read2st64_b64 v[172:175], v4 offset0:0 offset1:1
    s_mov_b64 exec, s[40:41]
    ds_read_b128 v[184:187], v5 offset:0
    ds_read_b128 v[188:191], v5 offset:576
    ds_read_b128 v[192:195], v5 offset:1152
    ds_read_b128 v[196:199], v5 offset:1728
    s_mov_b64 exec, -1
    ds_read_b64 v[162:163], v240 offset:2048
    ds_read2st64_b64 v[152:155], v238 offset0:0 offset1:1
    ds_read2st64_b64 v[156:159], v239 offset0:0 offset1:1
    s_nop 6
    s_waitcnt lgkmcnt(8)
    v_mfma_f32_32x32x16_bf16 v[16:31], v[168:171], v[144:147], v[16:31]
    v_mfma_f32_32x32x16_bf16 v[32:47], v[168:171], v[148:151], v[32:47]
    s_setprio 1
    s_nop 5
    s_waitcnt lgkmcnt(0)
    ds_add_u32 v241, v227 offset:12
    v_and_b32 v162, s70, v162
    v_and_b32 v163, s71, v163
    v_exp_f32 v16, v16
    v_exp_f32 v17, v17
    v_exp_f32 v18, v18
    v_exp_f32 v19, v19
    v_exp_f32 v20, v20
    v_mfma_f32_32x32x4_2b_bf16 v[48:79], v[164:165], v[160:161], 0 cbsz:1 abid:1
    v_exp_f32 v21, v21
    v_exp_f32 v22, v22
    v_exp_f32 v23, v23
    v_exp_f32 v24, v24
    v_exp_f32 v25, v25
    v_exp_f32 v26, v26
    v_exp_f32 v27, v27
    v_exp_f32 v28, v28
    v_smfmac_f32_32x32x32_bf16 v[80:95], v[184:187], v[16:23], v216
    v_exp_f32 v29, v29
    v_exp_f32 v30, v30
    v_exp_f32 v31, v31
    v_exp_f32 v32, v32
    v_exp_f32 v33, v33
    v_smfmac_f32_32x32x32_bf16 v[80:95], v[188:191], v[24:31], v216
    v_exp_f32 v34, v34
    v_exp_f32 v35, v35
    v_exp_f32 v36, v36
    v_exp_f32 v37, v37
    v_mfma_f32_32x32x16_bf16 v[48:63], v[172:175], v[144:147], v[48:63]
    v_exp_f32 v38, v38
    v_exp_f32 v39, v39
    v_exp_f32 v40, v40
    v_mfma_f32_32x32x16_bf16 v[64:79], v[172:175], v[148:151], v[64:79]
    v_exp_f32 v41, v41
    v_exp_f32 v42, v42
    v_exp_f32 v43, v43
    v_exp_f32 v44, v44
    v_smfmac_f32_32x32x32_bf16 v[96:111], v[184:187], v[32:39], v216
    v_exp_f32 v45, v45
    v_exp_f32 v46, v46
    v_exp_f32 v47, v47
    v_exp_f32 v48, v48
    v_exp_f32 v49, v49
    v_smfmac_f32_32x32x32_bf16 v[96:111], v[188:191], v[40:47], v216
    v_exp_f32 v50, v50
    v_exp_f32 v51, v51
    v_exp_f32 v52, v52
    v_mfma_f32_32x32x4_2b_bf16 v[16:47], v[164:165], v[162:163], 0 cbsz:1 abid:0
    s_waitcnt vmcnt(0)
    ds_add_u32 v241, v227 offset:4
    v_exp_f32 v53, v53
    v_exp_f32 v54, v54
    v_exp_f32 v55, v55
    v_exp_f32 v56, v56
    v_exp_f32 v57, v57
    v_exp_f32 v58, v58
    v_exp_f32 v59, v59
    v_exp_f32 v60, v60
    v_smfmac_f32_32x32x32_bf16 v[80:95], v[192:195], v[48:55], v216
    v_exp_f32 v61, v61
    v_exp_f32 v62, v62
    v_exp_f32 v63, v63
    v_exp_f32 v64, v64
    v_exp_f32 v65, v65
    v_smfmac_f32_32x32x32_bf16 v[80:95], v[196:199], v[56:63], v216
    v_exp_f32 v66, v66
    v_exp_f32 v67, v67
    v_exp_f32 v68, v68
    v_exp_f32 v69, v69
    v_mfma_f32_32x32x16_bf16 v[16:31], v[168:171], v[152:155], v[16:31]
    v_exp_f32 v70, v70
    v_exp_f32 v71, v71
    v_exp_f32 v72, v72
    v_mfma_f32_32x32x16_bf16 v[32:47], v[168:171], v[156:159], v[32:47]
    v_exp_f32 v73, v73
    v_exp_f32 v74, v74
    v_exp_f32 v75, v75
    v_exp_f32 v76, v76
    v_smfmac_f32_32x32x32_bf16 v[96:111], v[192:195], v[64:71], v216
    v_exp_f32 v77, v77
    v_exp_f32 v78, v78
    v_exp_f32 v79, v79
    v_exp_f32 v16, v16
    v_exp_f32 v17, v17
    v_smfmac_f32_32x32x32_bf16 v[96:111], v[196:199], v[72:79], v216
    v_exp_f32 v18, v18
    v_exp_f32 v19, v19
    v_exp_f32 v20, v20
    v_mfma_f32_32x32x4_2b_bf16 v[48:79], v[164:165], v[162:163], 0 cbsz:1 abid:1
    v_exp_f32 v21, v21
    v_exp_f32 v22, v22
    v_exp_f32 v23, v23
    v_exp_f32 v24, v24
    v_exp_f32 v25, v25
    v_exp_f32 v26, v26
    v_exp_f32 v27, v27
    v_exp_f32 v28, v28
    v_smfmac_f32_32x32x32_bf16 v[112:127], v[184:187], v[16:23], v216
    v_exp_f32 v29, v29
    ds_read_b32 v242, v229 offset:4
    ds_read_b64 v[166:167], v6 offset:4864
    ds_read2st64_b64 v[176:179], v4 offset0:9 offset1:10
    ds_read2st64_b64 v[180:183], v3 offset0:10 offset1:11
    s_mov_b64 exec, s[40:41]
    ds_read_b128 v[200:203], v5 offset:4864
    ds_read_b128 v[204:207], v5 offset:5440
    ds_read_b128 v[208:211], v5 offset:6016
    ds_read_b128 v[212:215], v5 offset:6592
    s_mov_b64 exec, -1
    v_exp_f32 v30, v30
    v_exp_f32 v31, v31
    v_exp_f32 v32, v32
    v_exp_f32 v33, v33
    v_smfmac_f32_32x32x32_bf16 v[112:127], v[188:191], v[24:31], v216
    v_exp_f32 v34, v34
    v_exp_f32 v35, v35
    v_exp_f32 v36, v36
    v_exp_f32 v37, v37
    v_mfma_f32_32x32x16_bf16 v[48:63], v[172:175], v[152:155], v[48:63]
    v_exp_f32 v38, v38
    v_exp_f32 v39, v39
    v_exp_f32 v40, v40
    v_mfma_f32_32x32x16_bf16 v[64:79], v[172:175], v[156:159], v[64:79]
    v_exp_f32 v41, v41
    v_exp_f32 v42, v42
    v_exp_f32 v43, v43
    v_exp_f32 v44, v44
    v_smfmac_f32_32x32x32_bf16 v[128:143], v[184:187], v[32:39], v216
    v_exp_f32 v45, v45
    v_exp_f32 v46, v46
    v_exp_f32 v47, v47
    v_exp_f32 v48, v48
    v_exp_f32 v49, v49
    v_smfmac_f32_32x32x32_bf16 v[128:143], v[188:191], v[40:47], v216
    v_exp_f32 v50, v50
    v_exp_f32 v51, v51
    v_exp_f32 v52, v52
    s_waitcnt lgkmcnt(0)
    v_cmp_gt_u32 vcc, 4, v242
    s_cbranch_vccnz B_retry1
B_back1:
    v_mfma_f32_32x32x4_2b_bf16 v[16:47], v[166:167], v[160:161], 0 cbsz:1 abid:0
    v_exp_f32 v53, v53
    v_exp_f32 v54, v54
    v_exp_f32 v55, v55
    v_exp_f32 v56, v56
    v_exp_f32 v57, v57
    v_exp_f32 v58, v58
    v_exp_f32 v59, v59
    v_exp_f32 v60, v60
    v_smfmac_f32_32x32x32_bf16 v[112:127], v[192:195], v[48:55], v216
    v_exp_f32 v61, v61
    v_exp_f32 v62, v62
    v_exp_f32 v63, v63
    v_exp_f32 v64, v64
    v_exp_f32 v65, v65
    v_smfmac_f32_32x32x32_bf16 v[112:127], v[196:199], v[56:63], v216
    v_exp_f32 v66, v66
    v_exp_f32 v67, v67
    v_exp_f32 v68, v68
    v_exp_f32 v69, v69
    v_mfma_f32_32x32x16_bf16 v[16:31], v[176:179], v[144:147], v[16:31]
    v_exp_f32 v70, v70
    v_exp_f32 v71, v71
    v_exp_f32 v72, v72
    v_mfma_f32_32x32x16_bf16 v[32:47], v[176:179], v[148:151], v[32:47]
    v_exp_f32 v73, v73
    v_exp_f32 v74, v74
    v_exp_f32 v75, v75
    v_exp_f32 v76, v76
    v_smfmac_f32_32x32x32_bf16 v[128:143], v[192:195], v[64:71], v216
    v_exp_f32 v77, v77
    v_exp_f32 v78, v78
    v_exp_f32 v79, v79
    v_exp_f32 v16, v16
    v_exp_f32 v17, v17
    v_smfmac_f32_32x32x32_bf16 v[128:143], v[196:199], v[72:79], v216
    v_exp_f32 v18, v18
    v_exp_f32 v19, v19
    v_exp_f32 v20, v20
    v_mfma_f32_32x32x4_2b_bf16 v[48:79], v[166:167], v[160:161], 0 cbsz:1 abid:1
    v_exp_f32 v21, v21
    v_exp_f32 v22, v22
    v_exp_f32 v23, v23
    v_exp_f32 v24, v24
    v_exp_f32 v25, v25
    v_exp_f32 v26, v26
    v_exp_f32 v27, v27
    v_exp_f32 v28, v28
    v_smfmac_f32_32x32x32_bf16 v[80:95], v[200:203], v[16:23], v216
    v_exp_f32 v29, v29
    v_exp_f32 v30, v30
    v_exp_f32 v31, v31
    v_exp_f32 v32, v32
    v_exp_f32 v33, v33
    v_smfmac_f32_32x32x32_bf16 v[80:95], v[204:207], v[24:31], v216
    v_exp_f32 v34, v34
    v_exp_f32 v35, v35
    v_exp_f32 v36, v36
    v_exp_f32 v37, v37
    v_mfma_f32_32x32x16_bf16 v[48:63], v[180:183], v[144:147], v[48:63]
    v_exp_f32 v38, v38
    v_exp_f32 v39, v39
    v_exp_f32 v40, v40
    v_mfma_f32_32x32x16_bf16 v[64:79], v[180:183], v[148:151], v[64:79]
    v_exp_f32 v41, v41
    v_exp_f32 v42, v42
    v_exp_f32 v43, v43
    v_exp_f32 v44, v44
    v_smfmac_f32_32x32x32_bf16 v[96:111], v[200:203], v[32:39], v216
    v_exp_f32 v45, v45
    v_exp_f32 v46, v46
    v_exp_f32 v47, v47
    v_exp_f32 v48, v48
    v_exp_f32 v49, v49
    v_smfmac_f32_32x32x32_bf16 v[96:111], v[204:207], v[40:47], v216
    v_exp_f32 v50, v50
    v_exp_f32 v51, v51
    v_exp_f32 v52, v52
    v_mfma_f32_32x32x4_2b_bf16 v[16:47], v[166:167], v[162:163], 0 cbsz:1 abid:0
    v_exp_f32 v53, v53
    v_exp_f32 v54, v54
    v_exp_f32 v55, v55
    v_exp_f32 v56, v56
    v_exp_f32 v57, v57
    v_exp_f32 v58, v58
    v_exp_f32 v59, v59
    v_exp_f32 v60, v60
    v_smfmac_f32_32x32x32_bf16 v[80:95], v[208:211], v[48:55], v216
    v_exp_f32 v61, v61
    v_exp_f32 v62, v62
    v_exp_f32 v63, v63
    v_exp_f32 v64, v64
    v_exp_f32 v65, v65
    v_smfmac_f32_32x32x32_bf16 v[80:95], v[212:215], v[56:63], v216
    v_exp_f32 v66, v66
    v_exp_f32 v67, v67
    v_exp_f32 v68, v68
    v_exp_f32 v69, v69
    v_mfma_f32_32x32x16_bf16 v[16:31], v[176:179], v[152:155], v[16:31]
    v_exp_f32 v70, v70
    v_exp_f32 v71, v71
    v_exp_f32 v72, v72
    v_mfma_f32_32x32x16_bf16 v[32:47], v[176:179], v[156:159], v[32:47]
    v_exp_f32 v73, v73
    v_exp_f32 v74, v74
    v_exp_f32 v75, v75
    v_exp_f32 v76, v76
    v_smfmac_f32_32x32x32_bf16 v[96:111], v[208:211], v[64:71], v216
    v_exp_f32 v77, v77
    v_exp_f32 v78, v78
    v_exp_f32 v79, v79
    v_exp_f32 v16, v16
    v_exp_f32 v17, v17
    v_smfmac_f32_32x32x32_bf16 v[96:111], v[212:215], v[72:79], v216
    v_exp_f32 v18, v18
    v_exp_f32 v19, v19
    v_exp_f32 v20, v20
    v_mfma_f32_32x32x4_2b_bf16 v[48:79], v[166:167], v[162:163], 0 cbsz:1 abid:1
    v_exp_f32 v21, v21
    v_exp_f32 v22, v22
    v_exp_f32 v23, v23
    v_exp_f32 v24, v24
    v_exp_f32 v25, v25
    v_exp_f32 v26, v26
    v_exp_f32 v27, v27
    v_exp_f32 v28, v28
    v_smfmac_f32_32x32x32_bf16 v[112:127], v[200:203], v[16:23], v216
    v_exp_f32 v29, v29
    v_exp_f32 v30, v30
    v_exp_f32 v31, v31
    v_exp_f32 v32, v32
    v_exp_f32 v33, v33
    v_smfmac_f32_32x32x32_bf16 v[112:127], v[204:207], v[24:31], v216
    v_exp_f32 v34, v34
    v_exp_f32 v35, v35
    v_exp_f32 v36, v36
    v_exp_f32 v37, v37
    v_mfma_f32_32x32x16_bf16 v[48:63], v[180:183], v[152:155], v[48:63]
    v_exp_f32 v38, v38
    v_exp_f32 v39, v39
    v_exp_f32 v40, v40
    v_mfma_f32_32x32x16_bf16 v[64:79], v[180:183], v[156:159], v[64:79]
    v_exp_f32 v41, v41
    ds_read_b32 v242, v229 offset:8
    ds_read_b64 v[164:165], v6 offset:19456
    ds_read2st64_b64 v[168:171], v3 offset0:38 offset1:39
    ds_read2st64_b64 v[172:175], v4 offset0:38 offset1:39
    s_mov_b64 exec, s[40:41]
    ds_read_b128 v[184:187], v5 offset:19456
    ds_read_b128 v[188:191], v5 offset:20032
    ds_read_b128 v[192:195], v5 offset:20608
    ds_read_b128 v[196:199], v5 offset:21184
    s_mov_b64 exec, -1
    v_exp_f32 v42, v42
    v_exp_f32 v43, v43
    v_exp_f32 v44, v44
    v_smfmac_f32_32x32x32_bf16 v[128:143], v[200:203], v[32:39], v216
    v_exp_f32 v45, v45
    v_exp_f32 v46, v46
    v_exp_f32 v47, v47
    v_exp_f32 v48, v48
    v_exp_f32 v49, v49
    v_smfmac_f32_32x32x32_bf16 v[128:143], v[204:207], v[40:47], v216
    v_exp_f32 v50, v50
    v_exp_f32 v51, v51
    v_exp_f32 v52, v52
    s_waitcnt lgkmcnt(0)
    v_cmp_gt_u32 vcc, 4, v242
    s_cbranch_vccnz B_retry2
B_back2:
    v_mfma_f32_32x32x4_2b_bf16 v[16:47], v[164:165], v[160:161], 0 cbsz:1 abid:0
    v_exp_f32 v53, v53
    v_exp_f32 v54, v54
    v_exp_f32 v55, v55
    v_exp_f32 v56, v56
    v_exp_f32 v57, v57
    v_exp_f32 v58, v58
    v_exp_f32 v59, v59
    v_exp_f32 v60, v60
    v_smfmac_f32_32x32x32_bf16 v[112:127], v[208:211], v[48:55], v216
    v_exp_f32 v61, v61
    v_exp_f32 v62, v62
    v_exp_f32 v63, v63
    v_exp_f32 v64, v64
    v_exp_f32 v65, v65
    v_smfmac_f32_32x32x32_bf16 v[112:127], v[212:215], v[56:63], v216
    v_exp_f32 v66, v66
    v_exp_f32 v67, v67
    v_exp_f32 v68, v68
    v_exp_f32 v69, v69
    v_mfma_f32_32x32x16_bf16 v[16:31], v[168:171], v[144:147], v[16:31]
    v_exp_f32 v70, v70
    v_exp_f32 v71, v71
    v_exp_f32 v72, v72
    v_mfma_f32_32x32x16_bf16 v[32:47], v[168:171], v[148:151], v[32:47]
    v_exp_f32 v73, v73
    v_exp_f32 v74, v74
    v_exp_f32 v75, v75
    v_exp_f32 v76, v76
    v_smfmac_f32_32x32x32_bf16 v[128:143], v[208:211], v[64:71], v216
    v_exp_f32 v77, v77
    v_exp_f32 v78, v78
    v_exp_f32 v79, v79
    v_exp_f32 v16, v16
    v_exp_f32 v17, v17
    v_smfmac_f32_32x32x32_bf16 v[128:143], v[212:215], v[72:79], v216
    v_exp_f32 v18, v18
    v_exp_f32 v19, v19
    v_exp_f32 v20, v20
    v_mfma_f32_32x32x4_2b_bf16 v[48:79], v[164:165], v[160:161], 0 cbsz:1 abid:1
    ds_read_b64 v[166:167], v6 offset:24320
    ds_read2st64_b64 v[176:179], v4 offset0:47 offset1:48
    ds_read2st64_b64 v[180:183], v3 offset0:48 offset1:49
    s_mov_b64 exec, s[40:41]
    ds_read_b128 v[200:203], v5 offset:24320
    ds_read_b128 v[204:207], v5 offset:24896
    ds_read_b128 v[208:211], v5 offset:25472
    ds_read_b128 v[212:215], v5 offset:26048
    s_mov_b64 exec, -1
    v_exp_f32 v21, v21
    v_exp_f32 v22, v22
    v_exp_f32 v23, v23
    v_exp_f32 v24, v24
    v_exp_f32 v25, v25
    v_exp_f32 v26, v26
    v_exp_f32 v27, v27
    v_exp_f32 v28, v28
    v_smfmac_f32_32x32x32_bf16 v[80:95], v[184:187], v[16:23], v216
    v_exp_f32 v29, v29
    v_exp_f32 v30, v30
    v_exp_f32 v31, v31
    v_exp_f32 v32, v32
    v_exp_f32 v33, v33
    v_smfmac_f32_32x32x32_bf16 v[80:95], v[188:191], v[24:31], v216
    v_exp_f32 v34, v34
    v_exp_f32 v35, v35
    v_exp_f32 v36, v36
    v_exp_f32 v37, v37
    v_mfma_f32_32x32x16_bf16 v[48:63], v[172:175], v[144:147], v[48:63]
    v_exp_f32 v38, v38
    v_exp_f32 v39, v39
    v_exp_f32 v40, v40
    v_mfma_f32_32x32x16_bf16 v[64:79], v[172:175], v[148:151], v[64:79]
    v_exp_f32 v41, v41
    v_exp_f32 v42, v42
    v_exp_f32 v43, v43
    v_exp_f32 v44, v44
    v_smfmac_f32_32x32x32_bf16 v[96:111], v[184:187], v[32:39], v216
    v_exp_f32 v45, v45
    v_exp_f32 v46, v46
    v_exp_f32 v47, v47
    v_exp_f32 v48, v48
    v_exp_f32 v49, v49
    v_smfmac_f32_32x32x32_bf16 v[96:111], v[188:191], v[40:47], v216
    v_exp_f32 v50, v50
    v_exp_f32 v51, v51
    v_exp_f32 v52, v52
    v_mfma_f32_32x32x4_2b_bf16 v[16:47], v[164:165], v[162:163], 0 cbsz:1 abid:0
    v_exp_f32 v53, v53
    v_exp_f32 v54, v54
    v_exp_f32 v55, v55
    v_exp_f32 v56, v56
    v_exp_f32 v57, v57
    v_exp_f32 v58, v58
    v_exp_f32 v59, v59
    v_exp_f32 v60, v60
    v_smfmac_f32_32x32x32_bf16 v[80:95], v[192:195], v[48:55], v216
    v_exp_f32 v61, v61
    v_exp_f32 v62, v62
    v_exp_f32 v63, v63
    v_exp_f32 v64, v64
    v_exp_f32 v65, v65
    v_smfmac_f32_32x32x32_bf16 v[80:95], v[196:199], v[56:63], v216
    v_exp_f32 v66, v66
    v_exp_f32 v67, v67
    v_exp_f32 v68, v68
    v_exp_f32 v69, v69
    v_mfma_f32_32x32x16_bf16 v[16:31], v[168:171], v[152:155], v[16:31]
    v_exp_f32 v70, v70
    v_exp_f32 v71, v71
    v_exp_f32 v72, v72
    v_mfma_f32_32x32x16_bf16 v[32:47], v[168:171], v[156:159], v[32:47]
    v_exp_f32 v73, v73
    v_exp_f32 v74, v74
    v_exp_f32 v75, v75
    v_exp_f32 v76, v76
    v_smfmac_f32_32x32x32_bf16 v[96:111], v[192:195], v[64:71], v216
    v_exp_f32 v77, v77
    v_exp_f32 v78, v78
    v_exp_f32 v79, v79
    v_exp_f32 v16, v16
    v_exp_f32 v17, v17
    v_smfmac_f32_32x32x32_bf16 v[96:111], v[196:199], v[72:79], v216
    v_exp_f32 v18, v18
    v_exp_f32 v19, v19
    v_exp_f32 v20, v20
    v_mfma_f32_32x32x4_2b_bf16 v[48:79], v[164:165], v[162:163], 0 cbsz:1 abid:1
    v_exp_f32 v21, v21
    v_exp_f32 v22, v22
    v_exp_f32 v23, v23
    v_exp_f32 v24, v24
    v_exp_f32 v25, v25
    v_exp_f32 v26, v26
    v_exp_f32 v27, v27
    v_exp_f32 v28, v28
    v_smfmac_f32_32x32x32_bf16 v[112:127], v[184:187], v[16:23], v216
    v_exp_f32 v29, v29
    v_exp_f32 v30, v30
    v_exp_f32 v31, v31
    v_exp_f32 v32, v32
    v_exp_f32 v33, v33
    v_smfmac_f32_32x32x32_bf16 v[112:127], v[188:191], v[24:31], v216
    v_exp_f32 v34, v34
    v_exp_f32 v35, v35
    v_exp_f32 v36, v36
    v_exp_f32 v37, v37
    v_mfma_f32_32x32x16_bf16 v[48:63], v[172:175], v[152:155], v[48:63]
    v_exp_f32 v38, v38
    v_exp_f32 v39, v39
    v_exp_f32 v40, v40
    v_mfma_f32_32x32x16_bf16 v[64:79], v[172:175], v[156:159], v[64:79]
    v_exp_f32 v41, v41
    v_exp_f32 v42, v42
    v_exp_f32 v43, v43
    v_exp_f32 v44, v44
    v_smfmac_f32_32x32x32_bf16 v[128:143], v[184:187], v[32:39], v216
    v_exp_f32 v45, v45
    v_exp_f32 v46, v46
    v_exp_f32 v47, v47
    v_exp_f32 v48, v48
    v_exp_f32 v49, v49
    v_smfmac_f32_32x32x32_bf16 v[128:143], v[188:191], v[40:47], v216
    v_exp_f32 v50, v50
    v_exp_f32 v51, v51
    v_exp_f32 v52, v52
    s_waitcnt lgkmcnt(0)
    v_mfma_f32_32x32x4_2b_bf16 v[16:47], v[166:167], v[160:161], 0 cbsz:1 abid:0
    v_exp_f32 v53, v53
    v_exp_f32 v54, v54
    v_exp_f32 v55, v55
    v_exp_f32 v56, v56
    v_exp_f32 v57, v57
    v_exp_f32 v58, v58
    v_exp_f32 v59, v59
    v_exp_f32 v60, v60
    v_smfmac_f32_32x32x32_bf16 v[112:127], v[192:195], v[48:55], v216
    v_exp_f32 v61, v61
    v_exp_f32 v62, v62
    v_exp_f32 v63, v63
    v_exp_f32 v64, v64
    v_exp_f32 v65, v65
    v_smfmac_f32_32x32x32_bf16 v[112:127], v[196:199], v[56:63], v216
    v_exp_f32 v66, v66
    v_exp_f32 v67, v67
    v_exp_f32 v68, v68
    v_exp_f32 v69, v69
    v_mfma_f32_32x32x16_bf16 v[16:31], v[176:179], v[144:147], v[16:31]
    v_exp_f32 v70, v70
    v_exp_f32 v71, v71
    v_exp_f32 v72, v72
    v_mfma_f32_32x32x16_bf16 v[32:47], v[176:179], v[148:151], v[32:47]
    v_exp_f32 v73, v73
    v_exp_f32 v74, v74
    v_exp_f32 v75, v75
    v_exp_f32 v76, v76
    v_smfmac_f32_32x32x32_bf16 v[128:143], v[192:195], v[64:71], v216
    v_exp_f32 v77, v77
    v_exp_f32 v78, v78
    v_exp_f32 v79, v79
    v_exp_f32 v16, v16
    v_exp_f32 v17, v17
    v_smfmac_f32_32x32x32_bf16 v[128:143], v[196:199], v[72:79], v216
    v_exp_f32 v18, v18
    v_exp_f32 v19, v19
    v_exp_f32 v20, v20
    v_mfma_f32_32x32x4_2b_bf16 v[48:79], v[166:167], v[160:161], 0 cbsz:1 abid:1
    v_exp_f32 v21, v21
    v_exp_f32 v22, v22
    v_exp_f32 v23, v23
    v_exp_f32 v24, v24
    v_exp_f32 v25, v25
    v_exp_f32 v26, v26
    v_exp_f32 v27, v27
    v_exp_f32 v28, v28
    v_smfmac_f32_32x32x32_bf16 v[80:95], v[200:203], v[16:23], v216
    v_exp_f32 v29, v29
    v_exp_f32 v30, v30
    v_exp_f32 v31, v31
    v_exp_f32 v32, v32
    v_exp_f32 v33, v33
    v_smfmac_f32_32x32x32_bf16 v[80:95], v[204:207], v[24:31], v216
    v_exp_f32 v34, v34
    v_exp_f32 v35, v35
    v_exp_f32 v36, v36
    v_exp_f32 v37, v37
    v_mfma_f32_32x32x16_bf16 v[48:63], v[180:183], v[144:147], v[48:63]
    v_exp_f32 v38, v38
    v_exp_f32 v39, v39
    v_exp_f32 v40, v40
    v_mfma_f32_32x32x16_bf16 v[64:79], v[180:183], v[148:151], v[64:79]
    v_exp_f32 v41, v41
    v_exp_f32 v42, v42
    v_exp_f32 v43, v43
    v_exp_f32 v44, v44
    v_smfmac_f32_32x32x32_bf16 v[96:111], v[200:203], v[32:39], v216
    v_exp_f32 v45, v45
    v_exp_f32 v46, v46
    v_exp_f32 v47, v47
    v_exp_f32 v48, v48
    v_exp_f32 v49, v49
    v_smfmac_f32_32x32x32_bf16 v[96:111], v[204:207], v[40:47], v216
    v_exp_f32 v50, v50
    v_exp_f32 v51, v51
    v_exp_f32 v52, v52
    v_mfma_f32_32x32x4_2b_bf16 v[16:47], v[166:167], v[162:163], 0 cbsz:1 abid:0
    v_exp_f32 v53, v53
    v_exp_f32 v54, v54
    v_exp_f32 v55, v55
    v_exp_f32 v56, v56
    v_exp_f32 v57, v57
    v_exp_f32 v58, v58
    v_exp_f32 v59, v59
    v_exp_f32 v60, v60
    v_smfmac_f32_32x32x32_bf16 v[80:95], v[208:211], v[48:55], v216
    v_exp_f32 v61, v61
    v_exp_f32 v62, v62
    v_exp_f32 v63, v63
    v_exp_f32 v64, v64
    v_exp_f32 v65, v65
    v_smfmac_f32_32x32x32_bf16 v[80:95], v[212:215], v[56:63], v216
    v_exp_f32 v66, v66
    v_exp_f32 v67, v67
    v_exp_f32 v68, v68
    v_exp_f32 v69, v69
    v_mfma_f32_32x32x16_bf16 v[16:31], v[176:179], v[152:155], v[16:31]
    v_exp_f32 v70, v70
    v_exp_f32 v71, v71
    v_exp_f32 v72, v72
    v_mfma_f32_32x32x16_bf16 v[32:47], v[176:179], v[156:159], v[32:47]
    v_exp_f32 v73, v73
    v_exp_f32 v74, v74
    v_exp_f32 v75, v75
    v_exp_f32 v76, v76
    v_smfmac_f32_32x32x32_bf16 v[96:111], v[208:211], v[64:71], v216
    v_exp_f32 v77, v77
    v_exp_f32 v78, v78
    v_exp_f32 v79, v79
    v_exp_f32 v16, v16
    v_exp_f32 v17, v17
    v_smfmac_f32_32x32x32_bf16 v[96:111], v[212:215], v[72:79], v216
    v_exp_f32 v18, v18
    v_exp_f32 v19, v19
    v_exp_f32 v20, v20
    v_mfma_f32_32x32x4_2b_bf16 v[48:79], v[166:167], v[162:163], 0 cbsz:1 abid:1
    ds_read_b32 v242, v229 offset:16
    ds_read_b64 v[164:165], v6 offset:38912
    ds_read2st64_b64 v[168:171], v3 offset0:76 offset1:77
    ds_read2st64_b64 v[172:175], v4 offset0:76 offset1:77
    s_mov_b64 exec, s[40:41]
    ds_read_b128 v[184:187], v5 offset:38912
    ds_read_b128 v[188:191], v5 offset:39488
    ds_read_b128 v[192:195], v5 offset:40064
    ds_read_b128 v[196:199], v5 offset:40640
    s_mov_b64 exec, -1
    v_exp_f32 v21, v21
    v_exp_f32 v22, v22
    v_exp_f32 v23, v23
    v_exp_f32 v24, v24
    v_exp_f32 v25, v25
    v_exp_f32 v26, v26
    v_exp_f32 v27, v27
    v_exp_f32 v28, v28
    v_smfmac_f32_32x32x32_bf16 v[112:127], v[200:203], v[16:23], v216
    v_exp_f32 v29, v29
    v_exp_f32 v30, v30
    v_exp_f32 v31, v31
    v_exp_f32 v32, v32
    v_exp_f32 v33, v33
    v_smfmac_f32_32x32x32_bf16 v[112:127], v[204:207], v[24:31], v216
    v_exp_f32 v34, v34
    v_exp_f32 v35, v35
    v_exp_f32 v36, v36
    v_exp_f32 v37, v37
    v_mfma_f32_32x32x16_bf16 v[48:63], v[180:183], v[152:155], v[48:63]
    v_exp_f32 v38, v38
    v_exp_f32 v39, v39
    v_exp_f32 v40, v40
    v_mfma_f32_32x32x16_bf16 v[64:79], v[180:183], v[156:159], v[64:79]
    v_exp_f32 v41, v41
    v_exp_f32 v42, v42
    v_exp_f32 v43, v43
    v_exp_f32 v44, v44
    v_smfmac_f32_32x32x32_bf16 v[128:143], v[200:203], v[32:39], v216
    v_exp_f32 v45, v45
    v_exp_f32 v46, v46
    v_exp_f32 v47, v47
    v_exp_f32 v48, v48
    v_exp_f32 v49, v49
    v_smfmac_f32_32x32x32_bf16 v[128:143], v[204:207], v[40:47], v216
    v_exp_f32 v50, v50
    v_exp_f32 v51, v51
    v_exp_f32 v52, v52
    s_waitcnt lgkmcnt(0)
    v_cmp_gt_u32 vcc, 4, v242
    s_cbranch_vccnz B_retry4
B_back4:
    v_mfma_f32_32x32x4_2b_bf16 v[16:47], v[164:165], v[160:161], 0 cbsz:1 abid:0
    v_exp_f32 v53, v53
    v_exp_f32 v54, v54
    v_exp_f32 v55, v55
    v_exp_f32 v56, v56
    v_exp_f32 v57, v57
I_b_0:
    s_cbranch_execz I_b_1
    v_exp_f32 v58, v58
    v_exp_f32 v59, v59
    v_exp_f32 v60, v60
    v_smfmac_f32_32x32x32_bf16 v[112:127], v[208:211], v[48:55], v216
    v_exp_f32 v61, v61
    v_exp_f32 v62, v62
    v_exp_f32 v63, v63
    v_exp_f32 v64, v64
    v_exp_f32 v65, v65
    v_smfmac_f32_32x32x32_bf16 v[112:127], v[212:215], v[56:63], v216
    v_exp_f32 v66, v66
    v_exp_f32 v67, v67
    v_exp_f32 v68, v68
    v_exp_f32 v69, v69
    v_mfma_f32_32x32x16_bf16 v[16:31], v[168:171], v[144:147], v[16:31]
    v_exp_f32 v70, v70
    v_exp_f32 v71, v71
    v_exp_f32 v72, v72
    v_mfma_f32_32x32x16_bf16 v[32:47], v[168:171], v[148:151], v[32:47]
    v_exp_f32 v73, v73
    v_exp_f32 v74, v74
    v_exp_f32 v75, v75
    v_exp_f32 v76, v76
    v_smfmac_f32_32x32x32_bf16 v[128:143], v[208:211], v[64:71], v216
    v_exp_f32 v77, v77
    v_exp_f32 v78, v78
    v_exp_f32 v79, v79
    v_exp_f32 v16, v16
    v_exp_f32 v17, v17
    v_smfmac_f32_32x32x32_bf16 v[128:143], v[212:215], v[72:79], v216
    v_exp_f32 v18, v18
    v_exp_f32 v19, v19
    v_exp_f32 v20, v20
    v_mfma_f32_32x32x4_2b_bf16 v[48:79], v[164:165], v[160:161], 0 cbsz:1 abid:1
    ds_read_b64 v[166:167], v6 offset:43776
    ds_read2st64_b64 v[176:179], v4 offset0:85 offset1:86
    ds_read2st64_b64 v[180:183], v3 offset0:86 offset1:87
    s_mov_b64 exec, s[40:41]
    ds_read_b128 v[200:203], v5 offset:43776
    ds_read_b128 v[204:207], v5 offset:44352
    ds_read_b128 v[208:211], v5 offset:44928
    ds_read_b128 v[212:215], v5 offset:45504
    s_mov_b64 exec, -1
    v_exp_f32 v21, v21
    v_exp_f32 v22, v22
    v_exp_f32 v23, v23
    v_exp_f32 v24, v24
    v_exp_f32 v25, v25
    v_exp_f32 v26, v26
    v_exp_f32 v27, v27
    v_exp_f32 v28, v28
    v_smfmac_f32_32x32x32_bf16 v[80:95], v[184:187], v[16:23], v216
    v_exp_f32 v29, v29
    v_exp_f32 v30, v30
    v_exp_f32 v31, v31
    v_exp_f32 v32, v32
    v_exp_f32 v33, v33
    v_smfmac_f32_32x32x32_bf16 v[80:95], v[188:191], v[24:31], v216
    v_exp_f32 v34, v34
    v_exp_f32 v35, v35
    v_exp_f32 v36, v36
    v_exp_f32 v37, v37
    v_mfma_f32_32x32x16_bf16 v[48:63], v[172:175], v[144:147], v[48:63]
    v_exp_f32 v38, v38
    v_exp_f32 v39, v39
    v_exp_f32 v40, v40
    v_mfma_f32_32x32x16_bf16 v[64:79], v[172:175], v[148:151], v[64:79]
    v_exp_f32 v41, v41
    v_exp_f32 v42, v42
    v_exp_f32 v43, v43
    v_exp_f32 v44, v44
    v_smfmac_f32_32x32x32_bf16 v[96:111], v[184:187], v[32:39], v216
    v_exp_f32 v45, v45
    v_exp_f32 v46, v46
    v_exp_f32 v47, v47
    v_exp_f32 v48, v48
    v_exp_f32 v49, v49
    v_smfmac_f32_32x32x32_bf16 v[96:111], v[188:191], v[40:47], v216
    v_exp_f32 v50, v50
    v_exp_f32 v51, v51
    v_exp_f32 v52, v52
    v_mfma_f32_32x32x4_2b_bf16 v[16:47], v[164:165], v[162:163], 0 cbsz:1 abid:0
    v_exp_f32 v53, v53
    v_exp_f32 v54, v54
    v_exp_f32 v55, v55
    v_exp_f32 v56, v56
    v_exp_f32 v57, v57
    v_exp_f32 v58, v58
    v_exp_f32 v59, v59
    v_exp_f32 v60, v60
    v_smfmac_f32_32x32x32_bf16 v[80:95], v[192:195], v[48:55], v216
    v_exp_f32 v61, v61
    v_exp_f32 v62, v62
    v_exp_f32 v63, v63
    v_exp_f32 v64, v64
    v_exp_f32 v65, v65
    v_smfmac_f32_32x32x32_bf16 v[80:95], v[196:199], v[56:63], v216
    v_exp_f32 v66, v66
    v_exp_f32 v67, v67
    v_exp_f32 v68, v68
    v_exp_f32 v69, v69
    v_mfma_f32_32x32x16_bf16 v[16:31], v[168:171], v[152:155], v[16:31]
    v_exp_f32 v70, v70
    v_exp_f32 v71, v71
    v_exp_f32 v72, v72
    v_mfma_f32_32x32x16_bf16 v[32:47], v[168:171], v[156:159], v[32:47]
    v_exp_f32 v73, v73
    v_exp_f32 v74, v74
    v_exp_f32 v75, v75
    v_exp_f32 v76, v76
    v_smfmac_f32_32x32x32_bf16 v[96:111], v[192:195], v[64:71], v216
    v_exp_f32 v77, v77
    v_exp_f32 v78, v78
    v_exp_f32 v79, v79
    v_exp_f32 v16, v16
    v_exp_f32 v17, v17
    v_smfmac_f32_32x32x32_bf16 v[96:111], v[196:199], v[72:79], v216
    v_exp_f32 v18, v18
    v_exp_f32 v19, v19
    v_exp_f32 v20, v20
    v_mfma_f32_32x32x4_2b_bf16 v[48:79], v[164:165], v[162:163], 0 cbsz:1 abid:1
    v_exp_f32 v21, v21
    v_exp_f32 v22, v22
    v_exp_f32 v23, v23
    v_exp_f32 v24, v24
    v_exp_f32 v25, v25
    v_exp_f32 v26, v26
    v_exp_f32 v27, v27
    v_exp_f32 v28, v28
    v_smfmac_f32_32x32x32_bf16 v[112:127], v[184:187], v[16:23], v216
    v_exp_f32 v29, v29
    v_exp_f32 v30, v30
    v_exp_f32 v31, v31
    v_exp_f32 v32, v32
    v_exp_f32 v33, v33
    v_smfmac_f32_32x32x32_bf16 v[112:127], v[188:191], v[24:31], v216
    v_exp_f32 v34, v34
    v_exp_f32 v35, v35
    v_exp_f32 v36, v36
    v_exp_f32 v37, v37
    v_mfma_f32_32x32x16_bf16 v[48:63], v[172:175], v[152:155], v[48:63]
    v_exp_f32 v38, v38
    v_exp_f32 v39, v39
    v_exp_f32 v40, v40
    v_mfma_f32_32x32x16_bf16 v[64:79], v[172:175], v[156:159], v[64:79]
    v_exp_f32 v41, v41
    v_exp_f32 v42, v42
    v_exp_f32 v43, v43
    v_exp_f32 v44, v44
    v_smfmac_f32_32x32x32_bf16 v[128:143], v[184:187], v[32:39], v216
    v_exp_f32 v45, v45
    v_exp_f32 v46, v46
    v_exp_f32 v47, v47
    v_exp_f32 v48, v48
    v_exp_f32 v49, v49
    v_smfmac_f32_32x32x32_bf16 v[128:143], v[188:191], v[40:47], v216
    v_exp_f32 v50, v50
    v_exp_f32 v51, v51
    v_exp_f32 v52, v52
    s_waitcnt lgkmcnt(0)
    v_mfma_f32_32x32x4_2b_bf16 v[16:47], v[166:167], v[160:161], 0 cbsz:1 abid:0
    ds_add_u32 v241, v227 offset:48
    v_exp_f32 v53, v53
    v_exp_f32 v54, v54
    v_exp_f32 v55, v55
    v_exp_f32 v56, v56
    v_exp_f32 v57, v57
    v_exp_f32 v58, v58
    v_exp_f32 v59, v59
    v_exp_f32 v60, v60
    v_smfmac_f32_32x32x32_bf16 v[112:127], v[192:195], v[48:55], v216
    v_exp_f32 v61, v61
    v_exp_f32 v62, v62
    v_exp_f32 v63, v63
    v_exp_f32 v64, v64
    v_exp_f32 v65, v65
    v_smfmac_f32_32x32x32_bf16 v[112:127], v[196:199], v[56:63], v216
    v_exp_f32 v66, v66
    v_exp_f32 v67, v67
    v_exp_f32 v68, v68
    v_exp_f32 v69, v69
    v_mfma_f32_32x32x16_bf16 v[16:31], v[176:179], v[144:147], v[16:31]
    v_exp_f32 v70, v70
    v_exp_f32 v71, v71
    v_exp_f32 v72, v72
    v_mfma_f32_32x32x16_bf16 v[32:47], v[176:179], v[148:151], v[32:47]
    v_exp_f32 v73, v73
    v_exp_f32 v74, v74
    v_exp_f32 v75, v75
    v_exp_f32 v76, v76
    v_smfmac_f32_32x32x32_bf16 v[128:143], v[192:195], v[64:71], v216
    v_exp_f32 v77, v77
    v_exp_f32 v78, v78
    v_exp_f32 v79, v79
    v_exp_f32 v16, v16
    v_exp_f32 v17, v17
    v_smfmac_f32_32x32x32_bf16 v[128:143], v[196:199], v[72:79], v216
    v_exp_f32 v18, v18
    v_exp_f32 v19, v19
    v_exp_f32 v20, v20
    v_mfma_f32_32x32x4_2b_bf16 v[48:79], v[166:167], v[160:161], 0 cbsz:1 abid:1
    v_exp_f32 v21, v21
    v_exp_f32 v22, v22
    v_exp_f32 v23, v23
    v_exp_f32 v24, v24
    v_exp_f32 v25, v25
    v_exp_f32 v26, v26
    v_exp_f32 v27, v27
    v_exp_f32 v28, v28
    v_smfmac_f32_32x32x32_bf16 v[80:95], v[200:203], v[16:23], v216
    v_exp_f32 v29, v29
    v_exp_f32 v30, v30
    v_exp_f32 v31, v31
    v_exp_f32 v32, v32
    v_exp_f32 v33, v33
    v_smfmac_f32_32x32x32_bf16 v[80:95], v[204:207], v[24:31], v216
    v_exp_f32 v34, v34
    v_exp_f32 v35, v35
    v_exp_f32 v36, v36
    v_exp_f32 v37, v37
    v_mfma_f32_32x32x16_bf16 v[48:63], v[180:183], v[144:147], v[48:63]
    v_exp_f32 v38, v38
    v_exp_f32 v39, v39
    v_exp_f32 v40, v40
    v_mfma_f32_32x32x16_bf16 v[64:79], v[180:183], v[148:151], v[64:79]
    v_exp_f32 v41, v41
    v_exp_f32 v42, v42
    v_exp_f32 v43, v43
    v_exp_f32 v44, v44
    v_smfmac_f32_32x32x32_bf16 v[96:111], v[200:203], v[32:39], v216
    v_exp_f32 v45, v45
    v_exp_f32 v46, v46
    v_exp_f32 v47, v47
    v_exp_f32 v48, v48
    v_exp_f32 v49, v49
    v_smfmac_f32_32x32x32_bf16 v[96:111], v[204:207], v[40:47], v216
    v_exp_f32 v50, v50
    v_exp_f32 v51, v51
    v_exp_f32 v52, v52
    v_mfma_f32_32x32x4_2b_bf16 v[16:47], v[166:167], v[162:163], 0 cbsz:1 abid:0
    v_exp_f32 v53, v53
    v_exp_f32 v54, v54
    v_exp_f32 v55, v55
    v_exp_f32 v56, v56
    v_exp_f32 v57, v57
    v_exp_f32 v58, v58
    v_exp_f32 v59, v59
    v_exp_f32 v60, v60
    v_smfmac_f32_32x32x32_bf16 v[80:95], v[208:211], v[48:55], v216
    v_exp_f32 v61, v61
    v_exp_f32 v62, v62
    v_exp_f32 v63, v63
    v_exp_f32 v64, v64
    v_exp_f32 v65, v65
    v_smfmac_f32_32x32x32_bf16 v[80:95], v[212:215], v[56:63], v216
    v_exp_f32 v66, v66
    v_exp_f32 v67, v67
    v_exp_f32 v68, v68
    v_exp_f32 v69, v69
    v_mfma_f32_32x32x16_bf16 v[16:31], v[176:179], v[152:155], v[16:31]
    v_exp_f32 v70, v70
    v_exp_f32 v71, v71
    v_exp_f32 v72, v72
    v_mfma_f32_32x32x16_bf16 v[32:47], v[176:179], v[156:159], v[32:47]
    v_exp_f32 v73, v73
    v_exp_f32 v74, v74
    v_exp_f32 v75, v75
    v_exp_f32 v76, v76
    v_smfmac_f32_32x32x32_bf16 v[96:111], v[208:211], v[64:71], v216
    v_exp_f32 v77, v77
    v_exp_f32 v78, v78
    v_exp_f32 v79, v79
    v_exp_f32 v16, v16
    v_exp_f32 v17, v17
    v_smfmac_f32_32x32x32_bf16 v[96:111], v[212:215], v[72:79], v216
    v_exp_f32 v18, v18
    v_exp_f32 v19, v19
    v_exp_f32 v20, v20
    v_mfma_f32_32x32x4_2b_bf16 v[48:79], v[166:167], v[162:163], 0 cbsz:1 abid:1
    v_exp_f32 v21, v21
    v_exp_f32 v22, v22
    v_exp_f32 v23, v23
    v_exp_f32 v24, v24
    v_exp_f32 v25, v25
    v_exp_f32 v26, v26
    v_exp_f32 v27, v27
    v_exp_f32 v28, v28
    v_smfmac_f32_32x32x32_bf16 v[112:127], v[200:203], v[16:23], v216
    v_exp_f32 v29, v29
    v_exp_f32 v30, v30
    v_exp_f32 v31, v31
    v_exp_f32 v32, v32
    v_exp_f32 v33, v33
    v_smfmac_f32_32x32x32_bf16 v[112:127], v[204:207], v[24:31], v216
    v_exp_f32 v34, v34
    v_exp_f32 v35, v35
    ds_read_b32 v242, v229 offset:20
    ds_read_b64 v[164:165], v6 offset:58368
    ds_read2st64_b64 v[168:171], v3 offset0:114 offset1:115
    ds_read2st64_b64 v[172:175], v4 offset0:114 offset1:115
    s_mov_b64 exec, s[40:41]
    ds_read_b128 v[184:187], v5 offset:58368
    ds_read_b128 v[188:191], v5 offset:58944
    ds_read_b128 v[192:195], v5 offset:59520
    ds_read_b128 v[196:199], v5 offset:60096
    s_mov_b64 exec, -1
    v_exp_f32 v36, v36
    v_exp_f32 v37, v37
    v_mfma_f32_32x32x16_bf16 v[48:63], v[180:183], v[152:155], v[48:63]
    v_exp_f32 v38, v38
    v_exp_f32 v39, v39
    v_exp_f32 v40, v40
    v_mfma_f32_32x32x16_bf16 v[64:79], v[180:183], v[156:159], v[64:79]
    v_exp_f32 v41, v41
    v_exp_f32 v42, v42
    v_exp_f32 v43, v43
    v_exp_f32 v44, v44
    v_smfmac_f32_32x32x32_bf16 v[128:143], v[200:203], v[32:39], v216
    v_exp_f32 v45, v45
    v_exp_f32 v46, v46
    v_exp_f32 v47, v47
    v_exp_f32 v48, v48
    v_exp_f32 v49, v49
    v_smfmac_f32_32x32x32_bf16 v[128:143], v[204:207], v[40:47], v216
    v_exp_f32 v50, v50
    v_exp_f32 v51, v51
    v_exp_f32 v52, v52
    s_waitcnt lgkmcnt(0)
    v_cmp_gt_u32 vcc, 4, v242
    s_cbranch_vccnz B_retry6
B_back6:
    v_mfma_f32_32x32x4_2b_bf16 v[16:47], v[164:165], v[160:161], 0 cbsz:1 abid:0
    v_exp_f32 v53, v53
    v_exp_f32 v54, v54
    v_exp_f32 v55, v55
    v_exp_f32 v56, v56
    v_exp_f32 v57, v57
    v_exp_f32 v58, v58
    v_exp_f32 v59, v59
    v_exp_f32 v60, v60
    v_smfmac_f32_32x32x32_bf16 v[112:127], v[208:211], v[48:55], v216
    v_exp_f32 v61, v61
    v_exp_f32 v62, v62
    v_exp_f32 v63, v63
    v_exp_f32 v64, v64
    v_exp_f32 v65, v65
    v_smfmac_f32_32x32x32_bf16 v[112:127], v[212:215], v[56:63], v216
    v_exp_f32 v66, v66
    v_exp_f32 v67, v67
    v_exp_f32 v68, v68
    v_exp_f32 v69, v69
    v_mfma_f32_32x32x16_bf16 v[16:31], v[168:171], v[144:147], v[16:31]
    v_exp_f32 v70, v70
    v_exp_f32 v71, v71
    v_exp_f32 v72, v72
    v_mfma_f32_32x32x16_bf16 v[32:47], v[168:171], v[148:151], v[32:47]
    v_exp_f32 v73, v73
    v_exp_f32 v74, v74
    v_exp_f32 v75, v75
    v_exp_f32 v76, v76
    v_smfmac_f32_32x32x32_bf16 v[128:143], v[208:211], v[64:71], v216
    v_exp_f32 v77, v77
    v_exp_f32 v78, v78
    v_exp_f32 v79, v79
    v_exp_f32 v16, v16
    v_exp_f32 v17, v17
    v_smfmac_f32_32x32x32_bf16 v[128:143], v[212:215], v[72:79], v216
    v_exp_f32 v18, v18
    v_exp_f32 v19, v19
    v_exp_f32 v20, v20
    v_mfma_f32_32x32x4_2b_bf16 v[48:79], v[164:165], v[160:161], 0 cbsz:1 abid:1
    ds_read_b64 v[166:167], v6 offset:63232
    ds_read2st64_b64 v[176:179], v4 offset0:123 offset1:124
    ds_read2st64_b64 v[180:183], v3 offset0:124 offset1:125
    s_mov_b64 exec, s[40:41]
    ds_read_b128 v[200:203], v5 offset:63232
    ds_read_b128 v[204:207], v5 offset:63808
    ds_read_b128 v[208:211], v5 offset:64384
    ds_read_b128 v[212:215], v5 offset:64960
    s_mov_b64 exec, -1
    v_exp_f32 v21, v21
    v_exp_f32 v22, v22
    v_exp_f32 v23, v23
    v_exp_f32 v24, v24
    v_exp_f32 v25, v25
    v_exp_f32 v26, v26
    v_exp_f32 v27, v27
    v_exp_f32 v28, v28
    v_smfmac_f32_32x32x32_bf16 v[80:95], v[184:187], v[16:23], v216
    v_exp_f32 v29, v29
    v_exp_f32 v30, v30
    v_exp_f32 v31, v31
    v_exp_f32 v32, v32
    v_exp_f32 v33, v33
    v_smfmac_f32_32x32x32_bf16 v[80:95], v[188:191], v[24:31], v216
    v_exp_f32 v34, v34
    v_exp_f32 v35, v35
    v_exp_f32 v36, v36
    v_exp_f32 v37, v37
    v_mfma_f32_32x32x16_bf16 v[48:63], v[172:175], v[144:147], v[48:63]
    v_exp_f32 v38, v38
    v_exp_f32 v39, v39
    v_exp_f32 v40, v40
    v_mfma_f32_32x32x16_bf16 v[64:79], v[172:175], v[148:151], v[64:79]
    v_exp_f32 v41, v41
    v_exp_f32 v42, v42
    v_exp_f32 v43, v43
    v_exp_f32 v44, v44
    v_smfmac_f32_32x32x32_bf16 v[96:111], v[184:187], v[32:39], v216
    v_exp_f32 v45, v45
    v_exp_f32 v46, v46
    v_exp_f32 v47, v47
    v_exp_f32 v48, v48
    v_exp_f32 v49, v49
    v_smfmac_f32_32x32x32_bf16 v[96:111], v[188:191], v[40:47], v216
    v_exp_f32 v50, v50
    v_exp_f32 v51, v51
    v_exp_f32 v52, v52
    v_mfma_f32_32x32x4_2b_bf16 v[16:47], v[164:165], v[162:163], 0 cbsz:1 abid:0
    v_exp_f32 v53, v53
    v_exp_f32 v54, v54
    v_exp_f32 v55, v55
    v_exp_f32 v56, v56
    v_exp_f32 v57, v57
    v_exp_f32 v58, v58
    v_exp_f32 v59, v59
    v_exp_f32 v60, v60
    v_smfmac_f32_32x32x32_bf16 v[80:95], v[192:195], v[48:55], v216
    v_exp_f32 v61, v61
    v_exp_f32 v62, v62
    v_exp_f32 v63, v63
    v_exp_f32 v64, v64
    v_exp_f32 v65, v65
    v_smfmac_f32_32x32x32_bf16 v[80:95], v[196:199], v[56:63], v216
    v_exp_f32 v66, v66
    v_exp_f32 v67, v67
    v_exp_f32 v68, v68
    v_exp_f32 v69, v69
    v_mfma_f32_32x32x16_bf16 v[16:31], v[168:171], v[152:155], v[16:31]
    v_exp_f32 v70, v70
    v_exp_f32 v71, v71
    v_exp_f32 v72, v72
    v_mfma_f32_32x32x16_bf16 v[32:47], v[168:171], v[156:159], v[32:47]
    v_exp_f32 v73, v73
    v_exp_f32 v74, v74
    v_exp_f32 v75, v75
    v_exp_f32 v76, v76
    v_smfmac_f32_32x32x32_bf16 v[96:111], v[192:195], v[64:71], v216
    v_exp_f32 v77, v77
    v_exp_f32 v78, v78
    v_exp_f32 v79, v79
    v_exp_f32 v16, v16
    v_exp_f32 v17, v17
    v_smfmac_f32_32x32x32_bf16 v[96:111], v[196:199], v[72:79], v216
    v_exp_f32 v18, v18
    v_exp_f32 v19, v19
    v_exp_f32 v20, v20
    v_mfma_f32_32x32x4_2b_bf16 v[48:79], v[164:165], v[162:163], 0 cbsz:1 abid:1
    v_exp_f32 v21, v21
    v_exp_f32 v22, v22
    v_exp_f32 v23, v23
    v_exp_f32 v24, v24
    v_exp_f32 v25, v25
    v_exp_f32 v26, v26
    v_exp_f32 v27, v27
    v_exp_f32 v28, v28
    v_smfmac_f32_32x32x32_bf16 v[112:127], v[184:187], v[16:23], v216
    v_exp_f32 v29, v29
    v_exp_f32 v30, v30
    v_exp_f32 v31, v31
    v_exp_f32 v32, v32
    v_exp_f32 v33, v33
    v_smfmac_f32_32x32x32_bf16 v[112:127], v[188:191], v[24:31], v216
    v_exp_f32 v34, v34
    v_exp_f32 v35, v35
    v_exp_f32 v36, v36
    v_exp_f32 v37, v37
    v_mfma_f32_32x32x16_bf16 v[48:63], v[172:175], v[152:155], v[48:63]
    v_exp_f32 v38, v38
    v_exp_f32 v39, v39
    v_exp_f32 v40, v40
    v_mfma_f32_32x32x16_bf16 v[64:79], v[172:175], v[156:159], v[64:79]
    v_exp_f32 v41, v41
    v_exp_f32 v42, v42
    v_exp_f32 v43, v43
    v_exp_f32 v44, v44
    v_smfmac_f32_32x32x32_bf16 v[128:143], v[184:187], v[32:39], v216
    v_exp_f32 v45, v45
    v_exp_f32 v46, v46
    v_exp_f32 v47, v47
    v_exp_f32 v48, v48
    v_exp_f32 v49, v49
    v_smfmac_f32_32x32x32_bf16 v[128:143], v[188:191], v[40:47], v216
    v_exp_f32 v50, v50
    v_exp_f32 v51, v51
    v_exp_f32 v52, v52
    s_waitcnt lgkmcnt(0)
    v_mfma_f32_32x32x4_2b_bf16 v[16:47], v[166:167], v[160:161], 0 cbsz:1 abid:0
    ds_add_u32 v241, v227 offset:52
    v_exp_f32 v53, v53
    v_exp_f32 v54, v54
    v_exp_f32 v55, v55
    v_exp_f32 v56, v56
    v_exp_f32 v57, v57
    v_exp_f32 v58, v58
    v_exp_f32 v59, v59
    v_exp_f32 v60, v60
    v_smfmac_f32_32x32x32_bf16 v[112:127], v[192:195], v[48:55], v216
    v_exp_f32 v61, v61
    v_exp_f32 v62, v62
    v_exp_f32 v63, v63
    v_exp_f32 v64, v64
    v_exp_f32 v65, v65
    v_smfmac_f32_32x32x32_bf16 v[112:127], v[196:199], v[56:63], v216
    v_exp_f32 v66, v66
    v_exp_f32 v67, v67
    v_exp_f32 v68, v68
    v_exp_f32 v69, v69
    v_mfma_f32_32x32x16_bf16 v[16:31], v[176:179], v[144:147], v[16:31]
    v_exp_f32 v70, v70
    v_exp_f32 v71, v71
    v_exp_f32 v72, v72
    v_mfma_f32_32x32x16_bf16 v[32:47], v[176:179], v[148:151], v[32:47]
    v_exp_f32 v73, v73
    v_exp_f32 v74, v74
    v_exp_f32 v75, v75
    v_exp_f32 v76, v76
    v_smfmac_f32_32x32x32_bf16 v[128:143], v[192:195], v[64:71], v216
    v_exp_f32 v77, v77
    v_exp_f32 v78, v78
    v_exp_f32 v79, v79
    v_exp_f32 v16, v16
    v_exp_f32 v17, v17
    v_smfmac_f32_32x32x32_bf16 v[128:143], v[196:199], v[72:79], v216
    v_exp_f32 v18, v18
    v_exp_f32 v19, v19
    v_exp_f32 v20, v20
    v_mfma_f32_32x32x4_2b_bf16 v[48:79], v[166:167], v[160:161], 0 cbsz:1 abid:1
    v_subrev_u32 v3, 77824, v3
    v_subrev_u32 v4, 77824, v4
    v_subrev_u32 v5, 77824, v5
    v_subrev_u32 v6, 77824, v6
    v_exp_f32 v21, v21
    v_exp_f32 v22, v22
    v_exp_f32 v23, v23
    v_exp_f32 v24, v24
    v_exp_f32 v25, v25
    v_exp_f32 v26, v26
    v_exp_f32 v27, v27
    v_exp_f32 v28, v28
    v_smfmac_f32_32x32x32_bf16 v[80:95], v[200:203], v[16:23], v216
    v_exp_f32 v29, v29
    v_exp_f32 v30, v30
    v_exp_f32 v31, v31
    v_exp_f32 v32, v32
    v_exp_f32 v33, v33
    v_smfmac_f32_32x32x32_bf16 v[80:95], v[204:207], v[24:31], v216
    v_exp_f32 v34, v34
    v_exp_f32 v35, v35
    v_exp_f32 v36, v36
    v_exp_f32 v37, v37
    v_mfma_f32_32x32x16_bf16 v[48:63], v[180:183], v[144:147], v[48:63]
    v_exp_f32 v38, v38
    v_exp_f32 v39, v39
    v_exp_f32 v40, v40
    v_mfma_f32_32x32x16_bf16 v[64:79], v[180:183], v[148:151], v[64:79]
    v_exp_f32 v41, v41
    v_exp_f32 v42, v42
    v_exp_f32 v43, v43
    v_exp_f32 v44, v44
    v_smfmac_f32_32x32x32_bf16 v[96:111], v[200:203], v[32:39], v216
    v_exp_f32 v45, v45
    v_exp_f32 v46, v46
    v_exp_f32 v47, v47
    v_exp_f32 v48, v48
    v_exp_f32 v49, v49
    v_smfmac_f32_32x32x32_bf16 v[96:111], v[204:207], v[40:47], v216
    v_exp_f32 v50, v50
    v_exp_f32 v51, v51
    v_exp_f32 v52, v52
    v_mfma_f32_32x32x4_2b_bf16 v[16:47], v[166:167], v[162:163], 0 cbsz:1 abid:0
    v_exp_f32 v53, v53
    v_exp_f32 v54, v54
    v_exp_f32 v55, v55
    v_exp_f32 v56, v56
    v_exp_f32 v57, v57
    v_exp_f32 v58, v58
    v_exp_f32 v59, v59
    v_exp_f32 v60, v60
    v_smfmac_f32_32x32x32_bf16 v[80:95], v[208:211], v[48:55], v216
    v_exp_f32 v61, v61
    v_exp_f32 v62, v62
    v_exp_f32 v63, v63
    v_exp_f32 v64, v64
    v_exp_f32 v65, v65
    v_smfmac_f32_32x32x32_bf16 v[80:95], v[212:215], v[56:63], v216
    v_exp_f32 v66, v66
    v_exp_f32 v67, v67
    v_exp_f32 v68, v68
    v_exp_f32 v69, v69
    v_mfma_f32_32x32x16_bf16 v[16:31], v[176:179], v[152:155], v[16:31]
    v_exp_f32 v70, v70
    v_exp_f32 v71, v71
    v_exp_f32 v72, v72
    v_mfma_f32_32x32x16_bf16 v[32:47], v[176:179], v[156:159], v[32:47]
    v_exp_f32 v73, v73
    v_exp_f32 v74, v74
    v_exp_f32 v75, v75
    v_exp_f32 v76, v76
    v_smfmac_f32_32x32x32_bf16 v[96:111], v[208:211], v[64:71], v216
    v_exp_f32 v77, v77
    v_exp_f32 v78, v78
    v_exp_f32 v79, v79
    v_exp_f32 v16, v16
    v_exp_f32 v17, v17
    v_smfmac_f32_32x32x32_bf16 v[96:111], v[212:215], v[72:79], v216
    v_exp_f32 v18, v18
    v_exp_f32 v19, v19
    v_exp_f32 v20, v20
    v_mfma_f32_32x32x4_2b_bf16 v[48:79], v[166:167], v[162:163], 0 cbsz:1 abid:1
    ds_read_b32 v242, v229 offset:24
    ds_read_b64 v[164:165], v6 offset:0
    ds_read2st64_b64 v[168:171], v3 offset0:0 offset1:1
    ds_read2st64_b64 v[172:175], v4 offset0:0 offset1:1
    s_mov_b64 exec, s[40:41]
    ds_read_b128 v[184:187], v5 offset:0
    ds_read_b128 v[188:191], v5 offset:576
    ds_read_b128 v[192:195], v5 offset:1152
    ds_read_b128 v[196:199], v5 offset:1728
    s_mov_b64 exec, -1
    v_exp_f32 v21, v21
    v_exp_f32 v22, v22
    v_exp_f32 v23, v23
    v_exp_f32 v24, v24
    v_exp_f32 v25, v25
    v_exp_f32 v26, v26
    v_exp_f32 v27, v27
    v_exp_f32 v28, v28
    v_smfmac_f32_32x32x32_bf16 v[112:127], v[200:203], v[16:23], v216
    v_exp_f32 v29, v29
    v_exp_f32 v30, v30
    v_exp_f32 v31, v31
    v_exp_f32 v32, v32
    v_exp_f32 v33, v33
    v_smfmac_f32_32x32x32_bf16 v[112:127], v[204:207], v[24:31], v216
    v_exp_f32 v34, v34
    v_exp_f32 v35, v35
    v_exp_f32 v36, v36
    v_exp_f32 v37, v37
    v_mfma_f32_32x32x16_bf16 v[48:63], v[180:183], v[152:155], v[48:63]
    v_exp_f32 v38, v38
    v_exp_f32 v39, v39
    v_exp_f32 v40, v40
    v_mfma_f32_32x32x16_bf16 v[64:79], v[180:183], v[156:159], v[64:79]
    v_exp_f32 v41, v41
    v_exp_f32 v42, v42
    v_exp_f32 v43, v43
    v_exp_f32 v44, v44
    v_smfmac_f32_32x32x32_bf16 v[128:143], v[200:203], v[32:39], v216
    v_exp_f32 v45, v45
    v_exp_f32 v46, v46
    v_exp_f32 v47, v47
    v_exp_f32 v48, v48
    v_exp_f32 v49, v49
    v_smfmac_f32_32x32x32_bf16 v[128:143], v[204:207], v[40:47], v216
    v_exp_f32 v50, v50
    v_exp_f32 v51, v51
    v_exp_f32 v52, v52
    s_waitcnt lgkmcnt(0)
    v_cmp_gt_u32 vcc, 4, v242
    s_cbranch_vccnz B_retry8
B_back8:
    v_mfma_f32_32x32x4_2b_bf16 v[16:47], v[164:165], v[160:161], 0 cbsz:1 abid:0
    v_exp_f32 v53, v53
    v_exp_f32 v54, v54
    v_exp_f32 v55, v55
    v_exp_f32 v56, v56
    v_exp_f32 v57, v57
    v_exp_f32 v58, v58
    v_exp_f32 v59, v59
    v_exp_f32 v60, v60
    v_smfmac_f32_32x32x32_bf16 v[112:127], v[208:211], v[48:55], v216
    v_exp_f32 v61, v61
    v_exp_f32 v62, v62
    v_exp_f32 v63, v63
    v_exp_f32 v64, v64
    v_exp_f32 v65, v65
    v_smfmac_f32_32x32x32_bf16 v[112:127], v[212:215], v[56:63], v216
    v_exp_f32 v66, v66
    v_exp_f32 v67, v67
    v_exp_f32 v68, v68
    v_exp_f32 v69, v69
    v_mfma_f32_32x32x16_bf16 v[16:31], v[168:171], v[144:147], v[16:31]
    v_exp_f32 v70, v70
    v_exp_f32 v71, v71
    v_exp_f32 v72, v72
    v_mfma_f32_32x32x16_bf16 v[32:47], v[168:171], v[148:151], v[32:47]
    v_exp_f32 v73, v73
    v_exp_f32 v74, v74
    v_exp_f32 v75, v75
    v_exp_f32 v76, v76
    v_smfmac_f32_32x32x32_bf16 v[128:143], v[208:211], v[64:71], v216
    v_exp_f32 v77, v77
    v_exp_f32 v78, v78
    v_exp_f32 v79, v79
    v_exp_f32 v16, v16
    v_exp_f32 v17, v17
    v_smfmac_f32_32x32x32_bf16 v[128:143], v[212:215], v[72:79], v216
    v_exp_f32 v18, v18
    v_exp_f32 v19, v19
    v_exp_f32 v20, v20
    v_mfma_f32_32x32x4_2b_bf16 v[48:79], v[164:165], v[160:161], 0 cbsz:1 abid:1
    ds_read_b64 v[166:167], v6 offset:4864
    ds_read2st64_b64 v[176:179], v4 offset0:9 offset1:10
    ds_read2st64_b64 v[180:183], v3 offset0:10 offset1:11
    s_mov_b64 exec, s[40:41]
    ds_read_b128 v[200:203], v5 offset:4864
    ds_read_b128 v[204:207], v5 offset:5440
    ds_read_b128 v[208:211], v5 offset:6016
    ds_read_b128 v[212:215], v5 offset:6592
    s_mov_b64 exec, -1
    v_exp_f32 v21, v21
    v_exp_f32 v22, v22
    v_exp_f32 v23, v23
    v_exp_f32 v24, v24
    v_exp_f32 v25, v25
    v_exp_f32 v26, v26
    v_exp_f32 v27, v27
    v_exp_f32 v28, v28
    v_smfmac_f32_32x32x32_bf16 v[80:95], v[184:187], v[16:23], v216
    v_exp_f32 v29, v29
    v_exp_f32 v30, v30
    v_exp_f32 v31, v31
    v_exp_f32 v32, v32
    v_exp_f32 v33, v33
    v_smfmac_f32_32x32x32_bf16 v[80:95], v[188:191], v[24:31], v216
    v_exp_f32 v34, v34
    v_exp_f32 v35, v35
    v_exp_f32 v36, v36
    v_exp_f32 v37, v37
    v_mfma_f32_32x32x16_bf16 v[48:63], v[172:175], v[144:147], v[48:63]
    v_exp_f32 v38, v38
    v_exp_f32 v39, v39
    v_exp_f32 v40, v40
    v_mfma_f32_32x32x16_bf16 v[64:79], v[172:175], v[148:151], v[64:79]
    v_exp_f32 v41, v41
    v_exp_f32 v42, v42
    v_exp_f32 v43, v43
    v_exp_f32 v44, v44
    v_smfmac_f32_32x32x32_bf16 v[96:111], v[184:187], v[32:39], v216
    v_exp_f32 v45, v45
    v_exp_f32 v46, v46
    v_exp_f32 v47, v47
    v_exp_f32 v48, v48
    v_exp_f32 v49, v49
    v_smfmac_f32_32x32x32_bf16 v[96:111], v[188:191], v[40:47], v216
    v_exp_f32 v50, v50
    v_exp_f32 v51, v51
    v_exp_f32 v52, v52
    v_mfma_f32_32x32x4_2b_bf16 v[16:47], v[164:165], v[162:163], 0 cbsz:1 abid:0
    v_exp_f32 v53, v53
    v_exp_f32 v54, v54
    v_exp_f32 v55, v55
    v_exp_f32 v56, v56
    v_exp_f32 v57, v57
    v_exp_f32 v58, v58
    v_exp_f32 v59, v59
    v_exp_f32 v60, v60
    v_smfmac_f32_32x32x32_bf16 v[80:95], v[192:195], v[48:55], v216
    v_exp_f32 v61, v61
    v_exp_f32 v62, v62
    v_exp_f32 v63, v63
    v_exp_f32 v64, v64
    v_exp_f32 v65, v65
    v_smfmac_f32_32x32x32_bf16 v[80:95], v[196:199], v[56:63], v216
    v_exp_f32 v66, v66
    v_exp_f32 v67, v67
    v_exp_f32 v68, v68
    v_exp_f32 v69, v69
    v_mfma_f32_32x32x16_bf16 v[16:31], v[168:171], v[152:155], v[16:31]
    v_exp_f32 v70, v70
    v_exp_f32 v71, v71
    v_exp_f32 v72, v72
    v_mfma_f32_32x32x16_bf16 v[32:47], v[168:171], v[156:159], v[32:47]
    v_exp_f32 v73, v73
    v_exp_f32 v74, v74
    v_exp_f32 v75, v75
    v_exp_f32 v76, v76
    v_smfmac_f32_32x32x32_bf16 v[96:111], v[192:195], v[64:71], v216
    v_exp_f32 v77, v77
    v_exp_f32 v78, v78
    v_exp_f32 v79, v79
    v_exp_f32 v16, v16
    v_exp_f32 v17, v17
    v_smfmac_f32_32x32x32_bf16 v[96:111], v[196:199], v[72:79], v216
    v_exp_f32 v18, v18
    v_exp_f32 v19, v19
    v_exp_f32 v20, v20
    v_mfma_f32_32x32x4_2b_bf16 v[48:79], v[164:165], v[162:163], 0 cbsz:1 abid:1
    v_exp_f32 v21, v21
    v_exp_f32 v22, v22
    v_exp_f32 v23, v23
    v_exp_f32 v24, v24
    v_exp_f32 v25, v25
    v_exp_f32 v26, v26
    v_exp_f32 v27, v27
    v_exp_f32 v28, v28
    v_smfmac_f32_32x32x32_bf16 v[112:127], v[184:187], v[16:23], v216
    v_exp_f32 v29, v29
    v_exp_f32 v30, v30
    v_exp_f32 v31, v31
    v_exp_f32 v32, v32
    v_exp_f32 v33, v33
    v_smfmac_f32_32x32x32_bf16 v[112:127], v[188:191], v[24:31], v216
    v_exp_f32 v34, v34
    v_exp_f32 v35, v35
    v_exp_f32 v36, v36
    v_exp_f32 v37, v37
    v_mfma_f32_32x32x16_bf16 v[48:63], v[172:175], v[152:155], v[48:63]
    v_exp_f32 v38, v38
    v_exp_f32 v39, v39
    v_exp_f32 v40, v40
    v_mfma_f32_32x32x16_bf16 v[64:79], v[172:175], v[156:159], v[64:79]
    v_exp_f32 v41, v41
    v_exp_f32 v42, v42
    v_exp_f32 v43, v43
    v_exp_f32 v44, v44
    v_smfmac_f32_32x32x32_bf16 v[128:143], v[184:187], v[32:39], v216
    v_exp_f32 v45, v45
    v_exp_f32 v46, v46
    v_exp_f32 v47, v47
    v_exp_f32 v48, v48
    v_exp_f32 v49, v49
    v_smfmac_f32_32x32x32_bf16 v[128:143], v[188:191], v[40:47], v216
    v_exp_f32 v50, v50
    v_exp_f32 v51, v51
    v_exp_f32 v52, v52
    s_waitcnt lgkmcnt(0)
    v_mfma_f32_32x32x4_2b_bf16 v[16:47], v[166:167], v[160:161], 0 cbsz:1 abid:0
    v_exp_f32 v53, v53
    v_exp_f32 v54, v54
    v_exp_f32 v55, v55
I_b_1:
    s_cbranch_execz I_b_2
    v_exp_f32 v56, v56
    v_exp_f32 v57, v57
    v_exp_f32 v58, v58
    v_exp_f32 v59, v59
    v_exp_f32 v60, v60
    v_smfmac_f32_32x32x32_bf16 v[112:127], v[192:195], v[48:55], v216
    v_exp_f32 v61, v61
    v_exp_f32 v62, v62
    v_exp_f32 v63, v63
    v_exp_f32 v64, v64
    v_exp_f32 v65, v65
    v_smfmac_f32_32x32x32_bf16 v[112:127], v[196:199], v[56:63], v216
    v_exp_f32 v66, v66
    v_exp_f32 v67, v67
    v_exp_f32 v68, v68
    v_exp_f32 v69, v69
    v_mfma_f32_32x32x16_bf16 v[16:31], v[176:179], v[144:147], v[16:31]
    v_exp_f32 v70, v70
    v_exp_f32 v71, v71
    v_exp_f32 v72, v72
    v_mfma_f32_32x32x16_bf16 v[32:47], v[176:179], v[148:151], v[32:47]
    v_exp_f32 v73, v73
    v_exp_f32 v74, v74
    v_exp_f32 v75, v75
    v_exp_f32 v76, v76
    v_smfmac_f32_32x32x32_bf16 v[128:143], v[192:195], v[64:71], v216
    v_exp_f32 v77, v77
    v_exp_f32 v78, v78
    v_exp_f32 v79, v79
    v_exp_f32 v16, v16
    v_exp_f32 v17, v17
    v_smfmac_f32_32x32x32_bf16 v[128:143], v[196:199], v[72:79], v216
    v_exp_f32 v18, v18
    v_exp_f32 v19, v19
    v_exp_f32 v20, v20
    v_mfma_f32_32x32x4_2b_bf16 v[48:79], v[166:167], v[160:161], 0 cbsz:1 abid:1
    ds_add_u32 v241, v227 offset:28
    ds_read_b64 v[164:165], v6 offset:19456
    ds_read2st64_b64 v[168:171], v3 offset0:38 offset1:39
    ds_read2st64_b64 v[172:175], v4 offset0:38 offset1:39
    s_mov_b64 exec, s[40:41]
    ds_read_b128 v[184:187], v5 offset:19456
    ds_read_b128 v[188:191], v5 offset:20032
    ds_read_b128 v[192:195], v5 offset:20608
    ds_read_b128 v[196:199], v5 offset:21184
    s_mov_b64 exec, -1
    v_exp_f32 v21, v21
    v_exp_f32 v22, v22
    v_exp_f32 v23, v23
    v_exp_f32 v24, v24
    v_exp_f32 v25, v25
    v_exp_f32 v26, v26
    v_exp_f32 v27, v27
    v_exp_f32 v28, v28
    v_smfmac_f32_32x32x32_bf16 v[80:95], v[200:203], v[16:23], v216
    v_exp_f32 v29, v29
    v_exp_f32 v30, v30
    v_exp_f32 v31, v31
    v_exp_f32 v32, v32
    v_exp_f32 v33, v33
    v_smfmac_f32_32x32x32_bf16 v[80:95], v[204:207], v[24:31], v216
    v_exp_f32 v34, v34
    v_exp_f32 v35, v35
    v_exp_f32 v36, v36
    v_exp_f32 v37, v37
    v_mfma_f32_32x32x16_bf16 v[48:63], v[180:183], v[144:147], v[48:63]
    v_exp_f32 v38, v38
    v_exp_f32 v39, v39
    v_exp_f32 v40, v40
    v_mfma_f32_32x32x16_bf16 v[64:79], v[180:183], v[148:151], v[64:79]
    v_exp_f32 v41, v41
    v_exp_f32 v42, v42
    v_exp_f32 v43, v43
    v_exp_f32 v44, v44
    v_smfmac_f32_32x32x32_bf16 v[96:111], v[200:203], v[32:39], v216
    v_exp_f32 v45, v45
    v_exp_f32 v46, v46
    v_exp_f32 v47, v47
    v_exp_f32 v48, v48
    v_exp_f32 v49, v49
    v_smfmac_f32_32x32x32_bf16 v[96:111], v[204:207], v[40:47], v216
    v_exp_f32 v50, v50
    v_exp_f32 v51, v51
    v_exp_f32 v52, v52
    v_mfma_f32_32x32x4_2b_bf16 v[16:47], v[166:167], v[162:163], 0 cbsz:1 abid:0
    v_exp_f32 v53, v53
    v_exp_f32 v54, v54
    v_exp_f32 v55, v55
    v_exp_f32 v56, v56
    v_exp_f32 v57, v57
    v_exp_f32 v58, v58
    v_exp_f32 v59, v59
    v_exp_f32 v60, v60
    v_smfmac_f32_32x32x32_bf16 v[80:95], v[208:211], v[48:55], v216
    v_exp_f32 v61, v61
    v_exp_f32 v62, v62
    v_exp_f32 v63, v63
    v_exp_f32 v64, v64
    v_exp_f32 v65, v65
    v_smfmac_f32_32x32x32_bf16 v[80:95], v[212:215], v[56:63], v216
    v_exp_f32 v66, v66
    v_exp_f32 v67, v67
    v_exp_f32 v68, v68
    v_exp_f32 v69, v69
    v_mfma_f32_32x32x16_bf16 v[16:31], v[176:179], v[152:155], v[16:31]
    v_exp_f32 v70, v70
    v_exp_f32 v71, v71
    v_exp_f32 v72, v72
    v_mfma_f32_32x32x16_bf16 v[32:47], v[176:179], v[156:159], v[32:47]
    v_exp_f32 v73, v73
    v_exp_f32 v74, v74
    v_exp_f32 v75, v75
    v_exp_f32 v76, v76
    v_smfmac_f32_32x32x32_bf16 v[96:111], v[208:211], v[64:71], v216
    v_exp_f32 v77, v77
    v_exp_f32 v78, v78
    v_exp_f32 v79, v79
    v_exp_f32 v16, v16
    v_exp_f32 v17, v17
    v_smfmac_f32_32x32x32_bf16 v[96:111], v[212:215], v[72:79], v216
    v_exp_f32 v18, v18
    v_exp_f32 v19, v19
    v_exp_f32 v20, v20
    v_mfma_f32_32x32x4_2b_bf16 v[48:79], v[166:167], v[162:163], 0 cbsz:1 abid:1
    v_exp_f32 v21, v21
    v_exp_f32 v22, v22
    v_exp_f32 v23, v23
    v_exp_f32 v24, v24
    v_exp_f32 v25, v25
    v_exp_f32 v26, v26
    v_exp_f32 v27, v27
    v_exp_f32 v28, v28
    v_smfmac_f32_32x32x32_bf16 v[112:127], v[200:203], v[16:23], v216
    v_exp_f32 v29, v29
    v_exp_f32 v30, v30
    v_exp_f32 v31, v31
    v_exp_f32 v32, v32
    v_exp_f32 v33, v33
    v_smfmac_f32_32x32x32_bf16 v[112:127], v[204:207], v[24:31], v216
    v_exp_f32 v34, v34
    v_exp_f32 v35, v35
    v_exp_f32 v36, v36
    v_exp_f32 v37, v37
    v_mfma_f32_32x32x16_bf16 v[48:63], v[180:183], v[152:155], v[48:63]
    v_exp_f32 v38, v38
    v_exp_f32 v39, v39
    v_exp_f32 v40, v40
    v_mfma_f32_32x32x16_bf16 v[64:79], v[180:183], v[156:159], v[64:79]
    v_exp_f32 v41, v41
    v_exp_f32 v42, v42
    v_exp_f32 v43, v43
    v_exp_f32 v44, v44
    v_smfmac_f32_32x32x32_bf16 v[128:143], v[200:203], v[32:39], v216
    v_exp_f32 v45, v45
    v_exp_f32 v46, v46
    v_exp_f32 v47, v47
    v_exp_f32 v48, v48
    v_exp_f32 v49, v49
    v_smfmac_f32_32x32x32_bf16 v[128:143], v[204:207], v[40:47], v216
    v_exp_f32 v50, v50
    v_exp_f32 v51, v51
    v_exp_f32 v52, v52
    s_waitcnt lgkmcnt(0)
    v_mfma_f32_32x32x4_2b_bf16 v[16:47], v[164:165], v[160:161], 0 cbsz:1 abid:0
    v_exp_f32 v53, v53
    v_exp_f32 v54, v54
    v_exp_f32 v55, v55
    v_exp_f32 v56, v56
    v_exp_f32 v57, v57
    v_exp_f32 v58, v58
    v_exp_f32 v59, v59
    v_exp_f32 v60, v60
    v_smfmac_f32_32x32x32_bf16 v[112:127], v[208:211], v[48:55], v216
    v_exp_f32 v61, v61
    v_exp_f32 v62, v62
    v_exp_f32 v63, v63
    v_exp_f32 v64, v64
    v_exp_f32 v65, v65
    v_smfmac_f32_32x32x32_bf16 v[112:127], v[212:215], v[56:63], v216
    v_exp_f32 v66, v66
    v_exp_f32 v67, v67
    v_exp_f32 v68, v68
    v_exp_f32 v69, v69
    v_mfma_f32_32x32x16_bf16 v[16:31], v[168:171], v[144:147], v[16:31]
    v_exp_f32 v70, v70
    v_exp_f32 v71, v71
    v_exp_f32 v72, v72
    v_mfma_f32_32x32x16_bf16 v[32:47], v[168:171], v[148:151], v[32:47]
    v_exp_f32 v73, v73
    v_exp_f32 v74, v74
    v_exp_f32 v75, v75
    v_exp_f32 v76, v76
    v_smfmac_f32_32x32x32_bf16 v[128:143], v[208:211], v[64:71], v216
    v_exp_f32 v77, v77
    v_exp_f32 v78, v78
    v_exp_f32 v79, v79
    v_exp_f32 v16, v16
    v_exp_f32 v17, v17
    v_smfmac_f32_32x32x32_bf16 v[128:143], v[212:215], v[72:79], v216
    v_exp_f32 v18, v18
    v_exp_f32 v19, v19
    v_exp_f32 v20, v20
    v_mfma_f32_32x32x4_2b_bf16 v[48:79], v[164:165], v[160:161], 0 cbsz:1 abid:1
    ds_read_b64 v[166:167], v6 offset:24320
    ds_read2st64_b64 v[176:179], v4 offset0:47 offset1:48
    ds_read2st64_b64 v[180:183], v3 offset0:48 offset1:49
    s_mov_b64 exec, s[40:41]
    ds_read_b128 v[200:203], v5 offset:24320
    ds_read_b128 v[204:207], v5 offset:24896
    ds_read_b128 v[208:211], v5 offset:25472
    ds_read_b128 v[212:215], v5 offset:26048
    s_mov_b64 exec, -1
    v_exp_f32 v21, v21
    v_exp_f32 v22, v22
    v_exp_f32 v23, v23
    v_exp_f32 v24, v24
    v_exp_f32 v25, v25
    v_exp_f32 v26, v26
    v_exp_f32 v27, v27
    v_exp_f32 v28, v28
    v_smfmac_f32_32x32x32_bf16 v[80:95], v[184:187], v[16:23], v216
    v_exp_f32 v29, v29
    v_exp_f32 v30, v30
    v_exp_f32 v31, v31
    v_exp_f32 v32, v32
    v_exp_f32 v33, v33
    v_smfmac_f32_32x32x32_bf16 v[80:95], v[188:191], v[24:31], v216
    v_exp_f32 v34, v34
    v_exp_f32 v35, v35
    v_exp_f32 v36, v36
    v_exp_f32 v37, v37
    v_mfma_f32_32x32x16_bf16 v[48:63], v[172:175], v[144:147], v[48:63]
    v_exp_f32 v38, v38
    v_exp_f32 v39, v39
    v_exp_f32 v40, v40
    v_mfma_f32_32x32x16_bf16 v[64:79], v[172:175], v[148:151], v[64:79]
    v_exp_f32 v41, v41
    v_exp_f32 v42, v42
    v_exp_f32 v43, v43
    v_exp_f32 v44, v44
    v_smfmac_f32_32x32x32_bf16 v[96:111], v[184:187], v[32:39], v216
    v_exp_f32 v45, v45
    v_exp_f32 v46, v46
    v_exp_f32 v47, v47
    v_exp_f32 v48, v48
    v_exp_f32 v49, v49
    v_smfmac_f32_32x32x32_bf16 v[96:111], v[188:191], v[40:47], v216
    v_exp_f32 v50, v50
    v_exp_f32 v51, v51
    v_exp_f32 v52, v52
    v_mfma_f32_32x32x4_2b_bf16 v[16:47], v[164:165], v[162:163], 0 cbsz:1 abid:0
    v_exp_f32 v53, v53
    v_exp_f32 v54, v54
    v_exp_f32 v55, v55
    v_exp_f32 v56, v56
    v_exp_f32 v57, v57
    v_exp_f32 v58, v58
    v_exp_f32 v59, v59
    v_exp_f32 v60, v60
    v_smfmac_f32_32x32x32_bf16 v[80:95], v[192:195], v[48:55], v216
    v_exp_f32 v61, v61
    v_exp_f32 v62, v62
    v_exp_f32 v63, v63
    v_exp_f32 v64, v64
    v_exp_f32 v65, v65
    v_smfmac_f32_32x32x32_bf16 v[80:95], v[196:199], v[56:63], v216
    v_exp_f32 v66, v66
    v_exp_f32 v67, v67
    v_exp_f32 v68, v68
    v_exp_f32 v69, v69
    v_mfma_f32_32x32x16_bf16 v[16:31], v[168:171], v[152:155], v[16:31]
    v_exp_f32 v70, v70
    v_exp_f32 v71, v71
    v_exp_f32 v72, v72
    v_mfma_f32_32x32x16_bf16 v[32:47], v[168:171], v[156:159], v[32:47]
    v_exp_f32 v73, v73
    v_exp_f32 v74, v74
    v_exp_f32 v75, v75
    v_exp_f32 v76, v76
    v_smfmac_f32_32x32x32_bf16 v[96:111], v[192:195], v[64:71], v216
    v_exp_f32 v77, v77
    v_exp_f32 v78, v78
    v_exp_f32 v79, v79
    v_exp_f32 v16, v16
    v_exp_f32 v17, v17
    v_smfmac_f32_32x32x32_bf16 v[96:111], v[196:199], v[72:79], v216
    v_exp_f32 v18, v18
    v_exp_f32 v19, v19
    v_exp_f32 v20, v20
    v_mfma_f32_32x32x4_2b_bf16 v[48:79], v[164:165], v[162:163], 0 cbsz:1 abid:1
    v_exp_f32 v21, v21
    v_exp_f32 v22, v22
    v_exp_f32 v23, v23
    v_exp_f32 v24, v24
    v_exp_f32 v25, v25
    v_exp_f32 v26, v26
    v_exp_f32 v27, v27
    v_exp_f32 v28, v28
    v_smfmac_f32_32x32x32_bf16 v[112:127], v[184:187], v[16:23], v216
    v_exp_f32 v29, v29
    v_exp_f32 v30, v30
    v_exp_f32 v31, v31
    v_exp_f32 v32, v32
    v_exp_f32 v33, v33
    v_smfmac_f32_32x32x32_bf16 v[112:127], v[188:191], v[24:31], v216
    v_exp_f32 v34, v34
    v_exp_f32 v35, v35
    v_exp_f32 v36, v36
    v_exp_f32 v37, v37
    v_mfma_f32_32x32x16_bf16 v[48:63], v[172:175], v[152:155], v[48:63]
    v_exp_f32 v38, v38
    v_exp_f32 v39, v39
    v_exp_f32 v40, v40
    v_mfma_f32_32x32x16_bf16 v[64:79], v[172:175], v[156:159], v[64:79]
    v_exp_f32 v41, v41
    v_exp_f32 v42, v42
    v_exp_f32 v43, v43
    v_exp_f32 v44, v44
    v_smfmac_f32_32x32x32_bf16 v[128:143], v[184:187], v[32:39], v216
    v_exp_f32 v45, v45
    v_exp_f32 v46, v46
    v_exp_f32 v47, v47
    v_exp_f32 v48, v48
    v_exp_f32 v49, v49
    v_smfmac_f32_32x32x32_bf16 v[128:143], v[188:191], v[40:47], v216
    v_exp_f32 v50, v50
    v_exp_f32 v51, v51
    v_exp_f32 v52, v52
    s_waitcnt lgkmcnt(0)
    v_mfma_f32_32x32x4_2b_bf16 v[16:47], v[166:167], v[160:161], 0 cbsz:1 abid:0
    v_exp_f32 v53, v53
    v_exp_f32 v54, v54
    v_exp_f32 v55, v55
    v_exp_f32 v56, v56
    v_exp_f32 v57, v57
    v_exp_f32 v58, v58
    v_exp_f32 v59, v59
    v_exp_f32 v60, v60
    v_smfmac_f32_32x32x32_bf16 v[112:127], v[192:195], v[48:55], v216
    v_exp_f32 v61, v61
    v_exp_f32 v62, v62
    v_exp_f32 v63, v63
    v_exp_f32 v64, v64
    v_exp_f32 v65, v65
    v_smfmac_f32_32x32x32_bf16 v[112:127], v[196:199], v[56:63], v216
    v_exp_f32 v66, v66
    v_exp_f32 v67, v67
    v_exp_f32 v68, v68
    v_exp_f32 v69, v69
    v_mfma_f32_32x32x16_bf16 v[16:31], v[176:179], v[144:147], v[16:31]
    v_exp_f32 v70, v70
    v_exp_f32 v71, v71
    v_exp_f32 v72, v72
    v_mfma_f32_32x32x16_bf16 v[32:47], v[176:179], v[148:151], v[32:47]
    v_exp_f32 v73, v73
    v_exp_f32 v74, v74
    v_exp_f32 v75, v75
    v_exp_f32 v76, v76
    v_smfmac_f32_32x32x32_bf16 v[128:143], v[192:195], v[64:71], v216
    v_exp_f32 v77, v77
    v_exp_f32 v78, v78
    v_exp_f32 v79, v79
    v_exp_f32 v16, v16
    v_exp_f32 v17, v17
    v_smfmac_f32_32x32x32_bf16 v[128:143], v[196:199], v[72:79], v216
    v_exp_f32 v18, v18
    v_exp_f32 v19, v19
    v_exp_f32 v20, v20
    v_mfma_f32_32x32x4_2b_bf16 v[48:79], v[166:167], v[160:161], 0 cbsz:1 abid:1
    ds_read_b32 v242, v229 offset:56
    ds_read_b64 v[164:165], v6 offset:38912
    ds_read2st64_b64 v[168:171], v3 offset0:76 offset1:77
    ds_read2st64_b64 v[172:175], v4 offset0:76 offset1:77
    s_mov_b64 exec, s[40:41]
    ds_read_b128 v[184:187], v5 offset:38912
    ds_read_b128 v[188:191], v5 offset:39488
    ds_read_b128 v[192:195], v5 offset:40064
    ds_read_b128 v[196:199], v5 offset:40640
    s_mov_b64 exec, -1
    v_exp_f32 v21, v21
    v_exp_f32 v22, v22
    v_exp_f32 v23, v23
    v_exp_f32 v24, v24
    v_exp_f32 v25, v25
    v_exp_f32 v26, v26
    v_exp_f32 v27, v27
    v_exp_f32 v28, v28
    v_smfmac_f32_32x32x32_bf16 v[80:95], v[200:203], v[16:23], v216
    v_exp_f32 v29, v29
    v_exp_f32 v30, v30
    v_exp_f32 v31, v31
    v_exp_f32 v32, v32
    v_exp_f32 v33, v33
    v_smfmac_f32_32x32x32_bf16 v[80:95], v[204:207], v[24:31], v216
    v_exp_f32 v34, v34
    v_exp_f32 v35, v35
    v_exp_f32 v36, v36
    v_exp_f32 v37, v37
    v_mfma_f32_32x32x16_bf16 v[48:63], v[180:183], v[144:147], v[48:63]
    v_exp_f32 v38, v38
    v_exp_f32 v39, v39
    v_exp_f32 v40, v40
    v_mfma_f32_32x32x16_bf16 v[64:79], v[180:183], v[148:151], v[64:79]
    v_exp_f32 v41, v41
    v_exp_f32 v42, v42
    v_exp_f32 v43, v43
    v_exp_f32 v44, v44
    v_smfmac_f32_32x32x32_bf16 v[96:111], v[200:203], v[32:39], v216
    v_exp_f32 v45, v45
    v_exp_f32 v46, v46
    v_exp_f32 v47, v47
    v_exp_f32 v48, v48
    v_exp_f32 v49, v49
    v_smfmac_f32_32x32x32_bf16 v[96:111], v[204:207], v[40:47], v216
    v_exp_f32 v50, v50
    v_exp_f32 v51, v51
    v_exp_f32 v52, v52
    v_mfma_f32_32x32x4_2b_bf16 v[16:47], v[166:167], v[162:163], 0 cbsz:1 abid:0
    v_exp_f32 v53, v53
    v_exp_f32 v54, v54
    v_exp_f32 v55, v55
    v_exp_f32 v56, v56
    v_exp_f32 v57, v57
    v_exp_f32 v58, v58
    v_exp_f32 v59, v59
    v_exp_f32 v60, v60
    v_smfmac_f32_32x32x32_bf16 v[80:95], v[208:211], v[48:55], v216
    v_exp_f32 v61, v61
    v_exp_f32 v62, v62
    v_exp_f32 v63, v63
    v_exp_f32 v64, v64
    v_exp_f32 v65, v65
    v_smfmac_f32_32x32x32_bf16 v[80:95], v[212:215], v[56:63], v216
    v_exp_f32 v66, v66
    v_exp_f32 v67, v67
    v_exp_f32 v68, v68
    v_exp_f32 v69, v69
    v_mfma_f32_32x32x16_bf16 v[16:31], v[176:179], v[152:155], v[16:31]
    v_exp_f32 v70, v70
    v_exp_f32 v71, v71
    v_exp_f32 v72, v72
    v_mfma_f32_32x32x16_bf16 v[32:47], v[176:179], v[156:159], v[32:47]
    v_exp_f32 v73, v73
    v_exp_f32 v74, v74
    v_exp_f32 v75, v75
    v_exp_f32 v76, v76
    v_smfmac_f32_32x32x32_bf16 v[96:111], v[208:211], v[64:71], v216
    v_exp_f32 v77, v77
    v_exp_f32 v78, v78
    v_exp_f32 v79, v79
    v_exp_f32 v16, v16
    v_exp_f32 v17, v17
    v_smfmac_f32_32x32x32_bf16 v[96:111], v[212:215], v[72:79], v216
    v_exp_f32 v18, v18
    v_exp_f32 v19, v19
    v_exp_f32 v20, v20
    v_mfma_f32_32x32x4_2b_bf16 v[48:79], v[166:167], v[162:163], 0 cbsz:1 abid:1
    v_exp_f32 v21, v21
    v_exp_f32 v22, v22
    v_exp_f32 v23, v23
    v_exp_f32 v24, v24
    v_exp_f32 v25, v25
    v_exp_f32 v26, v26
    v_exp_f32 v27, v27
    v_exp_f32 v28, v28
    v_smfmac_f32_32x32x32_bf16 v[112:127], v[200:203], v[16:23], v216
    v_exp_f32 v29, v29
    v_exp_f32 v30, v30
    v_exp_f32 v31, v31
    v_exp_f32 v32, v32
    v_exp_f32 v33, v33
    v_smfmac_f32_32x32x32_bf16 v[112:127], v[204:207], v[24:31], v216
    v_exp_f32 v34, v34
    v_exp_f32 v35, v35
    v_exp_f32 v36, v36
    v_exp_f32 v37, v37
    v_mfma_f32_32x32x16_bf16 v[48:63], v[180:183], v[152:155], v[48:63]
    v_exp_f32 v38, v38
    v_exp_f32 v39, v39
    v_exp_f32 v40, v40
    v_mfma_f32_32x32x16_bf16 v[64:79], v[180:183], v[156:159], v[64:79]
    v_exp_f32 v41, v41
    v_exp_f32 v42, v42
    v_exp_f32 v43, v43
    v_exp_f32 v44, v44
    v_smfmac_f32_32x32x32_bf16 v[128:143], v[200:203], v[32:39], v216
    v_exp_f32 v45, v45
    v_exp_f32 v46, v46
    v_exp_f32 v47, v47
    v_exp_f32 v48, v48
    v_exp_f32 v49, v49
    v_smfmac_f32_32x32x32_bf16 v[128:143], v[204:207], v[40:47], v216
    v_exp_f32 v50, v50
    v_exp_f32 v51, v51
    v_exp_f32 v52, v52
    s_waitcnt lgkmcnt(0)
    v_cmp_gt_u32 vcc, 4, v242
    s_cbranch_vccnz B_retry12
B_back12:
    v_mfma_f32_32x32x4_2b_bf16 v[16:47], v[164:165], v[160:161], 0 cbsz:1 abid:0
    v_exp_f32 v53, v53
    v_exp_f32 v54, v54
    v_exp_f32 v55, v55
    v_exp_f32 v56, v56
    v_exp_f32 v57, v57
    v_exp_f32 v58, v58
    v_exp_f32 v59, v59
    v_exp_f32 v60, v60
    v_smfmac_f32_32x32x32_bf16 v[112:127], v[208:211], v[48:55], v216
    v_exp_f32 v61, v61
    v_exp_f32 v62, v62
    v_exp_f32 v63, v63
    v_exp_f32 v64, v64
    v_exp_f32 v65, v65
    v_smfmac_f32_32x32x32_bf16 v[112:127], v[212:215], v[56:63], v216
    v_exp_f32 v66, v66
    v_exp_f32 v67, v67
    v_exp_f32 v68, v68
    v_exp_f32 v69, v69
    v_mfma_f32_32x32x16_bf16 v[16:31], v[168:171], v[144:147], v[16:31]
    v_exp_f32 v70, v70
    v_exp_f32 v71, v71
    v_exp_f32 v72, v72
    v_mfma_f32_32x32x16_bf16 v[32:47], v[168:171], v[148:151], v[32:47]
    v_exp_f32 v73, v73
    v_exp_f32 v74, v74
    v_exp_f32 v75, v75
    v_exp_f32 v76, v76
    v_smfmac_f32_32x32x32_bf16 v[128:143], v[208:211], v[64:71], v216
    v_exp_f32 v77, v77
    v_exp_f32 v78, v78
    v_exp_f32 v79, v79
    v_exp_f32 v16, v16
    v_exp_f32 v17, v17
    v_smfmac_f32_32x32x32_bf16 v[128:143], v[212:215], v[72:79], v216
    v_exp_f32 v18, v18
    v_exp_f32 v19, v19
    v_exp_f32 v20, v20
    v_mfma_f32_32x32x4_2b_bf16 v[48:79], v[164:165], v[160:161], 0 cbsz:1 abid:1
    ds_read_b64 v[166:167], v6 offset:43776
    ds_read2st64_b64 v[176:179], v4 offset0:85 offset1:86
    ds_read2st64_b64 v[180:183], v3 offset0:86 offset1:87
    s_mov_b64 exec, s[40:41]
    ds_read_b128 v[200:203], v5 offset:43776
    ds_read_b128 v[204:207], v5 offset:44352
    ds_read_b128 v[208:211], v5 offset:44928
    ds_read_b128 v[212:215], v5 offset:45504
    s_mov_b64 exec, -1
    v_exp_f32 v21, v21
    v_exp_f32 v22, v22
    v_exp_f32 v23, v23
    v_exp_f32 v24, v24
    v_exp_f32 v25, v25
    v_exp_f32 v26, v26
    v_exp_f32 v27, v27
    v_exp_f32 v28, v28
    v_smfmac_f32_32x32x32_bf16 v[80:95], v[184:187], v[16:23], v216
    v_exp_f32 v29, v29
    v_exp_f32 v30, v30
    v_exp_f32 v31, v31
    v_exp_f32 v32, v32
    v_exp_f32 v33, v33
    v_smfmac_f32_32x32x32_bf16 v[80:95], v[188:191], v[24:31], v216
    v_exp_f32 v34, v34
    v_exp_f32 v35, v35
    v_exp_f32 v36, v36
    v_exp_f32 v37, v37
    v_mfma_f32_32x32x16_bf16 v[48:63], v[172:175], v[144:147], v[48:63]
    v_exp_f32 v38, v38
    v_exp_f32 v39, v39
    v_exp_f32 v40, v40
    v_mfma_f32_32x32x16_bf16 v[64:79], v[172:175], v[148:151], v[64:79]
    v_exp_f32 v41, v41
    v_exp_f32 v42, v42
    v_exp_f32 v43, v43
    v_exp_f32 v44, v44
    v_smfmac_f32_32x32x32_bf16 v[96:111], v[184:187], v[32:39], v216
    v_exp_f32 v45, v45
    v_exp_f32 v46, v46
    v_exp_f32 v47, v47
    v_exp_f32 v48, v48
    v_exp_f32 v49, v49
    v_smfmac_f32_32x32x32_bf16 v[96:111], v[188:191], v[40:47], v216
    v_exp_f32 v50, v50
    v_exp_f32 v51, v51
    v_exp_f32 v52, v52
    v_mfma_f32_32x32x4_2b_bf16 v[16:47], v[164:165], v[162:163], 0 cbsz:1 abid:0
    v_exp_f32 v53, v53
    v_exp_f32 v54, v54
    v_exp_f32 v55, v55
    v_exp_f32 v56, v56
    v_exp_f32 v57, v57
    v_exp_f32 v58, v58
    v_exp_f32 v59, v59
    v_exp_f32 v60, v60
    v_smfmac_f32_32x32x32_bf16 v[80:95], v[192:195], v[48:55], v216
    v_exp_f32 v61, v61
    v_exp_f32 v62, v62
    v_exp_f32 v63, v63
    v_exp_f32 v64, v64
    v_exp_f32 v65, v65
    v_smfmac_f32_32x32x32_bf16 v[80:95], v[196:199], v[56:63], v216
    v_exp_f32 v66, v66
    v_exp_f32 v67, v67
    v_exp_f32 v68, v68
    v_exp_f32 v69, v69
    v_mfma_f32_32x32x16_bf16 v[16:31], v[168:171], v[152:155], v[16:31]
    v_exp_f32 v70, v70
    v_exp_f32 v71, v71
    v_exp_f32 v72, v72
    v_mfma_f32_32x32x16_bf16 v[32:47], v[168:171], v[156:159], v[32:47]
    v_exp_f32 v73, v73
    v_exp_f32 v74, v74
    v_exp_f32 v75, v75
    v_exp_f32 v76, v76
    v_smfmac_f32_32x32x32_bf16 v[96:111], v[192:195], v[64:71], v216
    v_exp_f32 v77, v77
    v_exp_f32 v78, v78
    v_exp_f32 v79, v79
    v_exp_f32 v16, v16
    v_exp_f32 v17, v17
    v_smfmac_f32_32x32x32_bf16 v[96:111], v[196:199], v[72:79], v216
    v_exp_f32 v18, v18
    v_exp_f32 v19, v19
    v_exp_f32 v20, v20
    v_mfma_f32_32x32x4_2b_bf16 v[48:79], v[164:165], v[162:163], 0 cbsz:1 abid:1
    v_exp_f32 v21, v21
    v_exp_f32 v22, v22
    v_exp_f32 v23, v23
    v_exp_f32 v24, v24
    v_exp_f32 v25, v25
    v_exp_f32 v26, v26
    v_exp_f32 v27, v27
    v_exp_f32 v28, v28
    v_smfmac_f32_32x32x32_bf16 v[112:127], v[184:187], v[16:23], v216
    v_exp_f32 v29, v29
    v_exp_f32 v30, v30
    v_exp_f32 v31, v31
    v_exp_f32 v32, v32
    v_exp_f32 v33, v33
    v_smfmac_f32_32x32x32_bf16 v[112:127], v[188:191], v[24:31], v216
    v_exp_f32 v34, v34
    v_exp_f32 v35, v35
    v_exp_f32 v36, v36
    v_exp_f32 v37, v37
    v_mfma_f32_32x32x16_bf16 v[48:63], v[172:175], v[152:155], v[48:63]
    v_exp_f32 v38, v38
    v_exp_f32 v39, v39
    v_exp_f32 v40, v40
    v_mfma_f32_32x32x16_bf16 v[64:79], v[172:175], v[156:159], v[64:79]
    v_exp_f32 v41, v41
    v_exp_f32 v42, v42
    v_exp_f32 v43, v43
    v_exp_f32 v44, v44
    v_smfmac_f32_32x32x32_bf16 v[128:143], v[184:187], v[32:39], v216
    v_exp_f32 v45, v45
    v_exp_f32 v46, v46
    v_exp_f32 v47, v47
    v_exp_f32 v48, v48
    v_exp_f32 v49, v49
    v_smfmac_f32_32x32x32_bf16 v[128:143], v[188:191], v[40:47], v216
    v_exp_f32 v50, v50
    v_exp_f32 v51, v51
    v_exp_f32 v52, v52
    s_waitcnt lgkmcnt(0)
    v_mfma_f32_32x32x4_2b_bf16 v[16:47], v[166:167], v[160:161], 0 cbsz:1 abid:0
    v_exp_f32 v53, v53
    v_exp_f32 v54, v54
    v_exp_f32 v55, v55
    v_exp_f32 v56, v56
    v_exp_f32 v57, v57
    v_exp_f32 v58, v58
    v_exp_f32 v59, v59
    v_exp_f32 v60, v60
    v_smfmac_f32_32x32x32_bf16 v[112:127], v[192:195], v[48:55], v216
    v_exp_f32 v61, v61
    v_exp_f32 v62, v62
    v_exp_f32 v63, v63
    v_exp_f32 v64, v64
    v_exp_f32 v65, v65
    v_smfmac_f32_32x32x32_bf16 v[112:127], v[196:199], v[56:63], v216
    v_exp_f32 v66, v66
    v_exp_f32 v67, v67
    v_exp_f32 v68, v68
    v_exp_f32 v69, v69
    v_mfma_f32_32x32x16_bf16 v[16:31], v[176:179], v[144:147], v[16:31]
    v_exp_f32 v70, v70
    v_exp_f32 v71, v71
    v_exp_f32 v72, v72
    v_mfma_f32_32x32x16_bf16 v[32:47], v[176:179], v[148:151], v[32:47]
    v_exp_f32 v73, v73
    v_exp_f32 v74, v74
    v_exp_f32 v75, v75
    v_exp_f32 v76, v76
    v_smfmac_f32_32x32x32_bf16 v[128:143], v[192:195], v[64:71], v216
    v_exp_f32 v77, v77
    v_exp_f32 v78, v78
    v_exp_f32 v79, v79
    v_exp_f32 v16, v16
    v_exp_f32 v17, v17
    v_smfmac_f32_32x32x32_bf16 v[128:143], v[196:199], v[72:79], v216
    v_exp_f32 v18, v18
    v_exp_f32 v19, v19
    v_exp_f32 v20, v20
    v_mfma_f32_32x32x4_2b_bf16 v[48:79], v[166:167], v[160:161], 0 cbsz:1 abid:1
    ds_read_b64 v[164:165], v6 offset:58368
    ds_read2st64_b64 v[168:171], v3 offset0:114 offset1:115
    ds_read2st64_b64 v[172:175], v4 offset0:114 offset1:115
    s_mov_b64 exec, s[40:41]
    ds_read_b128 v[184:187], v5 offset:58368
    ds_read_b128 v[188:191], v5 offset:58944
    ds_read_b128 v[192:195], v5 offset:59520
    ds_read_b128 v[196:199], v5 offset:60096
    s_mov_b64 exec, -1
    v_exp_f32 v21, v21
    v_exp_f32 v22, v22
    v_exp_f32 v23, v23
    v_exp_f32 v24, v24
    v_exp_f32 v25, v25
    v_exp_f32 v26, v26
    v_exp_f32 v27, v27
    v_exp_f32 v28, v28
    v_smfmac_f32_32x32x32_bf16 v[80:95], v[200:203], v[16:23], v216
    v_exp_f32 v29, v29
    v_exp_f32 v30, v30
    v_exp_f32 v31, v31
    v_exp_f32 v32, v32
    v_exp_f32 v33, v33
    v_smfmac_f32_32x32x32_bf16 v[80:95], v[204:207], v[24:31], v216
    v_exp_f32 v34, v34
    v_exp_f32 v35, v35
    v_exp_f32 v36, v36
    v_exp_f32 v37, v37
    v_mfma_f32_32x32x16_bf16 v[48:63], v[180:183], v[144:147], v[48:63]
    v_exp_f32 v38, v38
    v_exp_f32 v39, v39
    v_exp_f32 v40, v40
    v_mfma_f32_32x32x16_bf16 v[64:79], v[180:183], v[148:151], v[64:79]
    v_exp_f32 v41, v41
    v_exp_f32 v42, v42
    v_exp_f32 v43, v43
    v_exp_f32 v44, v44
    v_smfmac_f32_32x32x32_bf16 v[96:111], v[200:203], v[32:39], v216
    v_exp_f32 v45, v45
    v_exp_f32 v46, v46
    v_exp_f32 v47, v47
    v_exp_f32 v48, v48
    v_exp_f32 v49, v49
    v_smfmac_f32_32x32x32_bf16 v[96:111], v[204:207], v[40:47], v216
    v_exp_f32 v50, v50
    v_exp_f32 v51, v51
    v_exp_f32 v52, v52
    v_mfma_f32_32x32x4_2b_bf16 v[16:47], v[166:167], v[162:163], 0 cbsz:1 abid:0
    v_exp_f32 v53, v53
    v_exp_f32 v54, v54
    v_exp_f32 v55, v55
    v_exp_f32 v56, v56
    v_exp_f32 v57, v57
    v_exp_f32 v58, v58
    v_exp_f32 v59, v59
    v_exp_f32 v60, v60
    v_smfmac_f32_32x32x32_bf16 v[80:95], v[208:211], v[48:55], v216
    v_exp_f32 v61, v61
    v_exp_f32 v62, v62
    v_exp_f32 v63, v63
    v_exp_f32 v64, v64
    v_exp_f32 v65, v65
    v_smfmac_f32_32x32x32_bf16 v[80:95], v[212:215], v[56:63], v216
    v_exp_f32 v66, v66
    v_exp_f32 v67, v67
    v_exp_f32 v68, v68
    v_exp_f32 v69, v69
    v_mfma_f32_32x32x16_bf16 v[16:31], v[176:179], v[152:155], v[16:31]
    v_exp_f32 v70, v70
    v_exp_f32 v71, v71
    v_exp_f32 v72, v72
    v_mfma_f32_32x32x16_bf16 v[32:47], v[176:179], v[156:159], v[32:47]
    v_exp_f32 v73, v73
    v_exp_f32 v74, v74
    v_exp_f32 v75, v75
    v_exp_f32 v76, v76
    v_smfmac_f32_32x32x32_bf16 v[96:111], v[208:211], v[64:71], v216
    v_exp_f32 v77, v77
    v_exp_f32 v78, v78
    v_exp_f32 v79, v79
    v_exp_f32 v16, v16
    v_exp_f32 v17, v17
    v_smfmac_f32_32x32x32_bf16 v[96:111], v[212:215], v[72:79], v216
    v_exp_f32 v18, v18
    v_exp_f32 v19, v19
    v_exp_f32 v20, v20
    v_mfma_f32_32x32x4_2b_bf16 v[48:79], v[166:167], v[162:163], 0 cbsz:1 abid:1
    v_exp_f32 v21, v21
    v_exp_f32 v22, v22
    v_exp_f32 v23, v23
    v_exp_f32 v24, v24
    v_exp_f32 v25, v25
    v_exp_f32 v26, v26
    v_exp_f32 v27, v27
    v_exp_f32 v28, v28
    v_smfmac_f32_32x32x32_bf16 v[112:127], v[200:203], v[16:23], v216
    v_exp_f32 v29, v29
    v_exp_f32 v30, v30
    v_exp_f32 v31, v31
    v_exp_f32 v32, v32
    v_exp_f32 v33, v33
    v_smfmac_f32_32x32x32_bf16 v[112:127], v[204:207], v[24:31], v216
    v_exp_f32 v34, v34
    v_exp_f32 v35, v35
    v_exp_f32 v36, v36
    v_exp_f32 v37, v37
    v_mfma_f32_32x32x16_bf16 v[48:63], v[180:183], v[152:155], v[48:63]
    v_exp_f32 v38, v38
    v_exp_f32 v39, v39
    v_exp_f32 v40, v40
    v_mfma_f32_32x32x16_bf16 v[64:79], v[180:183], v[156:159], v[64:79]
    v_exp_f32 v41, v41
    v_exp_f32 v42, v42
    v_exp_f32 v43, v43
    v_exp_f32 v44, v44
    v_smfmac_f32_32x32x32_bf16 v[128:143], v[200:203], v[32:39], v216
    v_exp_f32 v45, v45
    v_exp_f32 v46, v46
    v_exp_f32 v47, v47
    v_exp_f32 v48, v48
    v_exp_f32 v49, v49
    v_smfmac_f32_32x32x32_bf16 v[128:143], v[204:207], v[40:47], v216
    v_exp_f32 v50, v50
    v_exp_f32 v51, v51
    v_exp_f32 v52, v52
    s_waitcnt lgkmcnt(0)
    v_mfma_f32_32x32x4_2b_bf16 v[16:47], v[164:165], v[160:161], 0 cbsz:1 abid:0
    v_exp_f32 v53, v53
    v_exp_f32 v54, v54
    v_exp_f32 v55, v55
    v_exp_f32 v56, v56
    v_exp_f32 v57, v57
    v_exp_f32 v58, v58
    v_exp_f32 v59, v59
    v_exp_f32 v60, v60
    v_smfmac_f32_32x32x32_bf16 v[112:127], v[208:211], v[48:55], v216
    v_exp_f32 v61, v61
    v_exp_f32 v62, v62
    v_exp_f32 v63, v63
    v_exp_f32 v64, v64
    v_exp_f32 v65, v65
I_b_2:
    s_cbranch_execz I_b_r
    v_smfmac_f32_32x32x32_bf16 v[112:127], v[212:215], v[56:63], v216
    v_exp_f32 v66, v66
    v_exp_f32 v67, v67
    v_exp_f32 v68, v68
    v_exp_f32 v69, v69
    v_mfma_f32_32x32x16_bf16 v[16:31], v[168:171], v[144:147], v[16:31]
    v_exp_f32 v70, v70
    v_exp_f32 v71, v71
    v_exp_f32 v72, v72
    v_mfma_f32_32x32x16_bf16 v[32:47], v[168:171], v[148:151], v[32:47]
    v_exp_f32 v73, v73
    v_exp_f32 v74, v74
    v_exp_f32 v75, v75
    v_exp_f32 v76, v76
    v_smfmac_f32_32x32x32_bf16 v[128:143], v[208:211], v[64:71], v216
    v_exp_f32 v77, v77
    v_exp_f32 v78, v78
    v_exp_f32 v79, v79
    v_exp_f32 v16, v16
    v_exp_f32 v17, v17
    v_smfmac_f32_32x32x32_bf16 v[128:143], v[212:215], v[72:79], v216
    v_exp_f32 v18, v18
    v_exp_f32 v19, v19
    v_exp_f32 v20, v20
    v_mfma_f32_32x32x4_2b_bf16 v[48:79], v[164:165], v[160:161], 0 cbsz:1 abid:1
    ds_read_b32 v242, v229 offset:28
    ds_read_b64 v[166:167], v6 offset:63232
    ds_read2st64_b64 v[176:179], v4 offset0:123 offset1:124
    ds_read2st64_b64 v[180:183], v3 offset0:124 offset1:125
    s_mov_b64 exec, s[40:41]
    ds_read_b128 v[200:203], v5 offset:63232
    ds_read_b128 v[204:207], v5 offset:63808
    ds_read_b128 v[208:211], v5 offset:64384
    ds_read_b128 v[212:215], v5 offset:64960
    s_mov_b64 exec, -1
    v_exp_f32 v21, v21
    v_exp_f32 v22, v22
    v_exp_f32 v23, v23
    v_exp_f32 v24, v24
    v_exp_f32 v25, v25
    v_exp_f32 v26, v26
    v_exp_f32 v27, v27
    v_exp_f32 v28, v28
    v_smfmac_f32_32x32x32_bf16 v[80:95], v[184:187], v[16:23], v216
    v_exp_f32 v29, v29
    v_exp_f32 v30, v30
    v_exp_f32 v31, v31
    v_exp_f32 v32, v32
    v_exp_f32 v33, v33
    v_smfmac_f32_32x32x32_bf16 v[80:95], v[188:191], v[24:31], v216
    v_exp_f32 v34, v34
    v_exp_f32 v35, v35
    v_exp_f32 v36, v36
    v_exp_f32 v37, v37
    v_mfma_f32_32x32x16_bf16 v[48:63], v[172:175], v[144:147], v[48:63]
    v_exp_f32 v38, v38
    v_exp_f32 v39, v39
    v_exp_f32 v40, v40
    v_mfma_f32_32x32x16_bf16 v[64:79], v[172:175], v[148:151], v[64:79]
    v_exp_f32 v41, v41
    v_exp_f32 v42, v42
    v_exp_f32 v43, v43
    v_exp_f32 v44, v44
    v_smfmac_f32_32x32x32_bf16 v[96:111], v[184:187], v[32:39], v216
    v_exp_f32 v45, v45
    v_exp_f32 v46, v46
    v_exp_f32 v47, v47
    v_exp_f32 v48, v48
    v_exp_f32 v49, v49
    v_smfmac_f32_32x32x32_bf16 v[96:111], v[188:191], v[40:47], v216
    v_exp_f32 v50, v50
    v_exp_f32 v51, v51
    v_exp_f32 v52, v52
    v_mfma_f32_32x32x4_2b_bf16 v[16:47], v[164:165], v[162:163], 0 cbsz:1 abid:0
    v_exp_f32 v53, v53
    v_exp_f32 v54, v54
    v_exp_f32 v55, v55
    v_exp_f32 v56, v56
    v_exp_f32 v57, v57
    v_exp_f32 v58, v58
    v_exp_f32 v59, v59
    v_exp_f32 v60, v60
    v_smfmac_f32_32x32x32_bf16 v[80:95], v[192:195], v[48:55], v216
    v_exp_f32 v61, v61
    v_exp_f32 v62, v62
    v_exp_f32 v63, v63
    v_exp_f32 v64, v64
    v_exp_f32 v65, v65
    v_smfmac_f32_32x32x32_bf16 v[80:95], v[196:199], v[56:63], v216
    v_exp_f32 v66, v66
    v_exp_f32 v67, v67
    v_exp_f32 v68, v68
    v_exp_f32 v69, v69
    v_mfma_f32_32x32x16_bf16 v[16:31], v[168:171], v[152:155], v[16:31]
    v_exp_f32 v70, v70
    v_exp_f32 v71, v71
    v_exp_f32 v72, v72
    v_mfma_f32_32x32x16_bf16 v[32:47], v[168:171], v[156:159], v[32:47]
    v_exp_f32 v73, v73
    v_exp_f32 v74, v74
    v_exp_f32 v75, v75
    v_exp_f32 v76, v76
    v_smfmac_f32_32x32x32_bf16 v[96:111], v[192:195], v[64:71], v216
    v_exp_f32 v77, v77
    v_exp_f32 v78, v78
    v_exp_f32 v79, v79
    v_exp_f32 v16, v16
    v_exp_f32 v17, v17
    v_smfmac_f32_32x32x32_bf16 v[96:111], v[196:199], v[72:79], v216
    v_exp_f32 v18, v18
    v_exp_f32 v19, v19
    v_exp_f32 v20, v20
    v_mfma_f32_32x32x4_2b_bf16 v[48:79], v[164:165], v[162:163], 0 cbsz:1 abid:1
    v_exp_f32 v21, v21
    v_exp_f32 v22, v22
    v_exp_f32 v23, v23
    v_exp_f32 v24, v24
    v_exp_f32 v25, v25
    v_exp_f32 v26, v26
    v_exp_f32 v27, v27
    v_exp_f32 v28, v28
    v_smfmac_f32_32x32x32_bf16 v[112:127], v[184:187], v[16:23], v216
    v_exp_f32 v29, v29
    v_exp_f32 v30, v30
    v_exp_f32 v31, v31
    v_exp_f32 v32, v32
    v_exp_f32 v33, v33
    v_smfmac_f32_32x32x32_bf16 v[112:127], v[188:191], v[24:31], v216
    v_exp_f32 v34, v34
    v_exp_f32 v35, v35
    v_exp_f32 v36, v36
    v_exp_f32 v37, v37
    v_mfma_f32_32x32x16_bf16 v[48:63], v[172:175], v[152:155], v[48:63]
    v_exp_f32 v38, v38
    v_exp_f32 v39, v39
    v_exp_f32 v40, v40
    v_mfma_f32_32x32x16_bf16 v[64:79], v[172:175], v[156:159], v[64:79]
    v_exp_f32 v41, v41
    v_exp_f32 v42, v42
    v_exp_f32 v43, v43
    v_exp_f32 v44, v44
    v_smfmac_f32_32x32x32_bf16 v[128:143], v[184:187], v[32:39], v216
    v_exp_f32 v45, v45
    v_exp_f32 v46, v46
    v_exp_f32 v47, v47
    v_exp_f32 v48, v48
    v_exp_f32 v49, v49
    v_smfmac_f32_32x32x32_bf16 v[128:143], v[188:191], v[40:47], v216
    v_exp_f32 v50, v50
    v_exp_f32 v51, v51
    v_exp_f32 v52, v52
    s_waitcnt lgkmcnt(0)
    v_cmp_gt_u32 vcc, 8, v242
    s_cbranch_vccnz B_retry15
B_back15:
    v_mfma_f32_32x32x4_2b_bf16 v[16:47], v[166:167], v[160:161], 0 cbsz:1 abid:0
    v_exp_f32 v53, v53
    v_exp_f32 v54, v54
    v_exp_f32 v55, v55
    v_exp_f32 v56, v56
    v_exp_f32 v57, v57
    v_exp_f32 v58, v58
    v_exp_f32 v59, v59
    v_exp_f32 v60, v60
    v_smfmac_f32_32x32x32_bf16 v[112:127], v[192:195], v[48:55], v216
    v_exp_f32 v61, v61
    v_exp_f32 v62, v62
    v_exp_f32 v63, v63
    v_exp_f32 v64, v64
    v_exp_f32 v65, v65
    v_smfmac_f32_32x32x32_bf16 v[112:127], v[196:199], v[56:63], v216
    v_exp_f32 v66, v66
    v_exp_f32 v67, v67
    v_exp_f32 v68, v68
    v_exp_f32 v69, v69
    v_mfma_f32_32x32x16_bf16 v[16:31], v[176:179], v[144:147], v[16:31]
    v_exp_f32 v70, v70
    v_exp_f32 v71, v71
    v_exp_f32 v72, v72
    v_mfma_f32_32x32x16_bf16 v[32:47], v[176:179], v[148:151], v[32:47]
    v_exp_f32 v73, v73
    v_exp_f32 v74, v74
    v_exp_f32 v75, v75
    v_exp_f32 v76, v76
    v_smfmac_f32_32x32x32_bf16 v[128:143], v[192:195], v[64:71], v216
    v_exp_f32 v77, v77
    v_exp_f32 v78, v78
    v_exp_f32 v79, v79
    v_exp_f32 v16, v16
    v_exp_f32 v17, v17
    v_smfmac_f32_32x32x32_bf16 v[128:143], v[196:199], v[72:79], v216
    v_exp_f32 v18, v18
    v_exp_f32 v19, v19
    v_exp_f32 v20, v20
    v_mfma_f32_32x32x4_2b_bf16 v[48:79], v[166:167], v[160:161], 0 cbsz:1 abid:1
    v_exp_f32 v21, v21
    v_exp_f32 v22, v22
    v_exp_f32 v23, v23
    v_exp_f32 v24, v24
    v_exp_f32 v25, v25
    v_exp_f32 v26, v26
    v_exp_f32 v27, v27
    v_exp_f32 v28, v28
    v_smfmac_f32_32x32x32_bf16 v[80:95], v[200:203], v[16:23], v216
    v_exp_f32 v29, v29
    v_exp_f32 v30, v30
    v_exp_f32 v31, v31
    v_exp_f32 v32, v32
    v_exp_f32 v33, v33
    v_smfmac_f32_32x32x32_bf16 v[80:95], v[204:207], v[24:31], v216
    v_exp_f32 v34, v34
    v_exp_f32 v35, v35
    v_exp_f32 v36, v36
    v_exp_f32 v37, v37
    v_mfma_f32_32x32x16_bf16 v[48:63], v[180:183], v[144:147], v[48:63]
    v_exp_f32 v38, v38
    v_exp_f32 v39, v39
    v_exp_f32 v40, v40
    v_mfma_f32_32x32x16_bf16 v[64:79], v[180:183], v[148:151], v[64:79]
    v_exp_f32 v41, v41
    v_exp_f32 v42, v42
    v_exp_f32 v43, v43
    v_exp_f32 v44, v44
    v_smfmac_f32_32x32x32_bf16 v[96:111], v[200:203], v[32:39], v216
    v_exp_f32 v45, v45
    v_exp_f32 v46, v46
    v_exp_f32 v47, v47
    v_exp_f32 v48, v48
    v_exp_f32 v49, v49
    v_smfmac_f32_32x32x32_bf16 v[96:111], v[204:207], v[40:47], v216
    v_exp_f32 v50, v50
    v_exp_f32 v51, v51
    v_exp_f32 v52, v52
    v_mfma_f32_32x32x4_2b_bf16 v[16:47], v[166:167], v[162:163], 0 cbsz:1 abid:0
    v_exp_f32 v53, v53
    v_exp_f32 v54, v54
    v_exp_f32 v55, v55
    v_exp_f32 v56, v56
    v_exp_f32 v57, v57
    v_exp_f32 v58, v58
    v_exp_f32 v59, v59
    v_exp_f32 v60, v60
    v_smfmac_f32_32x32x32_bf16 v[80:95], v[208:211], v[48:55], v216
    v_exp_f32 v61, v61
    v_exp_f32 v62, v62
    v_exp_f32 v63, v63
    v_exp_f32 v64, v64
    v_exp_f32 v65, v65
    v_smfmac_f32_32x32x32_bf16 v[80:95], v[212:215], v[56:63], v216
    v_exp_f32 v66, v66
    v_exp_f32 v67, v67
    v_exp_f32 v68, v68
    v_exp_f32 v69, v69
    v_mfma_f32_32x32x16_bf16 v[16:31], v[176:179], v[152:155], v[16:31]
    v_exp_f32 v70, v70
    v_exp_f32 v71, v71
    v_exp_f32 v72, v72
    v_mfma_f32_32x32x16_bf16 v[32:47], v[176:179], v[156:159], v[32:47]
    v_exp_f32 v73, v73
    v_exp_f32 v74, v74
    v_exp_f32 v75, v75
    v_exp_f32 v76, v76
    v_smfmac_f32_32x32x32_bf16 v[96:111], v[208:211], v[64:71], v216
    v_exp_f32 v77, v77
    v_exp_f32 v78, v78
    v_exp_f32 v79, v79
    v_exp_f32 v16, v16
    v_exp_f32 v17, v17
    v_smfmac_f32_32x32x32_bf16 v[96:111], v[212:215], v[72:79], v216
    v_exp_f32 v18, v18
    v_exp_f32 v19, v19
    v_exp_f32 v20, v20
    v_mfma_f32_32x32x4_2b_bf16 v[48:79], v[166:167], v[162:163], 0 cbsz:1 abid:1
    v_exp_f32 v21, v21
    ds_write_b128 v219, v[80:83] offset:0
    v_exp_f32 v22, v22
    v_exp_f32 v23, v23
    v_exp_f32 v24, v24
    ds_write_b128 v219, v[84:87] offset:1024
    v_exp_f32 v25, v25
    v_exp_f32 v26, v26
    v_exp_f32 v27, v27
    v_exp_f32 v28, v28
    v_smfmac_f32_32x32x32_bf16 v[112:127], v[200:203], v[16:23], v216
    v_exp_f32 v29, v29
    v_exp_f32 v30, v30
    v_permlane32_swap_b32 v88, v104
    v_permlane32_swap_b32 v89, v105
    v_permlane32_swap_b32 v90, v106
    ds_write_b128 v219, v[96:99] offset:2048
    v_exp_f32 v31, v31
    v_exp_f32 v32, v32
    v_exp_f32 v33, v33
    v_smfmac_f32_32x32x32_bf16 v[112:127], v[204:207], v[24:31], v216
    v_exp_f32 v34, v34
    ds_write_b128 v219, v[100:103] offset:3072
    v_exp_f32 v35, v35
    v_exp_f32 v36, v36
    v_exp_f32 v37, v37
    v_mfma_f32_32x32x16_bf16 v[48:63], v[180:183], v[152:155], v[48:63]
    v_exp_f32 v38, v38
    ds_write_b64 v220, v[88:89] offset:4096
    v_exp_f32 v39, v39
    v_exp_f32 v40, v40
    v_mfma_f32_32x32x16_bf16 v[64:79], v[180:183], v[156:159], v[64:79]
    v_exp_f32 v41, v41
    ds_write_b32 v221, v90 offset:4608
    ds_add_u32 v243, v227 offset:32
    v_exp_f32 v42, v42
    v_exp_f32 v43, v43
    v_exp_f32 v44, v44
    v_smfmac_f32_32x32x32_bf16 v[128:143], v[200:203], v[32:39], v216
    v_exp_f32 v45, v45
    v_exp_f32 v46, v46
    v_exp_f32 v47, v47
    v_exp_f32 v48, v48
    v_exp_f32 v49, v49
    v_smfmac_f32_32x32x32_bf16 v[128:143], v[204:207], v[40:47], v216
    v_exp_f32 v50, v50
    v_exp_f32 v51, v51
    v_exp_f32 v52, v52
    v_exp_f32 v53, v53
    v_exp_f32 v54, v54
    v_exp_f32 v55, v55
    v_exp_f32 v56, v56
    v_exp_f32 v57, v57
    v_smfmac_f32_32x32x32_bf16 v[112:127], v[208:211], v[48:55], v216
    v_exp_f32 v58, v58
    v_exp_f32 v59, v59
    v_exp_f32 v60, v60
    v_exp_f32 v61, v61
    ds_read_b32 v242, v244 offset:32
    ds_read_b128 v[80:83], v222 offset:0
    ds_read_b128 v[84:87], v222 offset:1024
    ds_read_b128 v[88:91], v222 offset:2048
    ds_read_b128 v[92:95], v222 offset:3072
    ds_read_b64 v[96:97], v223 offset:4096
    ds_read_b32 v98, v224 offset:4608
    v_exp_f32 v62, v62
    v_exp_f32 v63, v63
    v_exp_f32 v64, v64
    v_exp_f32 v65, v65
    v_smfmac_f32_32x32x32_bf16 v[112:127], v[212:215], v[56:63], v216
    v_exp_f32 v66, v66
    v_exp_f32 v67, v67
    v_exp_f32 v68, v68
    v_exp_f32 v69, v69
    v_exp_f32 v70, v70
    v_exp_f32 v71, v71
    v_exp_f32 v72, v72
    v_exp_f32 v73, v73
    v_smfmac_f32_32x32x32_bf16 v[128:143], v[208:211], v[64:71], v216
    v_exp_f32 v74, v74
    v_exp_f32 v75, v75
    v_exp_f32 v76, v76
    v_exp_f32 v77, v77
    v_exp_f32 v78, v78
    v_exp_f32 v79, v79
    s_mov_b32 s48, 0
    s_waitcnt lgkmcnt(0)
    v_smfmac_f32_32x32x32_bf16 v[128:143], v[212:215], v[72:79], v216
    v_cmp_eq_u32 vcc, 0, v242
    s_cbranch_vccnz B_retryx
B_backx:
    v_add_f32 v112, v112, v80
    v_add_f32 v113, v113, v81
    v_add_f32 v114, v114, v82
    v_add_f32 v115, v115, v83
    v_add_f32 v116, v116, v84
    v_add_f32 v117, v117, v85
    v_add_f32 v118, v118, v86
    v_add_f32 v119, v119, v87
    s_mov_b32 s28, 0x3f800000
    v_mov_b32 v13, 0x71800000
    v_permlane32_swap_b32 v120, v136
    v_permlane32_swap_b32 v121, v137
    v_permlane32_swap_b32 v122, v138
    v_add_f32 v122, v122, v98
    v_add_f32 v120, v120, v96
    v_add_f32 v121, v121, v97
    v_med3_f32 v13, v122, s28, v13
    v_cmp_neq_f32 vcc, v13, v122
    v_pk_add_f32 v[128:129], v[128:129], v[88:89]
    v_pk_add_f32 v[130:131], v[130:131], v[90:91]
    v_pk_add_f32 v[132:133], v[132:133], v[92:93]
    v_pk_add_f32 v[134:135], v[134:135], v[94:95]
    s_cbranch_vccnz B_slow0
B_norm:
    v_rcp_f32 v14, v122
    s_nop 0
    v_mov_b32 v12, v14
    v_mul_f32 v120, v14, v120
    v_mul_f32 v121, v14, v121
    v_permlane32_swap_b32 v14, v12
    v_cvt_pk_bf16_f32 v24, v120, v121
    v_pk_mul_f32 v[112:113], v[112:113], v[14:15] op_sel_hi:[1,0]
    v_pk_mul_f32 v[114:115], v[114:115], v[14:15] op_sel_hi:[1,0]
    v_pk_mul_f32 v[116:117], v[116:117], v[14:15] op_sel_hi:[1,0]
    v_pk_mul_f32 v[118:119], v[118:119], v[14:15] op_sel_hi:[1,0]
    v_cvt_pk_bf16_f32 v16, v112, v114
    v_cvt_pk_bf16_f32 v17, v116, v118
    v_cvt_pk_bf16_f32 v18, v113, v115
    v_cvt_pk_bf16_f32 v19, v117, v119
    buffer_store_dwordx4 v[16:19], v217, s[16:19], s50 offen sc1
    v_pk_mul_f32 v[128:129], v[128:129], v[12:13] op_sel_hi:[1,0]
    v_pk_mul_f32 v[130:131], v[130:131], v[12:13] op_sel_hi:[1,0]
    v_pk_mul_f32 v[132:133], v[132:133], v[12:13] op_sel_hi:[1,0]
    v_pk_mul_f32 v[134:135], v[134:135], v[12:13] op_sel_hi:[1,0]
    v_cvt_pk_bf16_f32 v20, v128, v130
    v_cvt_pk_bf16_f32 v21, v132, v134
    v_cvt_pk_bf16_f32 v22, v129, v131
    v_cvt_pk_bf16_f32 v23, v133, v135
    buffer_store_dwordx4 v[20:23], v217, s[16:19], s50 offen offset:1024 sc1
    buffer_store_dword v24, v218, s[16:19], s50 offen offset:2048 sc1
    s_cmp_lg_u32 s48, 0
    s_cbranch_scc1 B_pub
    s_mov_b64 exec, 0xff
    buffer_atomic_add v227, v228, s[16:19], s69 offen sc1
    s_mov_b64 exec, -1
    s_barrier
    v_fmac_f32 v122, 0, v112
    v_fmac_f32 v122, 0, v113
    v_fmac_f32 v122, 0, v114
    v_fmac_f32 v122, 0, v115
    v_fmac_f32 v122, 0, v116
    v_fmac_f32 v122, 0, v117
    v_fmac_f32 v122, 0, v118
    v_fmac_f32 v122, 0, v119
    v_fmac_f32 v122, 0, v120
    v_fmac_f32 v122, 0, v121
    v_fmac_f32 v122, 0, v128
    v_fmac_f32 v122, 0, v129
    v_fmac_f32 v122, 0, v130
    v_fmac_f32 v122, 0, v131
    v_fmac_f32 v122, 0, v132
    v_fmac_f32 v122, 0, v133
    v_fmac_f32 v122, 0, v134
    v_fmac_f32 v122, 0, v135
    v_cmp_u_f32 vcc, v122, v122
    s_cbranch_vccnz B_slow
B_pub:
    s_mov_b64 exec, 1
    s_add_u32 s69, s69, 32768
    s_waitcnt vmcnt(0)
    buffer_atomic_add v227, v228, s[16:19], s69 offen sc1
    s_barrier
    s_endpgm
A_start:
    s_mov_b64 exec, -1
    s_and_b32 s28, s2, 3
    s_bfe_u32 s29, s2, 0x10002
    s_lshr_b32 s30, s2, 3
    s_sub_u32 s38, 5, s29
    s_mul_i32 s37, s29, 5
    s_cmp_lt_u32 s28, 2
    s_cselect_b32 s34, 28, 21
    s_cselect_b32 s33, 0, 4
    s_cmp_ge_u32 s30, s34
    s_cbranch_scc1 A_spare
    s_lshl_b32 s31, s28, 2
    s_min_u32 s32, s31, 11
    s_mul_i32 s35, s30, 37
    s_lshr_b32 s35, s35, 8
    s_mul_i32 s36, s35, 7
    s_sub_u32 s36, s30, s36
    s_add_u32 s13, s32, s35
    s_cmp_ge_u32 s13, 8
    s_cselect_b32 s35, 2, 0
    s_add_u32 s13, s13, s35
    s_mul_i32 s35, s29, 3
    s_add_u32 s35, s35, s36
    s_lshl_b32 s35, s35, 1
    s_add_u32 s35, s35, 8
    s_add_u32 s37, s37, s36
    s_cmp_lt_u32 s36, s38
    s_cselect_b32 s14, s37, s35
    s_cselect_b32 s35, 9, 1
    s_add_u32 s3, s14, s35
    s_branch A_map
A_spare:
    s_sub_u32 s35, s30, s34
    s_add_u32 s35, s35, s33
    s_and_b32 s13, s28, 1
    s_add_u32 s13, s13, 8
    s_mov_b32 s3, 27
    s_add_u32 s14, s35, s37
    s_add_u32 s36, s29, 4
    s_cmp_ge_u32 s35, s38
    s_cselect_b32 s36, s36, 0
    s_add_u32 s14, s14, s36
    s_lshl_b32 s38, s38, 1
    s_cmp_ge_u32 s35, s38
    s_cselect_b32 s36, 4, 0
    s_add_u32 s14, s14, s36
A_map:
    s_and_b32 s28, s2, 7
    s_lshr_b32 s29, s2, 3
    s_lshl_b32 s15, s28, 2
    s_lshr_b32 s30, s29, 3
    s_add_u32 s15, s15, s30
    s_and_b32 s29, s29, 7
    s_and_b32 s49, s15, 1
    s_lshr_b32 s30, s15, 1
    s_mul_i32 s31, s30, 4608
    s_mul_i32 s32, s49, 2560
    s_add_u32 s32, s32, s31
    s_add_u32 s33, s31, 2048
    s_mul_i32 s42, s11, 221184
    s_mul_i32 s43, s11, 4864
    v_lshlrev_b32 v20, 4, v0
    v_add_u32 v1, s32, v20
    v_mov_b32 v2, v1
    s_mul_i32 s34, s15, 288
    s_add_u32 s34, s34, 71168
    s_movk_i32 s35, 8928
    v_add_u32 v22, s34, v20
    v_add_u32 v21, -32, v0
    v_max_i32 v21, 0, v21
    v_mul_u32_u24 v21, 3641, v21
    v_lshrrev_b32 v21, 16, v21
    v_mad_u32_u24 v3, v21, s35, v22
    v_add_u32 v21, 32, v0
    v_max_i32 v21, 0, v21
    v_mul_u32_u24 v21, 3641, v21
    v_lshrrev_b32 v21, 16, v21
    v_mad_u32_u24 v4, v21, s35, v22
    v_add_u32 v21, 80, v0
    v_max_i32 v21, 0, v21
    v_mul_u32_u24 v21, 3641, v21
    v_lshrrev_b32 v21, 16, v21
    v_mad_u32_u24 v5, v21, s35, v22
    v_cmp_gt_u32 vcc, 32, v0
    v_add_u32 v21, s31, v20
    s_nop 0
    v_cndmask_b32 v3, v3, v21, vcc
    v_lshlrev_b32 v6, 8, v0
    s_lshr_b32 s44, s11, 1
    s_lshl_b32 s34, s15, 4
    s_add_u32 s44, s44, s34
    s_lshl_b32 s44, s44, 7
    s_add_u32 s44, s44, 9437184
    s_and_b32 s28, s2, 7
    s_lshr_b32 s29, s2, 3
    s_lshl_b32 s30, s28, 2
    s_and_b32 s31, s29, 3
    s_add_u32 s30, s30, s31
    s_lshr_b32 s31, s29, 2
    s_mul_i32 s33, s31, 144
    s_mul_i32 s45, s11, 8064
    s_add_u32 s45, s45, s33
    s_mul_i32 s46, s11, 1008
    s_add_u32 s46, s46, 77824
    s_mul_i32 s34, s30, 73728
    s_add_u32 s66, s34, 7077888
    s_lshl_b32 s67, s11, 6
    s_add_u32 s67, s67, s66
    s_add_u32 s67, s67, 2048
    s_lshl_b32 s35, s11, 9
    s_add_u32 s66, s66, s35
    s_add_u32 s68, s34, s33
    s_lshr_b32 s35, s11, 1
    s_mul_i32 s35, s35, 36864
    s_add_u32 s68, s68, s35
    s_and_b32 s35, s11, 1
    s_mul_i32 s35, s35, 9216
    s_add_u32 s68, s68, s35
    s_mul_i32 s70, s11, 2560
    s_add_u32 s70, s70, 20480
    s_lshl_b32 s69, s30, 3
    s_add_u32 s69, s69, s31
    s_lshl_b32 s69, s69, 7
    s_add_u32 s69, s69, 9502720
    v_mul_u32_u24 v21, 7282, v0
    v_lshrrev_b32 v21, 16, v21
    v_mul_u32_u24 v7, 1008, v21
    v_add_u32 v7, v20, v7
    v_and_b32 v22, 15, v0
    v_lshrrev_b32 v23, 4, v0
    v_lshrrev_b32 v24, 5, v0
    v_mul_u32_u24 v8, 2304, v24
    v_and_b32 v25, 31, v0
    v_lshl_add_u32 v8, v25, 4, v8
    v_lshlrev_b32 v19, 7, v0
    v_lshrrev_b32 v25, 2, v0
    v_mul_u32_u24 v9, 2240, v25
    v_add_u32 v9, v20, v9
    v_lshrrev_b32 v25, 2, v22
    v_mul_u32_u24 v24, 18, v24
    v_and_b32 v26, 1, v23
    v_lshl_add_u32 v24, v26, 2, v24
    v_and_b32 v26, 1, v25
    v_lshl_add_u32 v24, v26, 1, v24
    v_and_b32 v26, 8, v22
    v_add_u32 v24, v24, v26
    v_lshrrev_b32 v26, 1, v25
    v_lshl_add_u32 v26, v23, 2, v26
    v_mul_u32_u24 v26, 18, v26
    v_and_b32 v25, 1, v25
    v_add3_u32 v26, v26, v25, 16
    v_and_b32 v25, 3, v0
    v_lshlrev_b32 v25, 3, v25
    v_add_u32 v25, 77824, v25
    s_movk_i32 s34, 144
    v_mad_u32_u24 v10, v24, s34, v25
    v_mad_u32_u24 v12, v26, s34, v25
    v_add_u32 v11, 41472, v10
    v_mul_u32_u24 v13, 160, v22
    v_lshl_add_u32 v13, v23, 3, v13
    v_lshl_add_u32 v14, v21, 4, v20
    v_mul_u32_u24 v22, 144, v21
    v_sub_u32 v22, v20, v22
    s_movk_i32 s34, 1152
    v_add_u32 v23, 0, v21
    v_and_b32 v24, 1, v23
    v_lshrrev_b32 v23, 1, v23
    v_lshl_add_u32 v23, v24, 4, v23
    v_mad_u32_u24 v16, v23, s34, v22
    v_add_u32 v23, 7, v21
    v_and_b32 v24, 1, v23
    v_lshrrev_b32 v23, 1, v23
    v_lshl_add_u32 v23, v24, 4, v23
    v_mad_u32_u24 v17, v23, s34, v22
    v_add_u32 v23, 14, v21
    v_and_b32 v24, 1, v23
    v_lshrrev_b32 v23, 1, v23
    v_lshl_add_u32 v23, v24, 4, v23
    v_mad_u32_u24 v18, v23, s34, v22
    v_add_u32 v20, 155648, v20
    ds_write_b128 v20, v[0:3] offset:0
    ds_write_b128 v20, v[4:7] offset:1024
    ds_write_b128 v20, v[8:11] offset:2048
    ds_write_b128 v20, v[12:15] offset:3072
    ds_write_b128 v20, v[16:19] offset:4096
    s_waitcnt lgkmcnt(0)
    v_and_b32 v8, 15, v0
    v_lshrrev_b32 v9, 4, v0
    v_lshrrev_b32 v10, 1, v8
    v_xor_b32 v10, v10, v9
I_s1:
    s_cbranch_execz A_start
    v_lshlrev_b32 v10, 4, v10
    v_lshl_add_u32 v10, v8, 7, v10
    s_lshl_b32 s28, s11, 12
    s_add_u32 s28, s28, 73728
    v_add_u32 v1, s28, v10
    v_xor_b32 v2, 64, v1
    v_bfe_u32 v10, v0, 2, 2
    v_lshl_add_u32 v11, v9, 3, v10
    v_lshlrev_b32 v11, 7, v11
    v_bfe_u32 v10, v0, 3, 2
    v_lshl_add_u32 v11, v10, 5, v11
    v_and_b32 v10, 3, v0
    v_lshl_add_u32 v11, v10, 3, v11
    v_add_u32 v3, 90112, v11
    v_xor_b32 v4, 32, v3
    v_xor_b32 v5, 64, v3
    v_xor_b32 v6, 0x60, v3
    v_mov_b32 v12, 0
    v_mov_b32 v13, 0
    v_and_b32 v14, 15, v0
    v_lshlrev_b32 v14, 2, v14
    v_add_u32 v14, 163776, v14
    ds_write_b32 v14, v12
    v_mov_b32 v12, v20
    s_lshl_b32 s28, s13, 1
    s_lshr_b32 s29, s11, 1
    s_add_u32 s28, s28, s29
    s_mul_i32 s47, s28, 221184
    s_and_b32 s48, s11, 1
    s_waitcnt lgkmcnt(0)
    s_mov_b32 s16, s58
    s_mov_b32 s17, s59
    s_mov_b32 s18, 9568256
    s_mov_b32 s19, 0x00020000
    s_mov_b32 s60, s56
    s_mov_b32 s61, s57
    s_mov_b32 s62, 256
    s_mov_b32 s63, 0x00020000
    s_cmp_ge_u32 s14, 18
    s_cbranch_scc1 A_V
    v_lshlrev_b32 v7, 9, v9
    v_lshl_add_u32 v7, v8, 4, v7
    v_add_u32 v8, 0x1000, v7
    s_lshl_b32 s28, s48, 8
    s_add_u32 s47, s47, s28
    s_mov_b64 exec, 0
    s_branch I_p0_0
I_p0_r:
    s_mov_b64 exec, -1
    s_barrier
    ds_read_b64_tr_b16 v[160:161], v3 offset:0
    ds_read_b64_tr_b16 v[162:163], v3 offset:512
    ds_read_b128 v[16:19], v1 offset:0
    ds_read_b128 v[20:23], v1 offset:2048
    ds_read_b64_tr_b16 v[164:165], v4 offset:0
    ds_read_b64_tr_b16 v[166:167], v4 offset:512
    s_waitcnt lgkmcnt(2)
    v_mfma_f32_16x16x32_bf16 v[192:195], v[160:163], v[16:19], 0
    ds_read_b64_tr_b16 v[168:169], v5 offset:0
    ds_read_b64_tr_b16 v[170:171], v5 offset:512
    v_mfma_f32_16x16x32_bf16 v[196:199], v[160:163], v[20:23], 0
    ds_read_b64_tr_b16 v[172:173], v6 offset:0
    ds_read_b64_tr_b16 v[174:175], v6 offset:512
    s_waitcnt lgkmcnt(4)
    v_mfma_f32_16x16x32_bf16 v[200:203], v[164:167], v[16:19], 0
    ds_read_b64_tr_b16 v[176:177], v3 offset:4096
    ds_read_b64_tr_b16 v[178:179], v3 offset:4608
    v_mfma_f32_16x16x32_bf16 v[204:207], v[164:167], v[20:23], 0
    ds_read_b128 v[24:27], v2 offset:0
    ds_read_b128 v[28:31], v2 offset:2048
    s_waitcnt lgkmcnt(6)
    v_mfma_f32_16x16x32_bf16 v[208:211], v[168:171], v[16:19], 0
    ds_read_b64_tr_b16 v[180:181], v4 offset:4096
    ds_read_b64_tr_b16 v[182:183], v4 offset:4608
    v_mfma_f32_16x16x32_bf16 v[212:215], v[168:171], v[20:23], 0
    ds_read_b64_tr_b16 v[184:185], v5 offset:4096
    ds_read_b64_tr_b16 v[186:187], v5 offset:4608
    s_waitcnt lgkmcnt(8)
    v_mfma_f32_16x16x32_bf16 v[216:219], v[172:175], v[16:19], 0
    ds_read_b64_tr_b16 v[188:189], v6 offset:4096
    v_mfma_f32_16x16x32_bf16 v[220:223], v[172:175], v[20:23], 0
    ds_read_b64_tr_b16 v[190:191], v6 offset:4608
    s_waitcnt lgkmcnt(6)
    v_mfma_f32_16x16x32_bf16 v[192:195], v[176:179], v[24:27], v[192:195]
    v_mfma_f32_16x16x32_bf16 v[196:199], v[176:179], v[28:31], v[196:199]
    s_waitcnt lgkmcnt(4)
    v_mfma_f32_16x16x32_bf16 v[200:203], v[180:183], v[24:27], v[200:203]
    v_mfma_f32_16x16x32_bf16 v[204:207], v[180:183], v[28:31], v[204:207]
    s_waitcnt lgkmcnt(2)
    v_mfma_f32_16x16x32_bf16 v[208:211], v[184:187], v[24:27], v[208:211]
    v_mfma_f32_16x16x32_bf16 v[212:215], v[184:187], v[28:31], v[212:215]
    s_waitcnt lgkmcnt(0)
    v_mfma_f32_16x16x32_bf16 v[216:219], v[188:191], v[24:27], v[216:219]
    v_mfma_f32_16x16x32_bf16 v[220:223], v[188:191], v[28:31], v[220:223]
    s_cmp_lt_u32 s14, 9
    s_cselect_b32 s28, 221184, 0
    s_lshl_b32 s50, s14, 13
    s_add_u32 s50, s50, s47
    s_add_u32 s50, s50, s28
    s_sub_u32 s50, s50, 73728
    s_cmp_lt_u32 s3, 9
    s_cselect_b32 s28, 221184, 0
    s_lshl_b32 s71, s3, 13
    s_add_u32 s71, s71, s47
    s_add_u32 s71, s71, s28
    s_sub_u32 s71, s71, 73728
    s_cmp_ge_u32 s3, 9
    s_cselect_b32 s28, 9, 0
    s_cselect_b32 s31, 0, 4
    s_cselect_b32 s33, 4, 99
    s_cmp_ge_u32 s3, 18
    s_cselect_b32 s28, 18, s28
    s_cselect_b32 s29, 0, 2
    s_sub_u32 s28, s3, s28
    s_lshl_b32 s28, s28, 6
    s_mul_i32 s30, s28, 3641
    s_lshr_b32 s30, s30, 16
    s_max_u32 s30, s30, 1
    s_sub_u32 s30, s30, 1
    v_lshrrev_b32 v10, 3, v0
    v_add_u32 v10, s30, v10
    v_and_b32 v11, 1, v10
    v_mul_u32_u24 v11, s29, v11
    v_mul_u32_u24 v14, 18, v10
    v_sub_u32 v11, v14, v11
    s_add_u32 s29, s29, 18
    v_add_u32 v14, s29, v11
    s_add_u32 s29, s28, 64
    v_min_u32 v14, s29, v14
    v_max_u32 v11, s28, v11
    v_sub_u32 v14, v14, v11
    s_lshr_b32 s28, s13, 1
    s_and_b32 s29, s13, 1
    s_cmp_eq_u32 s28, s33
    s_cselect_b32 s29, s29, s13
    s_cselect_b32 s31, 4, s31
    s_cselect_b32 s28, 8, 1
    s_lshl_b32 s29, s29, 7
    s_add_u32 s29, s29, s31
    s_add_u32 s29, s29, 9437184
    v_and_b32 v11, 7, v0
    v_cmp_gt_u32 s[30:31], s28, v11
    v_cmp_lt_i32 vcc, 0, v14
    v_lshl_add_u32 v10, v10, 3, v11
    s_and_b64 vcc, vcc, s[30:31]
    v_lshl_add_u32 v10, v10, 8, s29
    v_cndmask_b32 v13, -16, v10, vcc
    s_cmp_ge_u32 s14, 9
    s_cselect_b32 s28, 9, 0
    s_cselect_b32 s31, 0, 4
    s_cselect_b32 s33, 4, 99
    s_cmp_ge_u32 s14, 18
    s_cselect_b32 s28, 18, s28
    s_cselect_b32 s29, 0, 2
    s_sub_u32 s28, s14, s28
    s_lshl_b32 s28, s28, 6
    s_mul_i32 s30, s28, 3641
    s_lshr_b32 s30, s30, 16
I_p0_0:
    s_cbranch_execz I_p0_1
    s_max_u32 s30, s30, 1
    s_sub_u32 s30, s30, 1
    v_lshrrev_b32 v10, 3, v0
    v_add_u32 v10, s30, v10
    v_and_b32 v11, 1, v10
    v_mul_u32_u24 v11, s29, v11
    v_mul_u32_u24 v9, 18, v10
    v_sub_u32 v11, v9, v11
    s_add_u32 s29, s29, 18
    v_add_u32 v9, s29, v11
    s_add_u32 s29, s28, 64
    v_min_u32 v9, s29, v9
    v_max_u32 v11, s28, v11
    v_sub_u32 v9, v9, v11
    s_lshr_b32 s28, s13, 1
    s_and_b32 s29, s13, 1
    s_cmp_eq_u32 s28, s33
    s_cselect_b32 s29, s29, s13
    s_cselect_b32 s31, 4, s31
    s_cselect_b32 s28, 8, 1
    s_lshl_b32 s29, s29, 7
    s_add_u32 s29, s29, s31
    s_add_u32 s29, s29, 9437184
    v_and_b32 v11, 7, v0
    v_cmp_gt_u32 s[30:31], s28, v11
    v_cmp_lt_i32 vcc, 0, v9
    v_lshl_add_u32 v10, v10, 3, v11
    s_and_b64 vcc, vcc, s[30:31]
    v_lshl_add_u32 v10, v10, 8, s29
    v_cndmask_b32 v10, -16, v10, vcc
    s_cmp_lt_u32 s14, 9
    s_cselect_b32 s32, 0x3eae1a93, 1.0
    s_barrier
    ds_read_b64_tr_b16 v[160:161], v3 offset:24576
    ds_read_b64_tr_b16 v[162:163], v3 offset:25088
    ds_read_b128 v[32:35], v1 offset:24576
    ds_read_b128 v[36:39], v1 offset:26624
    ds_read_b64_tr_b16 v[164:165], v4 offset:24576
    ds_read_b64_tr_b16 v[166:167], v4 offset:25088
    s_waitcnt lgkmcnt(2)
    v_mfma_f32_16x16x32_bf16 v[192:195], v[160:163], v[32:35], v[192:195]
    ds_read_b64_tr_b16 v[168:169], v5 offset:24576
    ds_read_b64_tr_b16 v[170:171], v5 offset:25088
    v_mfma_f32_16x16x32_bf16 v[196:199], v[160:163], v[36:39], v[196:199]
    ds_read_b64_tr_b16 v[172:173], v6 offset:24576
    ds_read_b64_tr_b16 v[174:175], v6 offset:25088
    s_waitcnt lgkmcnt(4)
    v_mfma_f32_16x16x32_bf16 v[200:203], v[164:167], v[32:35], v[200:203]
    ds_read_b64_tr_b16 v[176:177], v3 offset:28672
    ds_read_b64_tr_b16 v[178:179], v3 offset:29184
    v_mfma_f32_16x16x32_bf16 v[204:207], v[164:167], v[36:39], v[204:207]
    ds_read_b128 v[40:43], v2 offset:24576
    ds_read_b128 v[44:47], v2 offset:26624
    s_waitcnt lgkmcnt(6)
    v_mfma_f32_16x16x32_bf16 v[208:211], v[168:171], v[32:35], v[208:211]
    ds_read_b64_tr_b16 v[180:181], v4 offset:28672
    ds_read_b64_tr_b16 v[182:183], v4 offset:29184
    v_mfma_f32_16x16x32_bf16 v[212:215], v[168:171], v[36:39], v[212:215]
    ds_read_b64_tr_b16 v[184:185], v5 offset:28672
    ds_read_b64_tr_b16 v[186:187], v5 offset:29184
    s_waitcnt lgkmcnt(8)
    v_mfma_f32_16x16x32_bf16 v[216:219], v[172:175], v[32:35], v[216:219]
    ds_read_b64_tr_b16 v[188:189], v6 offset:28672
    v_mfma_f32_16x16x32_bf16 v[220:223], v[172:175], v[36:39], v[220:223]
    ds_read_b64_tr_b16 v[190:191], v6 offset:29184
    s_waitcnt lgkmcnt(6)
    v_mfma_f32_16x16x32_bf16 v[192:195], v[176:179], v[40:43], v[192:195]
    v_mfma_f32_16x16x32_bf16 v[196:199], v[176:179], v[44:47], v[196:199]
    s_waitcnt lgkmcnt(4)
    v_mfma_f32_16x16x32_bf16 v[200:203], v[180:183], v[40:43], v[200:203]
    v_mfma_f32_16x16x32_bf16 v[204:207], v[180:183], v[44:47], v[204:207]
    s_waitcnt lgkmcnt(2)
    v_mfma_f32_16x16x32_bf16 v[208:211], v[184:187], v[40:43], v[208:211]
    v_mfma_f32_16x16x32_bf16 v[212:215], v[184:187], v[44:47], v[212:215]
    s_waitcnt lgkmcnt(0)
    v_mfma_f32_16x16x32_bf16 v[216:219], v[188:191], v[40:43], v[216:219]
    v_mfma_f32_16x16x32_bf16 v[220:223], v[188:191], v[44:47], v[220:223]
    v_add_u32 v1, 0xc000, v1
    v_add_u32 v2, 0xc000, v2
    v_add_u32 v3, 0xc000, v3
    v_add_u32 v4, 0xc000, v4
    v_add_u32 v5, 0xc000, v5
    v_add_u32 v6, 0xc000, v6
    s_barrier
    ds_read_b64_tr_b16 v[160:161], v3 offset:0
    ds_read_b64_tr_b16 v[162:163], v3 offset:512
    ds_read_b128 v[48:51], v1 offset:0
    ds_read_b128 v[52:55], v1 offset:2048
    ds_read_b64_tr_b16 v[164:165], v4 offset:0
    ds_read_b64_tr_b16 v[166:167], v4 offset:512
    s_waitcnt lgkmcnt(2)
    v_mfma_f32_16x16x32_bf16 v[192:195], v[160:163], v[48:51], v[192:195]
    ds_read_b64_tr_b16 v[168:169], v5 offset:0
    ds_read_b64_tr_b16 v[170:171], v5 offset:512
    v_mfma_f32_16x16x32_bf16 v[196:199], v[160:163], v[52:55], v[196:199]
    ds_read_b64_tr_b16 v[172:173], v6 offset:0
    ds_read_b64_tr_b16 v[174:175], v6 offset:512
    s_waitcnt lgkmcnt(4)
    v_mfma_f32_16x16x32_bf16 v[200:203], v[164:167], v[48:51], v[200:203]
    ds_read_b64_tr_b16 v[176:177], v3 offset:4096
    ds_read_b64_tr_b16 v[178:179], v3 offset:4608
    v_mfma_f32_16x16x32_bf16 v[204:207], v[164:167], v[52:55], v[204:207]
    ds_read_b128 v[56:59], v2 offset:0
    ds_read_b128 v[60:63], v2 offset:2048
    s_waitcnt lgkmcnt(6)
    v_mfma_f32_16x16x32_bf16 v[208:211], v[168:171], v[48:51], v[208:211]
    ds_read_b64_tr_b16 v[180:181], v4 offset:4096
    ds_read_b64_tr_b16 v[182:183], v4 offset:4608
    v_mfma_f32_16x16x32_bf16 v[212:215], v[168:171], v[52:55], v[212:215]
    ds_read_b64_tr_b16 v[184:185], v5 offset:4096
    ds_read_b64_tr_b16 v[186:187], v5 offset:4608
    s_waitcnt lgkmcnt(8)
    v_mfma_f32_16x16x32_bf16 v[216:219], v[172:175], v[48:51], v[216:219]
    ds_read_b64_tr_b16 v[188:189], v6 offset:4096
    v_mfma_f32_16x16x32_bf16 v[220:223], v[172:175], v[52:55], v[220:223]
    ds_read_b64_tr_b16 v[190:191], v6 offset:4608
    s_waitcnt lgkmcnt(6)
    v_mfma_f32_16x16x32_bf16 v[192:195], v[176:179], v[56:59], v[192:195]
    v_mfma_f32_16x16x32_bf16 v[196:199], v[176:179], v[60:63], v[196:199]
    s_waitcnt lgkmcnt(4)
    v_mfma_f32_16x16x32_bf16 v[200:203], v[180:183], v[56:59], v[200:203]
    v_mfma_f32_16x16x32_bf16 v[204:207], v[180:183], v[60:63], v[204:207]
    s_waitcnt lgkmcnt(2)
    v_mfma_f32_16x16x32_bf16 v[208:211], v[184:187], v[56:59], v[208:211]
    v_mfma_f32_16x16x32_bf16 v[212:215], v[184:187], v[60:63], v[212:215]
    s_waitcnt lgkmcnt(0)
    v_mfma_f32_16x16x32_bf16 v[216:219], v[188:191], v[56:59], v[216:219]
    v_mfma_f32_16x16x32_bf16 v[220:223], v[188:191], v[60:63], v[220:223]
    v_add_u32 v1, 0xfffe2000, v1
    v_add_u32 v2, 0xfffe2000, v2
    v_add_u32 v3, 0xfffe2000, v3
    v_add_u32 v4, 0xfffe2000, v4
    v_add_u32 v5, 0xfffe2000, v5
    v_add_u32 v6, 0xfffe2000, v6
    s_barrier
    ds_read_b64_tr_b16 v[160:161], v3 offset:0
    ds_read_b64_tr_b16 v[162:163], v3 offset:512
    ds_read_b128 v[64:67], v1 offset:0
    ds_read_b128 v[68:71], v1 offset:2048
    ds_read_b64_tr_b16 v[164:165], v4 offset:0
    ds_read_b64_tr_b16 v[166:167], v4 offset:512
    s_waitcnt lgkmcnt(2)
    v_mfma_f32_16x16x32_bf16 v[192:195], v[160:163], v[64:67], v[192:195]
    ds_read_b64_tr_b16 v[168:169], v5 offset:0
    ds_read_b64_tr_b16 v[170:171], v5 offset:512
    v_mfma_f32_16x16x32_bf16 v[196:199], v[160:163], v[68:71], v[196:199]
    ds_read_b64_tr_b16 v[172:173], v6 offset:0
    ds_read_b64_tr_b16 v[174:175], v6 offset:512
    s_waitcnt lgkmcnt(4)
    v_mfma_f32_16x16x32_bf16 v[200:203], v[164:167], v[64:67], v[200:203]
    ds_read_b64_tr_b16 v[176:177], v3 offset:4096
    ds_read_b64_tr_b16 v[178:179], v3 offset:4608
    v_mfma_f32_16x16x32_bf16 v[204:207], v[164:167], v[68:71], v[204:207]
    ds_read_b128 v[72:75], v2 offset:0
    ds_read_b128 v[76:79], v2 offset:2048
    s_waitcnt lgkmcnt(6)
    v_mfma_f32_16x16x32_bf16 v[208:211], v[168:171], v[64:67], v[208:211]
    ds_read_b64_tr_b16 v[180:181], v4 offset:4096
    ds_read_b64_tr_b16 v[182:183], v4 offset:4608
    v_mfma_f32_16x16x32_bf16 v[212:215], v[168:171], v[68:71], v[212:215]
    ds_read_b64_tr_b16 v[184:185], v5 offset:4096
    ds_read_b64_tr_b16 v[186:187], v5 offset:4608
    s_waitcnt lgkmcnt(8)
    v_mfma_f32_16x16x32_bf16 v[216:219], v[172:175], v[64:67], v[216:219]
    ds_read_b64_tr_b16 v[188:189], v6 offset:4096
    v_mfma_f32_16x16x32_bf16 v[220:223], v[172:175], v[68:71], v[220:223]
    ds_read_b64_tr_b16 v[190:191], v6 offset:4608
    s_waitcnt lgkmcnt(6)
    v_mfma_f32_16x16x32_bf16 v[192:195], v[176:179], v[72:75], v[192:195]
    v_mfma_f32_16x16x32_bf16 v[196:199], v[176:179], v[76:79], v[196:199]
    s_waitcnt lgkmcnt(4)
    v_mfma_f32_16x16x32_bf16 v[200:203], v[180:183], v[72:75], v[200:203]
    v_mfma_f32_16x16x32_bf16 v[204:207], v[180:183], v[76:79], v[204:207]
    s_waitcnt lgkmcnt(2)
    v_mfma_f32_16x16x32_bf16 v[208:211], v[184:187], v[72:75], v[208:211]
    v_mfma_f32_16x16x32_bf16 v[212:215], v[184:187], v[76:79], v[212:215]
    s_waitcnt lgkmcnt(0)
    v_mfma_f32_16x16x32_bf16 v[216:219], v[188:191], v[72:75], v[216:219]
    v_mfma_f32_16x16x32_bf16 v[220:223], v[188:191], v[76:79], v[220:223]
    s_barrier
    ds_read_b64_tr_b16 v[160:161], v3 offset:24576
    ds_read_b64_tr_b16 v[162:163], v3 offset:25088
    ds_read_b128 v[80:83], v1 offset:24576
    ds_read_b128 v[84:87], v1 offset:26624
    ds_read_b64_tr_b16 v[164:165], v4 offset:24576
    ds_read_b64_tr_b16 v[166:167], v4 offset:25088
    s_waitcnt lgkmcnt(2)
    v_mfma_f32_16x16x32_bf16 v[192:195], v[160:163], v[80:83], v[192:195]
    ds_read_b64_tr_b16 v[168:169], v5 offset:24576
    ds_read_b64_tr_b16 v[170:171], v5 offset:25088
    v_mfma_f32_16x16x32_bf16 v[196:199], v[160:163], v[84:87], v[196:199]
    ds_read_b64_tr_b16 v[172:173], v6 offset:24576
    ds_read_b64_tr_b16 v[174:175], v6 offset:25088
    s_waitcnt lgkmcnt(4)
    v_mfma_f32_16x16x32_bf16 v[200:203], v[164:167], v[80:83], v[200:203]
    ds_read_b64_tr_b16 v[176:177], v3 offset:28672
    ds_read_b64_tr_b16 v[178:179], v3 offset:29184
    v_mfma_f32_16x16x32_bf16 v[204:207], v[164:167], v[84:87], v[204:207]
    ds_read_b128 v[88:91], v2 offset:24576
    ds_read_b128 v[92:95], v2 offset:26624
    s_waitcnt lgkmcnt(6)
    v_mfma_f32_16x16x32_bf16 v[208:211], v[168:171], v[80:83], v[208:211]
    ds_read_b64_tr_b16 v[180:181], v4 offset:28672
    ds_read_b64_tr_b16 v[182:183], v4 offset:29184
    v_mfma_f32_16x16x32_bf16 v[212:215], v[168:171], v[84:87], v[212:215]
    ds_read_b64_tr_b16 v[184:185], v5 offset:28672
    ds_read_b64_tr_b16 v[186:187], v5 offset:29184
    s_waitcnt lgkmcnt(8)
    v_mfma_f32_16x16x32_bf16 v[216:219], v[172:175], v[80:83], v[216:219]
    ds_read_b64_tr_b16 v[188:189], v6 offset:28672
    v_mfma_f32_16x16x32_bf16 v[220:223], v[172:175], v[84:87], v[220:223]
    ds_read_b64_tr_b16 v[190:191], v6 offset:29184
    s_waitcnt lgkmcnt(6)
    v_mfma_f32_16x16x32_bf16 v[192:195], v[176:179], v[88:91], v[192:195]
    v_mfma_f32_16x16x32_bf16 v[196:199], v[176:179], v[92:95], v[196:199]
    s_waitcnt lgkmcnt(4)
    v_mfma_f32_16x16x32_bf16 v[200:203], v[180:183], v[88:91], v[200:203]
    v_mfma_f32_16x16x32_bf16 v[204:207], v[180:183], v[92:95], v[204:207]
    s_waitcnt lgkmcnt(2)
    v_mfma_f32_16x16x32_bf16 v[208:211], v[184:187], v[88:91], v[208:211]
    v_mfma_f32_16x16x32_bf16 v[212:215], v[184:187], v[92:95], v[212:215]
    s_waitcnt lgkmcnt(0)
    v_mfma_f32_16x16x32_bf16 v[216:219], v[188:191], v[88:91], v[216:219]
    v_mfma_f32_16x16x32_bf16 v[220:223], v[188:191], v[92:95], v[220:223]
    v_add_u32 v1, 0xc000, v1
    v_add_u32 v2, 0xc000, v2
    v_add_u32 v3, 0xc000, v3
    v_add_u32 v4, 0xc000, v4
    v_add_u32 v5, 0xc000, v5
    v_add_u32 v6, 0xc000, v6
    s_barrier
    ds_read_b64_tr_b16 v[160:161], v3 offset:0
    ds_read_b64_tr_b16 v[162:163], v3 offset:512
    ds_read_b128 v[96:99], v1 offset:0
    ds_read_b128 v[100:103], v1 offset:2048
    ds_read_b64_tr_b16 v[164:165], v4 offset:0
    ds_read_b64_tr_b16 v[166:167], v4 offset:512
    s_waitcnt lgkmcnt(2)
    v_mfma_f32_16x16x32_bf16 v[192:195], v[160:163], v[96:99], v[192:195]
    ds_read_b64_tr_b16 v[168:169], v5 offset:0
    ds_read_b64_tr_b16 v[170:171], v5 offset:512
    v_mfma_f32_16x16x32_bf16 v[196:199], v[160:163], v[100:103], v[196:199]
    ds_read_b64_tr_b16 v[172:173], v6 offset:0
    ds_read_b64_tr_b16 v[174:175], v6 offset:512
    s_waitcnt lgkmcnt(4)
    v_mfma_f32_16x16x32_bf16 v[200:203], v[164:167], v[96:99], v[200:203]
    ds_read_b64_tr_b16 v[176:177], v3 offset:4096
    ds_read_b64_tr_b16 v[178:179], v3 offset:4608
    v_mfma_f32_16x16x32_bf16 v[204:207], v[164:167], v[100:103], v[204:207]
    ds_read_b128 v[104:107], v2 offset:0
    ds_read_b128 v[108:111], v2 offset:2048
    s_waitcnt lgkmcnt(6)
    v_mfma_f32_16x16x32_bf16 v[208:211], v[168:171], v[96:99], v[208:211]
    ds_read_b64_tr_b16 v[180:181], v4 offset:4096
    ds_read_b64_tr_b16 v[182:183], v4 offset:4608
    v_mfma_f32_16x16x32_bf16 v[212:215], v[168:171], v[100:103], v[212:215]
    ds_read_b64_tr_b16 v[184:185], v5 offset:4096
    ds_read_b64_tr_b16 v[186:187], v5 offset:4608
    s_waitcnt lgkmcnt(8)
    v_mfma_f32_16x16x32_bf16 v[216:219], v[172:175], v[96:99], v[216:219]
    ds_read_b64_tr_b16 v[188:189], v6 offset:4096
    v_mfma_f32_16x16x32_bf16 v[220:223], v[172:175], v[100:103], v[220:223]
    ds_read_b64_tr_b16 v[190:191], v6 offset:4608
    s_waitcnt lgkmcnt(6)
    v_mfma_f32_16x16x32_bf16 v[192:195], v[176:179], v[104:107], v[192:195]
    v_mfma_f32_16x16x32_bf16 v[196:199], v[176:179], v[108:111], v[196:199]
    s_waitcnt lgkmcnt(4)
    v_mfma_f32_16x16x32_bf16 v[200:203], v[180:183], v[104:107], v[200:203]
    v_mfma_f32_16x16x32_bf16 v[204:207], v[180:183], v[108:111], v[204:207]
    s_waitcnt lgkmcnt(2)
    v_mfma_f32_16x16x32_bf16 v[208:211], v[184:187], v[104:107], v[208:211]
    v_mfma_f32_16x16x32_bf16 v[212:215], v[184:187], v[108:111], v[212:215]
    s_waitcnt lgkmcnt(0)
    v_mfma_f32_16x16x32_bf16 v[216:219], v[188:191], v[104:107], v[216:219]
    v_mfma_f32_16x16x32_bf16 v[220:223], v[188:191], v[108:111], v[220:223]
    s_barrier
    ds_read_b64_tr_b16 v[160:161], v3 offset:24576
    ds_read_b64_tr_b16 v[162:163], v3 offset:25088
    ds_read_b128 v[112:115], v1 offset:24576
    ds_read_b128 v[116:119], v1 offset:26624
    ds_read_b64_tr_b16 v[164:165], v4 offset:24576
    ds_read_b64_tr_b16 v[166:167], v4 offset:25088
    s_waitcnt lgkmcnt(2)
    v_mfma_f32_16x16x32_bf16 v[192:195], v[160:163], v[112:115], v[192:195]
    ds_read_b64_tr_b16 v[168:169], v5 offset:24576
    ds_read_b64_tr_b16 v[170:171], v5 offset:25088
    v_mfma_f32_16x16x32_bf16 v[196:199], v[160:163], v[116:119], v[196:199]
    ds_read_b64_tr_b16 v[172:173], v6 offset:24576
    ds_read_b64_tr_b16 v[174:175], v6 offset:25088
    s_waitcnt lgkmcnt(4)
    v_mfma_f32_16x16x32_bf16 v[200:203], v[164:167], v[112:115], v[200:203]
    ds_read_b64_tr_b16 v[176:177], v3 offset:28672
    ds_read_b64_tr_b16 v[178:179], v3 offset:29184
    v_mfma_f32_16x16x32_bf16 v[204:207], v[164:167], v[116:119], v[204:207]
    ds_read_b128 v[120:123], v2 offset:24576
    ds_read_b128 v[124:127], v2 offset:26624
    s_waitcnt lgkmcnt(6)
    v_mfma_f32_16x16x32_bf16 v[208:211], v[168:171], v[112:115], v[208:211]
    ds_read_b64_tr_b16 v[180:181], v4 offset:28672
    ds_read_b64_tr_b16 v[182:183], v4 offset:29184
    v_mfma_f32_16x16x32_bf16 v[212:215], v[168:171], v[116:119], v[212:215]
    ds_read_b64_tr_b16 v[184:185], v5 offset:28672
    ds_read_b64_tr_b16 v[186:187], v5 offset:29184
    s_waitcnt lgkmcnt(8)
    v_mfma_f32_16x16x32_bf16 v[216:219], v[172:175], v[112:115], v[216:219]
    ds_read_b64_tr_b16 v[188:189], v6 offset:28672
    v_mfma_f32_16x16x32_bf16 v[220:223], v[172:175], v[116:119], v[220:223]
    ds_read_b64_tr_b16 v[190:191], v6 offset:29184
    s_waitcnt lgkmcnt(6)
    v_mfma_f32_16x16x32_bf16 v[192:195], v[176:179], v[120:123], v[192:195]
    v_mfma_f32_16x16x32_bf16 v[196:199], v[176:179], v[124:127], v[196:199]
    s_waitcnt lgkmcnt(4)
    v_mfma_f32_16x16x32_bf16 v[200:203], v[180:183], v[120:123], v[200:203]
    v_mfma_f32_16x16x32_bf16 v[204:207], v[180:183], v[124:127], v[204:207]
    s_waitcnt lgkmcnt(2)
    v_mfma_f32_16x16x32_bf16 v[208:211], v[184:187], v[120:123], v[208:211]
    v_mfma_f32_16x16x32_bf16 v[212:215], v[184:187], v[124:127], v[212:215]
    s_waitcnt lgkmcnt(0)
    v_mfma_f32_16x16x32_bf16 v[216:219], v[188:191], v[120:123], v[216:219]
    v_mfma_f32_16x16x32_bf16 v[220:223], v[188:191], v[124:127], v[220:223]
    v_add_u32 v1, 0xc000, v1
    v_add_u32 v2, 0xc000, v2
    v_add_u32 v3, 0xc000, v3
    v_add_u32 v4, 0xc000, v4
    v_add_u32 v5, 0xc000, v5
    v_add_u32 v6, 0xc000, v6
    s_barrier
    ds_read_b64_tr_b16 v[160:161], v3 offset:0
    ds_read_b64_tr_b16 v[162:163], v3 offset:512
    ds_read_b128 v[128:131], v1 offset:0
    ds_read_b128 v[132:135], v1 offset:2048
    ds_read_b64_tr_b16 v[164:165], v4 offset:0
    ds_read_b64_tr_b16 v[166:167], v4 offset:512
    s_waitcnt lgkmcnt(2)
    v_mfma_f32_16x16x32_bf16 v[192:195], v[160:163], v[128:131], v[192:195]
    ds_read_b64_tr_b16 v[168:169], v5 offset:0
    ds_read_b64_tr_b16 v[170:171], v5 offset:512
    v_mfma_f32_16x16x32_bf16 v[196:199], v[160:163], v[132:135], v[196:199]
    ds_read_b64_tr_b16 v[172:173], v6 offset:0
    ds_read_b64_tr_b16 v[174:175], v6 offset:512
    s_waitcnt lgkmcnt(4)
    v_mfma_f32_16x16x32_bf16 v[200:203], v[164:167], v[128:131], v[200:203]
    ds_read_b64_tr_b16 v[176:177], v3 offset:4096
    ds_read_b64_tr_b16 v[178:179], v3 offset:4608
    v_mfma_f32_16x16x32_bf16 v[204:207], v[164:167], v[132:135], v[204:207]
    ds_read_b128 v[136:139], v2 offset:0
    ds_read_b128 v[140:143], v2 offset:2048
    s_waitcnt lgkmcnt(6)
    v_mfma_f32_16x16x32_bf16 v[208:211], v[168:171], v[128:131], v[208:211]
    ds_read_b64_tr_b16 v[180:181], v4 offset:4096
    ds_read_b64_tr_b16 v[182:183], v4 offset:4608
    v_mfma_f32_16x16x32_bf16 v[212:215], v[168:171], v[132:135], v[212:215]
    ds_read_b64_tr_b16 v[184:185], v5 offset:4096
    ds_read_b64_tr_b16 v[186:187], v5 offset:4608
    s_waitcnt lgkmcnt(8)
    v_mfma_f32_16x16x32_bf16 v[216:219], v[172:175], v[128:131], v[216:219]
    ds_read_b64_tr_b16 v[188:189], v6 offset:4096
    v_mfma_f32_16x16x32_bf16 v[220:223], v[172:175], v[132:135], v[220:223]
    ds_read_b64_tr_b16 v[190:191], v6 offset:4608
    s_waitcnt lgkmcnt(6)
    v_mfma_f32_16x16x32_bf16 v[192:195], v[176:179], v[136:139], v[192:195]
    v_mfma_f32_16x16x32_bf16 v[196:199], v[176:179], v[140:143], v[196:199]
    s_waitcnt lgkmcnt(4)
    v_mfma_f32_16x16x32_bf16 v[200:203], v[180:183], v[136:139], v[200:203]
    v_mfma_f32_16x16x32_bf16 v[204:207], v[180:183], v[140:143], v[204:207]
    s_waitcnt lgkmcnt(2)
    v_mfma_f32_16x16x32_bf16 v[208:211], v[184:187], v[136:139], v[208:211]
    v_mfma_f32_16x16x32_bf16 v[212:215], v[184:187], v[140:143], v[212:215]
    s_waitcnt lgkmcnt(0)
    v_mfma_f32_16x16x32_bf16 v[216:219], v[188:191], v[136:139], v[216:219]
    v_mfma_f32_16x16x32_bf16 v[220:223], v[188:191], v[140:143], v[220:223]
    s_barrier
    ds_read_b64_tr_b16 v[160:161], v3 offset:24576
    ds_read_b64_tr_b16 v[162:163], v3 offset:25088
    ds_read_b128 v[144:147], v1 offset:24576
    ds_read_b128 v[148:151], v1 offset:26624
    ds_read_b64_tr_b16 v[164:165], v4 offset:24576
    ds_read_b64_tr_b16 v[166:167], v4 offset:25088
    s_waitcnt lgkmcnt(2)
    v_mfma_f32_16x16x32_bf16 v[192:195], v[160:163], v[144:147], v[192:195]
    ds_read_b64_tr_b16 v[168:169], v5 offset:24576
    ds_read_b64_tr_b16 v[170:171], v5 offset:25088
    v_mfma_f32_16x16x32_bf16 v[196:199], v[160:163], v[148:151], v[196:199]
    ds_read_b64_tr_b16 v[172:173], v6 offset:24576
    ds_read_b64_tr_b16 v[174:175], v6 offset:25088
    s_waitcnt lgkmcnt(4)
    v_mfma_f32_16x16x32_bf16 v[200:203], v[164:167], v[144:147], v[200:203]
    ds_read_b64_tr_b16 v[176:177], v3 offset:28672
    ds_read_b64_tr_b16 v[178:179], v3 offset:29184
    v_mfma_f32_16x16x32_bf16 v[204:207], v[164:167], v[148:151], v[204:207]
    ds_read_b128 v[152:155], v2 offset:24576
    ds_read_b128 v[156:159], v2 offset:26624
    s_waitcnt lgkmcnt(6)
    v_mfma_f32_16x16x32_bf16 v[208:211], v[168:171], v[144:147], v[208:211]
    ds_read_b64_tr_b16 v[180:181], v4 offset:28672
    ds_read_b64_tr_b16 v[182:183], v4 offset:29184
    v_mfma_f32_16x16x32_bf16 v[212:215], v[168:171], v[148:151], v[212:215]
    ds_read_b64_tr_b16 v[184:185], v5 offset:28672
    ds_read_b64_tr_b16 v[186:187], v5 offset:29184
    s_waitcnt lgkmcnt(8)
    v_mfma_f32_16x16x32_bf16 v[216:219], v[172:175], v[144:147], v[216:219]
    ds_read_b64_tr_b16 v[188:189], v6 offset:28672
    v_mfma_f32_16x16x32_bf16 v[220:223], v[172:175], v[148:151], v[220:223]
    ds_read_b64_tr_b16 v[190:191], v6 offset:29184
    s_waitcnt lgkmcnt(6)
    v_mfma_f32_16x16x32_bf16 v[192:195], v[176:179], v[152:155], v[192:195]
    v_mfma_f32_16x16x32_bf16 v[196:199], v[176:179], v[156:159], v[196:199]
    s_waitcnt lgkmcnt(4)
    v_mfma_f32_16x16x32_bf16 v[200:203], v[180:183], v[152:155], v[200:203]
    v_mfma_f32_16x16x32_bf16 v[204:207], v[180:183], v[156:159], v[204:207]
    s_waitcnt lgkmcnt(2)
    v_mfma_f32_16x16x32_bf16 v[208:211], v[184:187], v[152:155], v[208:211]
    v_mfma_f32_16x16x32_bf16 v[212:215], v[184:187], v[156:159], v[212:215]
    s_waitcnt lgkmcnt(0)
    v_mfma_f32_16x16x32_bf16 v[216:219], v[188:191], v[152:155], v[216:219]
    v_mfma_f32_16x16x32_bf16 v[220:223], v[188:191], v[156:159], v[220:223]
    v_mov_b32 v160, s32
    s_nop 0
    v_pk_mul_f32 v[192:193], v[192:193], v[160:161] op_sel_hi:[1,0]
    v_pk_mul_f32 v[194:195], v[194:195], v[160:161] op_sel_hi:[1,0]
    v_pk_mul_f32 v[196:197], v[196:197], v[160:161] op_sel_hi:[1,0]
    v_pk_mul_f32 v[198:199], v[198:199], v[160:161] op_sel_hi:[1,0]
    v_cvt_pk_bf16_f32 v192, v192, v193
    v_cvt_pk_bf16_f32 v193, v194, v195
    v_cvt_pk_bf16_f32 v194, v196, v197
    v_cvt_pk_bf16_f32 v195, v198, v199
    buffer_store_dwordx4 v[192:195], v7, s[16:19], s50 offen offset:0 sc1
    v_pk_mul_f32 v[200:201], v[200:201], v[160:161] op_sel_hi:[1,0]
    v_pk_mul_f32 v[202:203], v[202:203], v[160:161] op_sel_hi:[1,0]
    v_pk_mul_f32 v[204:205], v[204:205], v[160:161] op_sel_hi:[1,0]
    v_pk_mul_f32 v[206:207], v[206:207], v[160:161] op_sel_hi:[1,0]
    v_cvt_pk_bf16_f32 v200, v200, v201
    v_cvt_pk_bf16_f32 v201, v202, v203
    v_cvt_pk_bf16_f32 v202, v204, v205
    v_cvt_pk_bf16_f32 v203, v206, v207
    buffer_store_dwordx4 v[200:203], v7, s[16:19], s50 offen offset:2048 sc1
    v_pk_mul_f32 v[208:209], v[208:209], v[160:161] op_sel_hi:[1,0]
    v_pk_mul_f32 v[210:211], v[210:211], v[160:161] op_sel_hi:[1,0]
    v_pk_mul_f32 v[212:213], v[212:213], v[160:161] op_sel_hi:[1,0]
    v_pk_mul_f32 v[214:215], v[214:215], v[160:161] op_sel_hi:[1,0]
    v_cvt_pk_bf16_f32 v208, v208, v209
    v_cvt_pk_bf16_f32 v209, v210, v211
    v_cvt_pk_bf16_f32 v210, v212, v213
    v_cvt_pk_bf16_f32 v211, v214, v215
    buffer_store_dwordx4 v[208:211], v8, s[16:19], s50 offen offset:0 sc1
    v_pk_mul_f32 v[216:217], v[216:217], v[160:161] op_sel_hi:[1,0]
    v_pk_mul_f32 v[218:219], v[218:219], v[160:161] op_sel_hi:[1,0]
    v_pk_mul_f32 v[220:221], v[220:221], v[160:161] op_sel_hi:[1,0]
    v_pk_mul_f32 v[222:223], v[222:223], v[160:161] op_sel_hi:[1,0]
    v_cvt_pk_bf16_f32 v216, v216, v217
    v_cvt_pk_bf16_f32 v217, v218, v219
    v_cvt_pk_bf16_f32 v218, v220, v221
    v_cvt_pk_bf16_f32 v219, v222, v223
    buffer_store_dwordx4 v[216:219], v8, s[16:19], s50 offen offset:2048 sc1
    v_add_u32 v3, 0xfffe4000, v3
    v_add_u32 v4, 0xfffe4000, v4
    v_add_u32 v5, 0xfffe4000, v5
    v_add_u32 v6, 0xfffe4000, v6
    s_cmp_ge_u32 s3, 27
    s_cbranch_scc1 A_single
    s_barrier
    s_setprio 2
    ds_read_b64_tr_b16 v[160:161], v3 offset:0
    ds_read_b64_tr_b16 v[162:163], v3 offset:512
    ds_read_b64_tr_b16 v[164:165], v4 offset:0
    ds_read_b64_tr_b16 v[166:167], v4 offset:512
    ds_read_b64_tr_b16 v[168:169], v5 offset:0
    ds_read_b64_tr_b16 v[170:171], v5 offset:512
    ds_read_b64_tr_b16 v[172:173], v6 offset:0
    ds_read_b64_tr_b16 v[174:175], v6 offset:512
    s_waitcnt lgkmcnt(4)
    v_mfma_f32_16x16x32_bf16 v[224:227], v[160:163], v[16:19], 0
    ds_read_b64_tr_b16 v[176:177], v3 offset:4096
    v_mfma_f32_16x16x32_bf16 v[228:231], v[160:163], v[20:23], 0
    ds_read_b64_tr_b16 v[178:179], v3 offset:4608
    v_mfma_f32_16x16x32_bf16 v[232:235], v[164:167], v[16:19], 0
    ds_read_b64_tr_b16 v[180:181], v4 offset:4096
    v_mfma_f32_16x16x32_bf16 v[236:239], v[164:167], v[20:23], 0
    ds_read_b64_tr_b16 v[182:183], v4 offset:4608
    s_waitcnt lgkmcnt(4)
    v_mfma_f32_16x16x32_bf16 v[240:243], v[168:171], v[16:19], 0
    ds_read_b64_tr_b16 v[184:185], v5 offset:4096
    v_mfma_f32_16x16x32_bf16 v[244:247], v[168:171], v[20:23], 0
    ds_read_b64_tr_b16 v[186:187], v5 offset:4608
    v_mfma_f32_16x16x32_bf16 v[248:251], v[172:175], v[16:19], 0
    ds_read_b64_tr_b16 v[188:189], v6 offset:4096
    v_mfma_f32_16x16x32_bf16 v[252:255], v[172:175], v[20:23], 0
    ds_read_b64_tr_b16 v[190:191], v6 offset:4608
    s_waitcnt lgkmcnt(4)
    v_mfma_f32_16x16x32_bf16 v[224:227], v[176:179], v[24:27], v[224:227]
    ds_read_b64_tr_b16 v[160:161], v3 offset:8192
    v_mfma_f32_16x16x32_bf16 v[228:231], v[176:179], v[28:31], v[228:231]
    ds_read_b64_tr_b16 v[162:163], v3 offset:8704
    v_mfma_f32_16x16x32_bf16 v[232:235], v[180:183], v[24:27], v[232:235]
    ds_read_b64_tr_b16 v[164:165], v4 offset:8192
    v_mfma_f32_16x16x32_bf16 v[236:239], v[180:183], v[28:31], v[236:239]
    ds_read_b64_tr_b16 v[166:167], v4 offset:8704
    s_waitcnt lgkmcnt(4)
    v_mfma_f32_16x16x32_bf16 v[240:243], v[184:187], v[24:27], v[240:243]
    ds_read_b64_tr_b16 v[168:169], v5 offset:8192
    v_mfma_f32_16x16x32_bf16 v[244:247], v[184:187], v[28:31], v[244:247]
    ds_read_b64_tr_b16 v[170:171], v5 offset:8704
    v_mfma_f32_16x16x32_bf16 v[248:251], v[188:191], v[24:27], v[248:251]
    ds_read_b64_tr_b16 v[172:173], v6 offset:8192
    v_mfma_f32_16x16x32_bf16 v[252:255], v[188:191], v[28:31], v[252:255]
    ds_read_b64_tr_b16 v[174:175], v6 offset:8704
    s_waitcnt lgkmcnt(4)
    v_mfma_f32_16x16x32_bf16 v[224:227], v[160:163], v[32:35], v[224:227]
    ds_read_b64_tr_b16 v[176:177], v3 offset:12288
    v_mfma_f32_16x16x32_bf16 v[228:231], v[160:163], v[36:39], v[228:231]
    ds_read_b64_tr_b16 v[178:179], v3 offset:12800
    v_mfma_f32_16x16x32_bf16 v[232:235], v[164:167], v[32:35], v[232:235]
    ds_read_b64_tr_b16 v[180:181], v4 offset:12288
    v_mfma_f32_16x16x32_bf16 v[236:239], v[164:167], v[36:39], v[236:239]
    ds_read_b64_tr_b16 v[182:183], v4 offset:12800
    s_waitcnt lgkmcnt(4)
    v_mfma_f32_16x16x32_bf16 v[240:243], v[168:171], v[32:35], v[240:243]
    ds_read_b64_tr_b16 v[184:185], v5 offset:12288
    v_mfma_f32_16x16x32_bf16 v[244:247], v[168:171], v[36:39], v[244:247]
    ds_read_b64_tr_b16 v[186:187], v5 offset:12800
    v_mfma_f32_16x16x32_bf16 v[248:251], v[172:175], v[32:35], v[248:251]
    ds_read_b64_tr_b16 v[188:189], v6 offset:12288
    v_mfma_f32_16x16x32_bf16 v[252:255], v[172:175], v[36:39], v[252:255]
    ds_read_b64_tr_b16 v[190:191], v6 offset:12800
    s_waitcnt lgkmcnt(4)
    v_mfma_f32_16x16x32_bf16 v[224:227], v[176:179], v[40:43], v[224:227]
    ds_read_b64_tr_b16 v[160:161], v3 offset:16384
    v_mfma_f32_16x16x32_bf16 v[228:231], v[176:179], v[44:47], v[228:231]
    ds_read_b64_tr_b16 v[162:163], v3 offset:16896
    v_mfma_f32_16x16x32_bf16 v[232:235], v[180:183], v[40:43], v[232:235]
    ds_read_b64_tr_b16 v[164:165], v4 offset:16384
    v_mfma_f32_16x16x32_bf16 v[236:239], v[180:183], v[44:47], v[236:239]
    ds_read_b64_tr_b16 v[166:167], v4 offset:16896
    s_waitcnt lgkmcnt(4)
    v_mfma_f32_16x16x32_bf16 v[240:243], v[184:187], v[40:43], v[240:243]
    ds_read_b64_tr_b16 v[168:169], v5 offset:16384
    v_mfma_f32_16x16x32_bf16 v[244:247], v[184:187], v[44:47], v[244:247]
    ds_read_b64_tr_b16 v[170:171], v5 offset:16896
    v_mfma_f32_16x16x32_bf16 v[248:251], v[188:191], v[40:43], v[248:251]
    ds_read_b64_tr_b16 v[172:173], v6 offset:16384
    v_mfma_f32_16x16x32_bf16 v[252:255], v[188:191], v[44:47], v[252:255]
    ds_read_b64_tr_b16 v[174:175], v6 offset:16896
    s_waitcnt lgkmcnt(4)
    v_mfma_f32_16x16x32_bf16 v[224:227], v[160:163], v[48:51], v[224:227]
    ds_read_b64_tr_b16 v[176:177], v3 offset:20480
    v_mfma_f32_16x16x32_bf16 v[228:231], v[160:163], v[52:55], v[228:231]
    ds_read_b64_tr_b16 v[178:179], v3 offset:20992
    v_mfma_f32_16x16x32_bf16 v[232:235], v[164:167], v[48:51], v[232:235]
    ds_read_b64_tr_b16 v[180:181], v4 offset:20480
    v_mfma_f32_16x16x32_bf16 v[236:239], v[164:167], v[52:55], v[236:239]
    ds_read_b64_tr_b16 v[182:183], v4 offset:20992
    s_waitcnt lgkmcnt(4)
    v_mfma_f32_16x16x32_bf16 v[240:243], v[168:171], v[48:51], v[240:243]
    ds_read_b64_tr_b16 v[184:185], v5 offset:20480
    v_mfma_f32_16x16x32_bf16 v[244:247], v[168:171], v[52:55], v[244:247]
    ds_read_b64_tr_b16 v[186:187], v5 offset:20992
    v_mfma_f32_16x16x32_bf16 v[248:251], v[172:175], v[48:51], v[248:251]
    ds_read_b64_tr_b16 v[188:189], v6 offset:20480
    v_mfma_f32_16x16x32_bf16 v[252:255], v[172:175], v[52:55], v[252:255]
    ds_read_b64_tr_b16 v[190:191], v6 offset:20992
    s_barrier
    s_waitcnt vmcnt(0)
    buffer_atomic_add v9, v10, s[16:19], 0 offen sc1
    s_waitcnt lgkmcnt(4)
    v_mfma_f32_16x16x32_bf16 v[224:227], v[176:179], v[56:59], v[224:227]
    ds_read_b64_tr_b16 v[160:161], v3 offset:24576
    v_mfma_f32_16x16x32_bf16 v[228:231], v[176:179], v[60:63], v[228:231]
    ds_read_b64_tr_b16 v[162:163], v3 offset:25088
    v_mfma_f32_16x16x32_bf16 v[232:235], v[180:183], v[56:59], v[232:235]
    ds_read_b64_tr_b16 v[164:165], v4 offset:24576
    v_mfma_f32_16x16x32_bf16 v[236:239], v[180:183], v[60:63], v[236:239]
I_p0_1:
    s_cbranch_execz I_p0_r
    ds_read_b64_tr_b16 v[166:167], v4 offset:25088
    s_waitcnt lgkmcnt(4)
    v_mfma_f32_16x16x32_bf16 v[240:243], v[184:187], v[56:59], v[240:243]
    ds_read_b64_tr_b16 v[168:169], v5 offset:24576
    v_mfma_f32_16x16x32_bf16 v[244:247], v[184:187], v[60:63], v[244:247]
    ds_read_b64_tr_b16 v[170:171], v5 offset:25088
    v_mfma_f32_16x16x32_bf16 v[248:251], v[188:191], v[56:59], v[248:251]
    ds_read_b64_tr_b16 v[172:173], v6 offset:24576
    v_mfma_f32_16x16x32_bf16 v[252:255], v[188:191], v[60:63], v[252:255]
    ds_read_b64_tr_b16 v[174:175], v6 offset:25088
    s_waitcnt lgkmcnt(4)
    v_mfma_f32_16x16x32_bf16 v[224:227], v[160:163], v[64:67], v[224:227]
    ds_read_b64_tr_b16 v[176:177], v3 offset:28672
    v_mfma_f32_16x16x32_bf16 v[228:231], v[160:163], v[68:71], v[228:231]
    ds_read_b64_tr_b16 v[178:179], v3 offset:29184
    v_mfma_f32_16x16x32_bf16 v[232:235], v[164:167], v[64:67], v[232:235]
    ds_read_b64_tr_b16 v[180:181], v4 offset:28672
    v_mfma_f32_16x16x32_bf16 v[236:239], v[164:167], v[68:71], v[236:239]
    ds_read_b64_tr_b16 v[182:183], v4 offset:29184
    s_waitcnt lgkmcnt(4)
    v_mfma_f32_16x16x32_bf16 v[240:243], v[168:171], v[64:67], v[240:243]
    ds_read_b64_tr_b16 v[184:185], v5 offset:28672
    v_mfma_f32_16x16x32_bf16 v[244:247], v[168:171], v[68:71], v[244:247]
    ds_read_b64_tr_b16 v[186:187], v5 offset:29184
    v_mfma_f32_16x16x32_bf16 v[248:251], v[172:175], v[64:67], v[248:251]
    ds_read_b64_tr_b16 v[188:189], v6 offset:28672
    v_mfma_f32_16x16x32_bf16 v[252:255], v[172:175], v[68:71], v[252:255]
    ds_read_b64_tr_b16 v[190:191], v6 offset:29184
    s_waitcnt lgkmcnt(4)
    v_mfma_f32_16x16x32_bf16 v[224:227], v[176:179], v[72:75], v[224:227]
    ds_read_b64_tr_b16 v[160:161], v3 offset:32768
    v_mfma_f32_16x16x32_bf16 v[228:231], v[176:179], v[76:79], v[228:231]
    ds_read_b64_tr_b16 v[162:163], v3 offset:33280
    v_mfma_f32_16x16x32_bf16 v[232:235], v[180:183], v[72:75], v[232:235]
    ds_read_b64_tr_b16 v[164:165], v4 offset:32768
    v_mfma_f32_16x16x32_bf16 v[236:239], v[180:183], v[76:79], v[236:239]
    ds_read_b64_tr_b16 v[166:167], v4 offset:33280
    s_waitcnt lgkmcnt(4)
    v_mfma_f32_16x16x32_bf16 v[240:243], v[184:187], v[72:75], v[240:243]
    ds_read_b64_tr_b16 v[168:169], v5 offset:32768
    v_mfma_f32_16x16x32_bf16 v[244:247], v[184:187], v[76:79], v[244:247]
    ds_read_b64_tr_b16 v[170:171], v5 offset:33280
    v_mfma_f32_16x16x32_bf16 v[248:251], v[188:191], v[72:75], v[248:251]
    ds_read_b64_tr_b16 v[172:173], v6 offset:32768
    v_mfma_f32_16x16x32_bf16 v[252:255], v[188:191], v[76:79], v[252:255]
    ds_read_b64_tr_b16 v[174:175], v6 offset:33280
    s_waitcnt lgkmcnt(4)
    v_mfma_f32_16x16x32_bf16 v[224:227], v[160:163], v[80:83], v[224:227]
    ds_read_b64_tr_b16 v[176:177], v3 offset:36864
    v_mfma_f32_16x16x32_bf16 v[228:231], v[160:163], v[84:87], v[228:231]
    ds_read_b64_tr_b16 v[178:179], v3 offset:37376
    v_mfma_f32_16x16x32_bf16 v[232:235], v[164:167], v[80:83], v[232:235]
    ds_read_b64_tr_b16 v[180:181], v4 offset:36864
    v_mfma_f32_16x16x32_bf16 v[236:239], v[164:167], v[84:87], v[236:239]
    ds_read_b64_tr_b16 v[182:183], v4 offset:37376
    s_waitcnt lgkmcnt(4)
    v_mfma_f32_16x16x32_bf16 v[240:243], v[168:171], v[80:83], v[240:243]
    ds_read_b64_tr_b16 v[184:185], v5 offset:36864
    v_mfma_f32_16x16x32_bf16 v[244:247], v[168:171], v[84:87], v[244:247]
    ds_read_b64_tr_b16 v[186:187], v5 offset:37376
    v_mfma_f32_16x16x32_bf16 v[248:251], v[172:175], v[80:83], v[248:251]
    ds_read_b64_tr_b16 v[188:189], v6 offset:36864
    v_mfma_f32_16x16x32_bf16 v[252:255], v[172:175], v[84:87], v[252:255]
    ds_read_b64_tr_b16 v[190:191], v6 offset:37376
    s_waitcnt lgkmcnt(4)
    v_mfma_f32_16x16x32_bf16 v[224:227], v[176:179], v[88:91], v[224:227]
    ds_read_b64_tr_b16 v[160:161], v3 offset:40960
    v_mfma_f32_16x16x32_bf16 v[228:231], v[176:179], v[92:95], v[228:231]
    ds_read_b64_tr_b16 v[162:163], v3 offset:41472
    v_mfma_f32_16x16x32_bf16 v[232:235], v[180:183], v[88:91], v[232:235]
    ds_read_b64_tr_b16 v[164:165], v4 offset:40960
    v_mfma_f32_16x16x32_bf16 v[236:239], v[180:183], v[92:95], v[236:239]
    ds_read_b64_tr_b16 v[166:167], v4 offset:41472
    s_waitcnt lgkmcnt(4)
    v_mfma_f32_16x16x32_bf16 v[240:243], v[184:187], v[88:91], v[240:243]
    ds_read_b64_tr_b16 v[168:169], v5 offset:40960
    v_mfma_f32_16x16x32_bf16 v[244:247], v[184:187], v[92:95], v[244:247]
    ds_read_b64_tr_b16 v[170:171], v5 offset:41472
    v_mfma_f32_16x16x32_bf16 v[248:251], v[188:191], v[88:91], v[248:251]
    ds_read_b64_tr_b16 v[172:173], v6 offset:40960
    v_mfma_f32_16x16x32_bf16 v[252:255], v[188:191], v[92:95], v[252:255]
    ds_read_b64_tr_b16 v[174:175], v6 offset:41472
    s_waitcnt lgkmcnt(4)
    v_mfma_f32_16x16x32_bf16 v[224:227], v[160:163], v[96:99], v[224:227]
    ds_read_b64_tr_b16 v[176:177], v3 offset:45056
    v_mfma_f32_16x16x32_bf16 v[228:231], v[160:163], v[100:103], v[228:231]
    ds_read_b64_tr_b16 v[178:179], v3 offset:45568
    v_mfma_f32_16x16x32_bf16 v[232:235], v[164:167], v[96:99], v[232:235]
    ds_read_b64_tr_b16 v[180:181], v4 offset:45056
    v_mfma_f32_16x16x32_bf16 v[236:239], v[164:167], v[100:103], v[236:239]
    ds_read_b64_tr_b16 v[182:183], v4 offset:45568
    s_waitcnt lgkmcnt(4)
    v_mfma_f32_16x16x32_bf16 v[240:243], v[168:171], v[96:99], v[240:243]
    ds_read_b64_tr_b16 v[184:185], v5 offset:45056
    v_mfma_f32_16x16x32_bf16 v[244:247], v[168:171], v[100:103], v[244:247]
    ds_read_b64_tr_b16 v[186:187], v5 offset:45568
    v_mfma_f32_16x16x32_bf16 v[248:251], v[172:175], v[96:99], v[248:251]
    ds_read_b64_tr_b16 v[188:189], v6 offset:45056
    v_mfma_f32_16x16x32_bf16 v[252:255], v[172:175], v[100:103], v[252:255]
    ds_read_b64_tr_b16 v[190:191], v6 offset:45568
    s_waitcnt lgkmcnt(4)
    v_mfma_f32_16x16x32_bf16 v[224:227], v[176:179], v[104:107], v[224:227]
    ds_read_b64_tr_b16 v[160:161], v3 offset:49152
    v_mfma_f32_16x16x32_bf16 v[228:231], v[176:179], v[108:111], v[228:231]
    ds_read_b64_tr_b16 v[162:163], v3 offset:49664
    v_mfma_f32_16x16x32_bf16 v[232:235], v[180:183], v[104:107], v[232:235]
    ds_read_b64_tr_b16 v[164:165], v4 offset:49152
    v_mfma_f32_16x16x32_bf16 v[236:239], v[180:183], v[108:111], v[236:239]
    ds_read_b64_tr_b16 v[166:167], v4 offset:49664
    s_waitcnt lgkmcnt(4)
    v_mfma_f32_16x16x32_bf16 v[240:243], v[184:187], v[104:107], v[240:243]
    ds_read_b64_tr_b16 v[168:169], v5 offset:49152
    v_mfma_f32_16x16x32_bf16 v[244:247], v[184:187], v[108:111], v[244:247]
    ds_read_b64_tr_b16 v[170:171], v5 offset:49664
    v_mfma_f32_16x16x32_bf16 v[248:251], v[188:191], v[104:107], v[248:251]
    ds_read_b64_tr_b16 v[172:173], v6 offset:49152
    v_mfma_f32_16x16x32_bf16 v[252:255], v[188:191], v[108:111], v[252:255]
    ds_read_b64_tr_b16 v[174:175], v6 offset:49664
    s_waitcnt lgkmcnt(4)
    v_mfma_f32_16x16x32_bf16 v[224:227], v[160:163], v[112:115], v[224:227]
    ds_read_b64_tr_b16 v[176:177], v3 offset:53248
    v_mfma_f32_16x16x32_bf16 v[228:231], v[160:163], v[116:119], v[228:231]
    ds_read_b64_tr_b16 v[178:179], v3 offset:53760
    v_mfma_f32_16x16x32_bf16 v[232:235], v[164:167], v[112:115], v[232:235]
    ds_read_b64_tr_b16 v[180:181], v4 offset:53248
    v_mfma_f32_16x16x32_bf16 v[236:239], v[164:167], v[116:119], v[236:239]
    ds_read_b64_tr_b16 v[182:183], v4 offset:53760
    s_waitcnt lgkmcnt(4)
    v_mfma_f32_16x16x32_bf16 v[240:243], v[168:171], v[112:115], v[240:243]
    ds_read_b64_tr_b16 v[184:185], v5 offset:53248
    v_mfma_f32_16x16x32_bf16 v[244:247], v[168:171], v[116:119], v[244:247]
    ds_read_b64_tr_b16 v[186:187], v5 offset:53760
    v_mfma_f32_16x16x32_bf16 v[248:251], v[172:175], v[112:115], v[248:251]
    ds_read_b64_tr_b16 v[188:189], v6 offset:53248
    v_mfma_f32_16x16x32_bf16 v[252:255], v[172:175], v[116:119], v[252:255]
    ds_read_b64_tr_b16 v[190:191], v6 offset:53760
    s_waitcnt lgkmcnt(4)
    v_mfma_f32_16x16x32_bf16 v[224:227], v[176:179], v[120:123], v[224:227]
    ds_read_b64_tr_b16 v[160:161], v3 offset:57344
    v_mfma_f32_16x16x32_bf16 v[228:231], v[176:179], v[124:127], v[228:231]
    ds_read_b64_tr_b16 v[162:163], v3 offset:57856
    v_mfma_f32_16x16x32_bf16 v[232:235], v[180:183], v[120:123], v[232:235]
    ds_read_b64_tr_b16 v[164:165], v4 offset:57344
    v_mfma_f32_16x16x32_bf16 v[236:239], v[180:183], v[124:127], v[236:239]
    ds_read_b64_tr_b16 v[166:167], v4 offset:57856
    s_waitcnt lgkmcnt(4)
    v_mfma_f32_16x16x32_bf16 v[240:243], v[184:187], v[120:123], v[240:243]
    ds_read_b64_tr_b16 v[168:169], v5 offset:57344
    v_mfma_f32_16x16x32_bf16 v[244:247], v[184:187], v[124:127], v[244:247]
    ds_read_b64_tr_b16 v[170:171], v5 offset:57856
    v_mfma_f32_16x16x32_bf16 v[248:251], v[188:191], v[120:123], v[248:251]
    ds_read_b64_tr_b16 v[172:173], v6 offset:57344
    v_mfma_f32_16x16x32_bf16 v[252:255], v[188:191], v[124:127], v[252:255]
    ds_read_b64_tr_b16 v[174:175], v6 offset:57856
    v_add_u32 v3, 0xf000, v3
    v_add_u32 v4, 0xf000, v4
    v_add_u32 v5, 0xf000, v5
    v_add_u32 v6, 0xf000, v6
    s_waitcnt lgkmcnt(4)
    v_mfma_f32_16x16x32_bf16 v[224:227], v[160:163], v[128:131], v[224:227]
    ds_read_b64_tr_b16 v[176:177], v3 offset:0
    v_mfma_f32_16x16x32_bf16 v[228:231], v[160:163], v[132:135], v[228:231]
    ds_read_b64_tr_b16 v[178:179], v3 offset:512
    v_mfma_f32_16x16x32_bf16 v[232:235], v[164:167], v[128:131], v[232:235]
    ds_read_b64_tr_b16 v[180:181], v4 offset:0
    v_mfma_f32_16x16x32_bf16 v[236:239], v[164:167], v[132:135], v[236:239]
    ds_read_b64_tr_b16 v[182:183], v4 offset:512
    s_waitcnt lgkmcnt(4)
    v_mfma_f32_16x16x32_bf16 v[240:243], v[168:171], v[128:131], v[240:243]
    ds_read_b64_tr_b16 v[184:185], v5 offset:0
    v_mfma_f32_16x16x32_bf16 v[244:247], v[168:171], v[132:135], v[244:247]
    ds_read_b64_tr_b16 v[186:187], v5 offset:512
    v_mfma_f32_16x16x32_bf16 v[248:251], v[172:175], v[128:131], v[248:251]
    ds_read_b64_tr_b16 v[188:189], v6 offset:0
    v_mfma_f32_16x16x32_bf16 v[252:255], v[172:175], v[132:135], v[252:255]
    ds_read_b64_tr_b16 v[190:191], v6 offset:512
    s_waitcnt lgkmcnt(4)
    v_mfma_f32_16x16x32_bf16 v[224:227], v[176:179], v[136:139], v[224:227]
    ds_read_b64_tr_b16 v[160:161], v3 offset:4096
    v_mfma_f32_16x16x32_bf16 v[228:231], v[176:179], v[140:143], v[228:231]
    ds_read_b64_tr_b16 v[162:163], v3 offset:4608
    v_mfma_f32_16x16x32_bf16 v[232:235], v[180:183], v[136:139], v[232:235]
    ds_read_b64_tr_b16 v[164:165], v4 offset:4096
    v_mfma_f32_16x16x32_bf16 v[236:239], v[180:183], v[140:143], v[236:239]
    ds_read_b64_tr_b16 v[166:167], v4 offset:4608
    s_waitcnt lgkmcnt(4)
    v_mfma_f32_16x16x32_bf16 v[240:243], v[184:187], v[136:139], v[240:243]
    ds_read_b64_tr_b16 v[168:169], v5 offset:4096
    v_mfma_f32_16x16x32_bf16 v[244:247], v[184:187], v[140:143], v[244:247]
    ds_read_b64_tr_b16 v[170:171], v5 offset:4608
    v_mfma_f32_16x16x32_bf16 v[248:251], v[188:191], v[136:139], v[248:251]
    ds_read_b64_tr_b16 v[172:173], v6 offset:4096
    v_mfma_f32_16x16x32_bf16 v[252:255], v[188:191], v[140:143], v[252:255]
    ds_read_b64_tr_b16 v[174:175], v6 offset:4608
    s_waitcnt lgkmcnt(4)
    v_mfma_f32_16x16x32_bf16 v[224:227], v[160:163], v[144:147], v[224:227]
    ds_read_b64_tr_b16 v[176:177], v3 offset:8192
    v_mfma_f32_16x16x32_bf16 v[228:231], v[160:163], v[148:151], v[228:231]
    ds_read_b64_tr_b16 v[178:179], v3 offset:8704
    v_mfma_f32_16x16x32_bf16 v[232:235], v[164:167], v[144:147], v[232:235]
    ds_read_b64_tr_b16 v[180:181], v4 offset:8192
    v_mfma_f32_16x16x32_bf16 v[236:239], v[164:167], v[148:151], v[236:239]
    ds_read_b64_tr_b16 v[182:183], v4 offset:8704
    s_waitcnt lgkmcnt(4)
    v_mfma_f32_16x16x32_bf16 v[240:243], v[168:171], v[144:147], v[240:243]
    ds_read_b64_tr_b16 v[184:185], v5 offset:8192
    v_mfma_f32_16x16x32_bf16 v[244:247], v[168:171], v[148:151], v[244:247]
    ds_read_b64_tr_b16 v[186:187], v5 offset:8704
    v_mfma_f32_16x16x32_bf16 v[248:251], v[172:175], v[144:147], v[248:251]
    ds_read_b64_tr_b16 v[188:189], v6 offset:8192
    v_mfma_f32_16x16x32_bf16 v[252:255], v[172:175], v[148:151], v[252:255]
    ds_read_b64_tr_b16 v[190:191], v6 offset:8704
    s_waitcnt lgkmcnt(4)
    v_mfma_f32_16x16x32_bf16 v[224:227], v[176:179], v[152:155], v[224:227]
    v_mfma_f32_16x16x32_bf16 v[228:231], v[176:179], v[156:159], v[228:231]
    v_mfma_f32_16x16x32_bf16 v[232:235], v[180:183], v[152:155], v[232:235]
    v_mfma_f32_16x16x32_bf16 v[236:239], v[180:183], v[156:159], v[236:239]
    s_waitcnt lgkmcnt(0)
    v_mfma_f32_16x16x32_bf16 v[240:243], v[184:187], v[152:155], v[240:243]
    v_mfma_f32_16x16x32_bf16 v[244:247], v[184:187], v[156:159], v[244:247]
    v_mfma_f32_16x16x32_bf16 v[248:251], v[188:191], v[152:155], v[248:251]
    v_mfma_f32_16x16x32_bf16 v[252:255], v[188:191], v[156:159], v[252:255]
    s_setprio 3
    s_sub_u32 s28, s13, 10
    s_cmp_lt_u32 s28, 4
    s_cbranch_scc0 A_held0
    v_cvt_pk_bf16_f32 v224, v224, v225
    v_cvt_pk_bf16_f32 v225, v226, v227
    v_cvt_pk_bf16_f32 v226, v228, v229
    v_cvt_pk_bf16_f32 v227, v230, v231
    buffer_store_dwordx4 v[224:227], v7, s[16:19], s71 offen offset:0 sc1
    v_cvt_pk_bf16_f32 v232, v232, v233
    v_cvt_pk_bf16_f32 v233, v234, v235
    v_cvt_pk_bf16_f32 v234, v236, v237
    v_cvt_pk_bf16_f32 v235, v238, v239
    buffer_store_dwordx4 v[232:235], v7, s[16:19], s71 offen offset:2048 sc1
    v_cvt_pk_bf16_f32 v240, v240, v241
    v_cvt_pk_bf16_f32 v241, v242, v243
    v_cvt_pk_bf16_f32 v242, v244, v245
    v_cvt_pk_bf16_f32 v243, v246, v247
    buffer_store_dwordx4 v[240:243], v8, s[16:19], s71 offen offset:0 sc1
    v_cvt_pk_bf16_f32 v248, v248, v249
    v_cvt_pk_bf16_f32 v249, v250, v251
    v_cvt_pk_bf16_f32 v250, v252, v253
    v_cvt_pk_bf16_f32 v251, v254, v255
    buffer_store_dwordx4 v[248:251], v8, s[16:19], s71 offen offset:2048 sc1
    s_waitcnt vmcnt(0)
    buffer_atomic_add v14, v13, s[16:19], 0 offen sc1
    s_branch A_attn
A_held0:
    v_mov_b32 v22, v12
    v_mov_b32 v29, v13
    v_mov_b64 v[24:25], v[8:9]
    v_mov_b32 v26, v7
    v_mov_b32 v27, v10
    v_mov_b32 v28, v14
    ds_read_b128 v[0:3], v22 offset:0
    ds_read_b128 v[4:7], v22 offset:1024
    ds_read_b128 v[8:11], v22 offset:2048
    ds_read_b128 v[12:15], v22 offset:3072
    ds_read_b128 v[16:19], v22 offset:4096
    v_cvt_pk_bf16_f32 v224, v224, v225
    v_cvt_pk_bf16_f32 v225, v226, v227
    v_cvt_pk_bf16_f32 v226, v228, v229
    v_cvt_pk_bf16_f32 v227, v230, v231
    v_cvt_pk_bf16_f32 v232, v232, v233
    v_cvt_pk_bf16_f32 v233, v234, v235
    v_cvt_pk_bf16_f32 v234, v236, v237
    v_cvt_pk_bf16_f32 v235, v238, v239
    v_cvt_pk_bf16_f32 v240, v240, v241
    v_cvt_pk_bf16_f32 v241, v242, v243
    v_cvt_pk_bf16_f32 v242, v244, v245
    v_cvt_pk_bf16_f32 v243, v246, v247
    v_cvt_pk_bf16_f32 v248, v248, v249
    v_cvt_pk_bf16_f32 v249, v250, v251
    v_cvt_pk_bf16_f32 v250, v252, v253
    v_cvt_pk_bf16_f32 v251, v254, v255
    s_mov_b32 s12, 1
    s_waitcnt vmcnt(0)
    s_branch A_post
A_st0:
    buffer_store_dwordx4 v[224:227], v26, s[16:19], s71 offen offset:0 sc1
    buffer_store_dwordx4 v[232:235], v26, s[16:19], s71 offen offset:2048 sc1
    buffer_store_dwordx4 v[240:243], v24, s[16:19], s71 offen offset:0 sc1
    buffer_store_dwordx4 v[248:251], v24, s[16:19], s71 offen offset:2048 sc1
    s_waitcnt vmcnt(0)
    buffer_atomic_add v28, v29, s[16:19], 0 offen sc1
    s_branch A_post3
A_V:
    v_mul_u32_u24 v7, 9216, v9
    v_lshl_add_u32 v7, v8, 4, v7
    s_mul_i32 s28, s48, 36864
    s_add_u32 s47, s47, s28
    s_add_u32 s47, s47, 55296
    s_lshl_b32 s50, s14, 10
    s_add_u32 s50, s50, s47
    s_lshl_b32 s71, s3, 10
    s_add_u32 s71, s71, s47
    s_cmp_ge_u32 s3, 9
    s_cselect_b32 s28, 9, 0
    s_cselect_b32 s31, 0, 4
    s_cselect_b32 s33, 4, 99
    s_cmp_ge_u32 s3, 18
    s_cselect_b32 s28, 18, s28
    s_cselect_b32 s29, 0, 2
    s_sub_u32 s28, s3, s28
    s_lshl_b32 s28, s28, 6
    s_mul_i32 s30, s28, 3641
    s_lshr_b32 s30, s30, 16
    s_max_u32 s30, s30, 1
    s_sub_u32 s30, s30, 1
    v_lshrrev_b32 v10, 3, v0
    v_add_u32 v10, s30, v10
    v_and_b32 v11, 1, v10
    v_mul_u32_u24 v11, s29, v11
    v_mul_u32_u24 v14, 18, v10
    v_sub_u32 v11, v14, v11
    s_add_u32 s29, s29, 18
    v_add_u32 v14, s29, v11
    s_add_u32 s29, s28, 64
    v_min_u32 v14, s29, v14
    v_max_u32 v11, s28, v11
    v_sub_u32 v14, v14, v11
    s_lshr_b32 s28, s13, 1
    s_and_b32 s29, s13, 1
    s_cmp_eq_u32 s28, s33
    s_cselect_b32 s29, s29, s13
    s_cselect_b32 s31, 4, s31
    s_cselect_b32 s28, 8, 1
    s_lshl_b32 s29, s29, 7
    s_add_u32 s29, s29, s31
    s_add_u32 s29, s29, 9437184
    v_and_b32 v11, 7, v0
    v_cmp_gt_u32 s[30:31], s28, v11
    v_cmp_lt_i32 vcc, 0, v14
    v_lshl_add_u32 v10, v10, 3, v11
    s_and_b64 vcc, vcc, s[30:31]
    v_lshl_add_u32 v10, v10, 8, s29
    v_cndmask_b32 v13, -16, v10, vcc
    s_cmp_ge_u32 s14, 9
    s_cselect_b32 s28, 9, 0
    s_cselect_b32 s31, 0, 4
    s_cselect_b32 s33, 4, 99
    s_cmp_ge_u32 s14, 18
    s_cselect_b32 s28, 18, s28
    s_cselect_b32 s29, 0, 2
    s_sub_u32 s28, s14, s28
    s_lshl_b32 s28, s28, 6
    s_mul_i32 s30, s28, 3641
    s_lshr_b32 s30, s30, 16
    s_max_u32 s30, s30, 1
    s_sub_u32 s30, s30, 1
    v_lshrrev_b32 v10, 3, v0
    v_add_u32 v10, s30, v10
    v_and_b32 v11, 1, v10
    v_mul_u32_u24 v11, s29, v11
    v_mul_u32_u24 v9, 18, v10
    v_sub_u32 v11, v9, v11
    s_add_u32 s29, s29, 18
    v_add_u32 v9, s29, v11
    s_add_u32 s29, s28, 64
    v_min_u32 v9, s29, v9
    v_max_u32 v11, s28, v11
    v_sub_u32 v9, v9, v11
    s_lshr_b32 s28, s13, 1
    s_and_b32 s29, s13, 1
    s_cmp_eq_u32 s28, s33
    s_cselect_b32 s29, s29, s13
    s_cselect_b32 s31, 4, s31
    s_cselect_b32 s28, 8, 1
    s_lshl_b32 s29, s29, 7
    s_add_u32 s29, s29, s31
    s_add_u32 s29, s29, 9437184
    v_and_b32 v11, 7, v0
    v_cmp_gt_u32 s[30:31], s28, v11
    v_cmp_lt_i32 vcc, 0, v9
    v_lshl_add_u32 v10, v10, 3, v11
    s_and_b64 vcc, vcc, s[30:31]
    v_lshl_add_u32 v10, v10, 8, s29
    v_cndmask_b32 v10, -16, v10, vcc
    s_mov_b64 exec, 0
    s_branch I_p1_0
I_p1_r:
    s_mov_b64 exec, -1
    s_barrier
    ds_read_b64_tr_b16 v[160:161], v3 offset:0
    ds_read_b64_tr_b16 v[162:163], v3 offset:512
    ds_read_b128 v[16:19], v1 offset:0
    ds_read_b128 v[20:23], v1 offset:2048
    ds_read_b64_tr_b16 v[164:165], v4 offset:0
    ds_read_b64_tr_b16 v[166:167], v4 offset:512
    s_waitcnt lgkmcnt(2)
    v_mfma_f32_16x16x32_bf16 v[192:195], v[16:19], v[160:163], 0
    ds_read_b64_tr_b16 v[168:169], v5 offset:0
    ds_read_b64_tr_b16 v[170:171], v5 offset:512
    v_mfma_f32_16x16x32_bf16 v[196:199], v[20:23], v[160:163], 0
    ds_read_b64_tr_b16 v[172:173], v6 offset:0
    ds_read_b64_tr_b16 v[174:175], v6 offset:512
    s_waitcnt lgkmcnt(4)
    v_mfma_f32_16x16x32_bf16 v[200:203], v[16:19], v[164:167], 0
    ds_read_b64_tr_b16 v[176:177], v3 offset:4096
    ds_read_b64_tr_b16 v[178:179], v3 offset:4608
    v_mfma_f32_16x16x32_bf16 v[204:207], v[20:23], v[164:167], 0
    ds_read_b128 v[24:27], v2 offset:0
    ds_read_b128 v[28:31], v2 offset:2048
    s_waitcnt lgkmcnt(6)
    v_mfma_f32_16x16x32_bf16 v[208:211], v[16:19], v[168:171], 0
    ds_read_b64_tr_b16 v[180:181], v4 offset:4096
    ds_read_b64_tr_b16 v[182:183], v4 offset:4608
    v_mfma_f32_16x16x32_bf16 v[212:215], v[20:23], v[168:171], 0
    ds_read_b64_tr_b16 v[184:185], v5 offset:4096
    ds_read_b64_tr_b16 v[186:187], v5 offset:4608
    s_waitcnt lgkmcnt(8)
    v_mfma_f32_16x16x32_bf16 v[216:219], v[16:19], v[172:175], 0
    ds_read_b64_tr_b16 v[188:189], v6 offset:4096
    v_mfma_f32_16x16x32_bf16 v[220:223], v[20:23], v[172:175], 0
    ds_read_b64_tr_b16 v[190:191], v6 offset:4608
    s_barrier
    s_waitcnt lgkmcnt(6)
    v_mfma_f32_16x16x32_bf16 v[192:195], v[24:27], v[176:179], v[192:195]
    ds_read_b64_tr_b16 v[160:161], v3 offset:24576
    ds_read_b64_tr_b16 v[162:163], v3 offset:25088
    v_mfma_f32_16x16x32_bf16 v[196:199], v[28:31], v[176:179], v[196:199]
    ds_read_b128 v[32:35], v1 offset:24576
    ds_read_b128 v[36:39], v1 offset:26624
    s_waitcnt lgkmcnt(8)
    v_mfma_f32_16x16x32_bf16 v[200:203], v[24:27], v[180:183], v[200:203]
    ds_read_b64_tr_b16 v[164:165], v4 offset:24576
    v_mfma_f32_16x16x32_bf16 v[204:207], v[28:31], v[180:183], v[204:207]
    ds_read_b64_tr_b16 v[166:167], v4 offset:25088
    s_waitcnt lgkmcnt(8)
    v_mfma_f32_16x16x32_bf16 v[208:211], v[24:27], v[184:187], v[208:211]
    ds_read_b64_tr_b16 v[168:169], v5 offset:24576
    v_mfma_f32_16x16x32_bf16 v[212:215], v[28:31], v[184:187], v[212:215]
    ds_read_b64_tr_b16 v[170:171], v5 offset:25088
    s_waitcnt lgkmcnt(8)
    v_mfma_f32_16x16x32_bf16 v[216:219], v[24:27], v[188:191], v[216:219]
    ds_read_b64_tr_b16 v[172:173], v6 offset:24576
    v_mfma_f32_16x16x32_bf16 v[220:223], v[28:31], v[188:191], v[220:223]
    ds_read_b64_tr_b16 v[174:175], v6 offset:25088
    s_waitcnt lgkmcnt(6)
    v_mfma_f32_16x16x32_bf16 v[192:195], v[32:35], v[160:163], v[192:195]
    ds_read_b64_tr_b16 v[176:177], v3 offset:28672
    ds_read_b64_tr_b16 v[178:179], v3 offset:29184
    v_mfma_f32_16x16x32_bf16 v[196:199], v[36:39], v[160:163], v[196:199]
    ds_read_b128 v[40:43], v2 offset:24576
    ds_read_b128 v[44:47], v2 offset:26624
    s_waitcnt lgkmcnt(8)
    v_mfma_f32_16x16x32_bf16 v[200:203], v[32:35], v[164:167], v[200:203]
    ds_read_b64_tr_b16 v[180:181], v4 offset:28672
    v_mfma_f32_16x16x32_bf16 v[204:207], v[36:39], v[164:167], v[204:207]
    ds_read_b64_tr_b16 v[182:183], v4 offset:29184
    s_waitcnt lgkmcnt(8)
    v_mfma_f32_16x16x32_bf16 v[208:211], v[32:35], v[168:171], v[208:211]
    ds_read_b64_tr_b16 v[184:185], v5 offset:28672
    v_mfma_f32_16x16x32_bf16 v[212:215], v[36:39], v[168:171], v[212:215]
    ds_read_b64_tr_b16 v[186:187], v5 offset:29184
    s_waitcnt lgkmcnt(8)
    v_mfma_f32_16x16x32_bf16 v[216:219], v[32:35], v[172:175], v[216:219]
    ds_read_b64_tr_b16 v[188:189], v6 offset:28672
    v_mfma_f32_16x16x32_bf16 v[220:223], v[36:39], v[172:175], v[220:223]
    ds_read_b64_tr_b16 v[190:191], v6 offset:29184
    v_add_u32 v1, 0xc000, v1
    v_add_u32 v2, 0xc000, v2
    v_add_u32 v3, 0xc000, v3
    v_add_u32 v4, 0xc000, v4
    v_add_u32 v5, 0xc000, v5
    v_add_u32 v6, 0xc000, v6
    s_barrier
    s_waitcnt lgkmcnt(6)
    v_mfma_f32_16x16x32_bf16 v[192:195], v[40:43], v[176:179], v[192:195]
    ds_read_b64_tr_b16 v[160:161], v3 offset:0
    ds_read_b64_tr_b16 v[162:163], v3 offset:512
    v_mfma_f32_16x16x32_bf16 v[196:199], v[44:47], v[176:179], v[196:199]
    ds_read_b128 v[48:51], v1 offset:0
    ds_read_b128 v[52:55], v1 offset:2048
    s_waitcnt lgkmcnt(8)
    v_mfma_f32_16x16x32_bf16 v[200:203], v[40:43], v[180:183], v[200:203]
    ds_read_b64_tr_b16 v[164:165], v4 offset:0
    v_mfma_f32_16x16x32_bf16 v[204:207], v[44:47], v[180:183], v[204:207]
    ds_read_b64_tr_b16 v[166:167], v4 offset:512
    s_waitcnt lgkmcnt(8)
    v_mfma_f32_16x16x32_bf16 v[208:211], v[40:43], v[184:187], v[208:211]
    ds_read_b64_tr_b16 v[168:169], v5 offset:0
    v_mfma_f32_16x16x32_bf16 v[212:215], v[44:47], v[184:187], v[212:215]
    ds_read_b64_tr_b16 v[170:171], v5 offset:512
    s_waitcnt lgkmcnt(8)
    v_mfma_f32_16x16x32_bf16 v[216:219], v[40:43], v[188:191], v[216:219]
    ds_read_b64_tr_b16 v[172:173], v6 offset:0
    v_mfma_f32_16x16x32_bf16 v[220:223], v[44:47], v[188:191], v[220:223]
    ds_read_b64_tr_b16 v[174:175], v6 offset:512
    s_waitcnt lgkmcnt(6)
    v_mfma_f32_16x16x32_bf16 v[192:195], v[48:51], v[160:163], v[192:195]
    ds_read_b64_tr_b16 v[176:177], v3 offset:4096
    ds_read_b64_tr_b16 v[178:179], v3 offset:4608
    v_mfma_f32_16x16x32_bf16 v[196:199], v[52:55], v[160:163], v[196:199]
    ds_read_b128 v[56:59], v2 offset:0
    ds_read_b128 v[60:63], v2 offset:2048
    s_waitcnt lgkmcnt(8)
    v_mfma_f32_16x16x32_bf16 v[200:203], v[48:51], v[164:167], v[200:203]
    ds_read_b64_tr_b16 v[180:181], v4 offset:4096
    v_mfma_f32_16x16x32_bf16 v[204:207], v[52:55], v[164:167], v[204:207]
    ds_read_b64_tr_b16 v[182:183], v4 offset:4608
    s_waitcnt lgkmcnt(8)
    v_mfma_f32_16x16x32_bf16 v[208:211], v[48:51], v[168:171], v[208:211]
    ds_read_b64_tr_b16 v[184:185], v5 offset:4096
    v_mfma_f32_16x16x32_bf16 v[212:215], v[52:55], v[168:171], v[212:215]
    ds_read_b64_tr_b16 v[186:187], v5 offset:4608
    s_waitcnt lgkmcnt(8)
    v_mfma_f32_16x16x32_bf16 v[216:219], v[48:51], v[172:175], v[216:219]
    ds_read_b64_tr_b16 v[188:189], v6 offset:4096
    v_mfma_f32_16x16x32_bf16 v[220:223], v[52:55], v[172:175], v[220:223]
    ds_read_b64_tr_b16 v[190:191], v6 offset:4608
    v_add_u32 v1, 0xfffe2000, v1
    v_add_u32 v2, 0xfffe2000, v2
    v_add_u32 v3, 0xfffe2000, v3
    v_add_u32 v4, 0xfffe2000, v4
    v_add_u32 v5, 0xfffe2000, v5
    v_add_u32 v6, 0xfffe2000, v6
    s_barrier
    s_waitcnt lgkmcnt(6)
    v_mfma_f32_16x16x32_bf16 v[192:195], v[56:59], v[176:179], v[192:195]
    ds_read_b64_tr_b16 v[160:161], v3 offset:0
    ds_read_b64_tr_b16 v[162:163], v3 offset:512
    v_mfma_f32_16x16x32_bf16 v[196:199], v[60:63], v[176:179], v[196:199]
    ds_read_b128 v[64:67], v1 offset:0
    ds_read_b128 v[68:71], v1 offset:2048
    s_waitcnt lgkmcnt(8)
    v_mfma_f32_16x16x32_bf16 v[200:203], v[56:59], v[180:183], v[200:203]
    ds_read_b64_tr_b16 v[164:165], v4 offset:0
    v_mfma_f32_16x16x32_bf16 v[204:207], v[60:63], v[180:183], v[204:207]
    ds_read_b64_tr_b16 v[166:167], v4 offset:512
    s_waitcnt lgkmcnt(8)
    v_mfma_f32_16x16x32_bf16 v[208:211], v[56:59], v[184:187], v[208:211]
    ds_read_b64_tr_b16 v[168:169], v5 offset:0
    v_mfma_f32_16x16x32_bf16 v[212:215], v[60:63], v[184:187], v[212:215]
    ds_read_b64_tr_b16 v[170:171], v5 offset:512
    s_waitcnt lgkmcnt(8)
    v_mfma_f32_16x16x32_bf16 v[216:219], v[56:59], v[188:191], v[216:219]
    ds_read_b64_tr_b16 v[172:173], v6 offset:0
    v_mfma_f32_16x16x32_bf16 v[220:223], v[60:63], v[188:191], v[220:223]
    ds_read_b64_tr_b16 v[174:175], v6 offset:512
    s_waitcnt lgkmcnt(6)
    v_mfma_f32_16x16x32_bf16 v[192:195], v[64:67], v[160:163], v[192:195]
    ds_read_b64_tr_b16 v[176:177], v3 offset:4096
    ds_read_b64_tr_b16 v[178:179], v3 offset:4608
    v_mfma_f32_16x16x32_bf16 v[196:199], v[68:71], v[160:163], v[196:199]
    ds_read_b128 v[72:75], v2 offset:0
    ds_read_b128 v[76:79], v2 offset:2048
    s_waitcnt lgkmcnt(8)
    v_mfma_f32_16x16x32_bf16 v[200:203], v[64:67], v[164:167], v[200:203]
    ds_read_b64_tr_b16 v[180:181], v4 offset:4096
    v_mfma_f32_16x16x32_bf16 v[204:207], v[68:71], v[164:167], v[204:207]
    ds_read_b64_tr_b16 v[182:183], v4 offset:4608
    s_waitcnt lgkmcnt(8)
    v_mfma_f32_16x16x32_bf16 v[208:211], v[64:67], v[168:171], v[208:211]
    ds_read_b64_tr_b16 v[184:185], v5 offset:4096
    v_mfma_f32_16x16x32_bf16 v[212:215], v[68:71], v[168:171], v[212:215]
    ds_read_b64_tr_b16 v[186:187], v5 offset:4608
    s_waitcnt lgkmcnt(8)
    v_mfma_f32_16x16x32_bf16 v[216:219], v[64:67], v[172:175], v[216:219]
    ds_read_b64_tr_b16 v[188:189], v6 offset:4096
    v_mfma_f32_16x16x32_bf16 v[220:223], v[68:71], v[172:175], v[220:223]
    ds_read_b64_tr_b16 v[190:191], v6 offset:4608
    s_barrier
    s_waitcnt lgkmcnt(6)
    v_mfma_f32_16x16x32_bf16 v[192:195], v[72:75], v[176:179], v[192:195]
    ds_read_b64_tr_b16 v[160:161], v3 offset:24576
    ds_read_b64_tr_b16 v[162:163], v3 offset:25088
    v_mfma_f32_16x16x32_bf16 v[196:199], v[76:79], v[176:179], v[196:199]
    ds_read_b128 v[80:83], v1 offset:24576
    ds_read_b128 v[84:87], v1 offset:26624
    s_waitcnt lgkmcnt(8)
    v_mfma_f32_16x16x32_bf16 v[200:203], v[72:75], v[180:183], v[200:203]
    ds_read_b64_tr_b16 v[164:165], v4 offset:24576
    v_mfma_f32_16x16x32_bf16 v[204:207], v[76:79], v[180:183], v[204:207]
    ds_read_b64_tr_b16 v[166:167], v4 offset:25088
    s_waitcnt lgkmcnt(8)
    v_mfma_f32_16x16x32_bf16 v[208:211], v[72:75], v[184:187], v[208:211]
    ds_read_b64_tr_b16 v[168:169], v5 offset:24576
    v_mfma_f32_16x16x32_bf16 v[212:215], v[76:79], v[184:187], v[212:215]
    ds_read_b64_tr_b16 v[170:171], v5 offset:25088
    s_waitcnt lgkmcnt(8)
    v_mfma_f32_16x16x32_bf16 v[216:219], v[72:75], v[188:191], v[216:219]
    ds_read_b64_tr_b16 v[172:173], v6 offset:24576
    v_mfma_f32_16x16x32_bf16 v[220:223], v[76:79], v[188:191], v[220:223]
    ds_read_b64_tr_b16 v[174:175], v6 offset:25088
    s_waitcnt lgkmcnt(6)
    v_mfma_f32_16x16x32_bf16 v[192:195], v[80:83], v[160:163], v[192:195]
    ds_read_b64_tr_b16 v[176:177], v3 offset:28672
    ds_read_b64_tr_b16 v[178:179], v3 offset:29184
    v_mfma_f32_16x16x32_bf16 v[196:199], v[84:87], v[160:163], v[196:199]
    ds_read_b128 v[88:91], v2 offset:24576
    ds_read_b128 v[92:95], v2 offset:26624
I_p1_0:
    s_cbranch_execz I_p1_1
    s_waitcnt lgkmcnt(8)
    v_mfma_f32_16x16x32_bf16 v[200:203], v[80:83], v[164:167], v[200:203]
    ds_read_b64_tr_b16 v[180:181], v4 offset:28672
    v_mfma_f32_16x16x32_bf16 v[204:207], v[84:87], v[164:167], v[204:207]
    ds_read_b64_tr_b16 v[182:183], v4 offset:29184
    s_waitcnt lgkmcnt(8)
    v_mfma_f32_16x16x32_bf16 v[208:211], v[80:83], v[168:171], v[208:211]
    ds_read_b64_tr_b16 v[184:185], v5 offset:28672
    v_mfma_f32_16x16x32_bf16 v[212:215], v[84:87], v[168:171], v[212:215]
    ds_read_b64_tr_b16 v[186:187], v5 offset:29184
    s_waitcnt lgkmcnt(8)
    v_mfma_f32_16x16x32_bf16 v[216:219], v[80:83], v[172:175], v[216:219]
    ds_read_b64_tr_b16 v[188:189], v6 offset:28672
    v_mfma_f32_16x16x32_bf16 v[220:223], v[84:87], v[172:175], v[220:223]
    ds_read_b64_tr_b16 v[190:191], v6 offset:29184
    v_add_u32 v1, 0xc000, v1
    v_add_u32 v2, 0xc000, v2
    v_add_u32 v3, 0xc000, v3
    v_add_u32 v4, 0xc000, v4
    v_add_u32 v5, 0xc000, v5
    v_add_u32 v6, 0xc000, v6
    s_barrier
    s_waitcnt lgkmcnt(6)
    v_mfma_f32_16x16x32_bf16 v[192:195], v[88:91], v[176:179], v[192:195]
    ds_read_b64_tr_b16 v[160:161], v3 offset:0
    ds_read_b64_tr_b16 v[162:163], v3 offset:512
    v_mfma_f32_16x16x32_bf16 v[196:199], v[92:95], v[176:179], v[196:199]
    ds_read_b128 v[96:99], v1 offset:0
    ds_read_b128 v[100:103], v1 offset:2048
    s_waitcnt lgkmcnt(8)
    v_mfma_f32_16x16x32_bf16 v[200:203], v[88:91], v[180:183], v[200:203]
    ds_read_b64_tr_b16 v[164:165], v4 offset:0
    v_mfma_f32_16x16x32_bf16 v[204:207], v[92:95], v[180:183], v[204:207]
    ds_read_b64_tr_b16 v[166:167], v4 offset:512
    s_waitcnt lgkmcnt(8)
    v_mfma_f32_16x16x32_bf16 v[208:211], v[88:91], v[184:187], v[208:211]
    ds_read_b64_tr_b16 v[168:169], v5 offset:0
    v_mfma_f32_16x16x32_bf16 v[212:215], v[92:95], v[184:187], v[212:215]
    ds_read_b64_tr_b16 v[170:171], v5 offset:512
    s_waitcnt lgkmcnt(8)
    v_mfma_f32_16x16x32_bf16 v[216:219], v[88:91], v[188:191], v[216:219]
    ds_read_b64_tr_b16 v[172:173], v6 offset:0
    v_mfma_f32_16x16x32_bf16 v[220:223], v[92:95], v[188:191], v[220:223]
    ds_read_b64_tr_b16 v[174:175], v6 offset:512
    s_waitcnt lgkmcnt(6)
    v_mfma_f32_16x16x32_bf16 v[192:195], v[96:99], v[160:163], v[192:195]
    ds_read_b64_tr_b16 v[176:177], v3 offset:4096
    ds_read_b64_tr_b16 v[178:179], v3 offset:4608
    v_mfma_f32_16x16x32_bf16 v[196:199], v[100:103], v[160:163], v[196:199]
    ds_read_b128 v[104:107], v2 offset:0
    ds_read_b128 v[108:111], v2 offset:2048
    s_waitcnt lgkmcnt(8)
    v_mfma_f32_16x16x32_bf16 v[200:203], v[96:99], v[164:167], v[200:203]
    ds_read_b64_tr_b16 v[180:181], v4 offset:4096
    v_mfma_f32_16x16x32_bf16 v[204:207], v[100:103], v[164:167], v[204:207]
    ds_read_b64_tr_b16 v[182:183], v4 offset:4608
    s_waitcnt lgkmcnt(8)
    v_mfma_f32_16x16x32_bf16 v[208:211], v[96:99], v[168:171], v[208:211]
    ds_read_b64_tr_b16 v[184:185], v5 offset:4096
    v_mfma_f32_16x16x32_bf16 v[212:215], v[100:103], v[168:171], v[212:215]
    ds_read_b64_tr_b16 v[186:187], v5 offset:4608
    s_waitcnt lgkmcnt(8)
    v_mfma_f32_16x16x32_bf16 v[216:219], v[96:99], v[172:175], v[216:219]
    ds_read_b64_tr_b16 v[188:189], v6 offset:4096
    v_mfma_f32_16x16x32_bf16 v[220:223], v[100:103], v[172:175], v[220:223]
    ds_read_b64_tr_b16 v[190:191], v6 offset:4608
    s_barrier
    s_waitcnt lgkmcnt(6)
    v_mfma_f32_16x16x32_bf16 v[192:195], v[104:107], v[176:179], v[192:195]
    ds_read_b64_tr_b16 v[160:161], v3 offset:24576
    ds_read_b64_tr_b16 v[162:163], v3 offset:25088
    v_mfma_f32_16x16x32_bf16 v[196:199], v[108:111], v[176:179], v[196:199]
    ds_read_b128 v[112:115], v1 offset:24576
    ds_read_b128 v[116:119], v1 offset:26624
    s_waitcnt lgkmcnt(8)
    v_mfma_f32_16x16x32_bf16 v[200:203], v[104:107], v[180:183], v[200:203]
    ds_read_b64_tr_b16 v[164:165], v4 offset:24576
    v_mfma_f32_16x16x32_bf16 v[204:207], v[108:111], v[180:183], v[204:207]
    ds_read_b64_tr_b16 v[166:167], v4 offset:25088
    s_waitcnt lgkmcnt(8)
    v_mfma_f32_16x16x32_bf16 v[208:211], v[104:107], v[184:187], v[208:211]
    ds_read_b64_tr_b16 v[168:169], v5 offset:24576
    v_mfma_f32_16x16x32_bf16 v[212:215], v[108:111], v[184:187], v[212:215]
    ds_read_b64_tr_b16 v[170:171], v5 offset:25088
    s_waitcnt lgkmcnt(8)
    v_mfma_f32_16x16x32_bf16 v[216:219], v[104:107], v[188:191], v[216:219]
    ds_read_b64_tr_b16 v[172:173], v6 offset:24576
    v_mfma_f32_16x16x32_bf16 v[220:223], v[108:111], v[188:191], v[220:223]
    ds_read_b64_tr_b16 v[174:175], v6 offset:25088
    s_waitcnt lgkmcnt(6)
    v_mfma_f32_16x16x32_bf16 v[192:195], v[112:115], v[160:163], v[192:195]
    ds_read_b64_tr_b16 v[176:177], v3 offset:28672
    ds_read_b64_tr_b16 v[178:179], v3 offset:29184
    v_mfma_f32_16x16x32_bf16 v[196:199], v[116:119], v[160:163], v[196:199]
    ds_read_b128 v[120:123], v2 offset:24576
    ds_read_b128 v[124:127], v2 offset:26624
    s_waitcnt lgkmcnt(8)
    v_mfma_f32_16x16x32_bf16 v[200:203], v[112:115], v[164:167], v[200:203]
    ds_read_b64_tr_b16 v[180:181], v4 offset:28672
    v_mfma_f32_16x16x32_bf16 v[204:207], v[116:119], v[164:167], v[204:207]
    ds_read_b64_tr_b16 v[182:183], v4 offset:29184
    s_waitcnt lgkmcnt(8)
    v_mfma_f32_16x16x32_bf16 v[208:211], v[112:115], v[168:171], v[208:211]
    ds_read_b64_tr_b16 v[184:185], v5 offset:28672
    v_mfma_f32_16x16x32_bf16 v[212:215], v[116:119], v[168:171], v[212:215]
    ds_read_b64_tr_b16 v[186:187], v5 offset:29184
    s_waitcnt lgkmcnt(8)
    v_mfma_f32_16x16x32_bf16 v[216:219], v[112:115], v[172:175], v[216:219]
    ds_read_b64_tr_b16 v[188:189], v6 offset:28672
    v_mfma_f32_16x16x32_bf16 v[220:223], v[116:119], v[172:175], v[220:223]
    ds_read_b64_tr_b16 v[190:191], v6 offset:29184
    v_add_u32 v1, 0xc000, v1
    v_add_u32 v2, 0xc000, v2
    v_add_u32 v3, 0xc000, v3
    v_add_u32 v4, 0xc000, v4
    v_add_u32 v5, 0xc000, v5
    v_add_u32 v6, 0xc000, v6
    s_barrier
    s_waitcnt lgkmcnt(6)
    v_mfma_f32_16x16x32_bf16 v[192:195], v[120:123], v[176:179], v[192:195]
    ds_read_b64_tr_b16 v[160:161], v3 offset:0
    ds_read_b64_tr_b16 v[162:163], v3 offset:512
    v_mfma_f32_16x16x32_bf16 v[196:199], v[124:127], v[176:179], v[196:199]
    ds_read_b128 v[128:131], v1 offset:0
    ds_read_b128 v[132:135], v1 offset:2048
    s_waitcnt lgkmcnt(8)
    v_mfma_f32_16x16x32_bf16 v[200:203], v[120:123], v[180:183], v[200:203]
    ds_read_b64_tr_b16 v[164:165], v4 offset:0
    v_mfma_f32_16x16x32_bf16 v[204:207], v[124:127], v[180:183], v[204:207]
    ds_read_b64_tr_b16 v[166:167], v4 offset:512
    s_waitcnt lgkmcnt(8)
    v_mfma_f32_16x16x32_bf16 v[208:211], v[120:123], v[184:187], v[208:211]
    ds_read_b64_tr_b16 v[168:169], v5 offset:0
    v_mfma_f32_16x16x32_bf16 v[212:215], v[124:127], v[184:187], v[212:215]
    ds_read_b64_tr_b16 v[170:171], v5 offset:512
    s_waitcnt lgkmcnt(8)
    v_mfma_f32_16x16x32_bf16 v[216:219], v[120:123], v[188:191], v[216:219]
    ds_read_b64_tr_b16 v[172:173], v6 offset:0
    v_mfma_f32_16x16x32_bf16 v[220:223], v[124:127], v[188:191], v[220:223]
    ds_read_b64_tr_b16 v[174:175], v6 offset:512
    s_waitcnt lgkmcnt(6)
    v_mfma_f32_16x16x32_bf16 v[192:195], v[128:131], v[160:163], v[192:195]
    ds_read_b64_tr_b16 v[176:177], v3 offset:4096
    ds_read_b64_tr_b16 v[178:179], v3 offset:4608
    v_mfma_f32_16x16x32_bf16 v[196:199], v[132:135], v[160:163], v[196:199]
    ds_read_b128 v[136:139], v2 offset:0
    ds_read_b128 v[140:143], v2 offset:2048
    s_waitcnt lgkmcnt(8)
    v_mfma_f32_16x16x32_bf16 v[200:203], v[128:131], v[164:167], v[200:203]
    ds_read_b64_tr_b16 v[180:181], v4 offset:4096
    v_mfma_f32_16x16x32_bf16 v[204:207], v[132:135], v[164:167], v[204:207]
    ds_read_b64_tr_b16 v[182:183], v4 offset:4608
    s_waitcnt lgkmcnt(8)
    v_mfma_f32_16x16x32_bf16 v[208:211], v[128:131], v[168:171], v[208:211]
    ds_read_b64_tr_b16 v[184:185], v5 offset:4096
    v_mfma_f32_16x16x32_bf16 v[212:215], v[132:135], v[168:171], v[212:215]
    ds_read_b64_tr_b16 v[186:187], v5 offset:4608
    s_waitcnt lgkmcnt(8)
    v_mfma_f32_16x16x32_bf16 v[216:219], v[128:131], v[172:175], v[216:219]
    ds_read_b64_tr_b16 v[188:189], v6 offset:4096
    v_mfma_f32_16x16x32_bf16 v[220:223], v[132:135], v[172:175], v[220:223]
    ds_read_b64_tr_b16 v[190:191], v6 offset:4608
    s_barrier
    s_waitcnt lgkmcnt(6)
    v_mfma_f32_16x16x32_bf16 v[192:195], v[136:139], v[176:179], v[192:195]
    ds_read_b64_tr_b16 v[160:161], v3 offset:24576
    ds_read_b64_tr_b16 v[162:163], v3 offset:25088
    v_mfma_f32_16x16x32_bf16 v[196:199], v[140:143], v[176:179], v[196:199]
    ds_read_b128 v[144:147], v1 offset:24576
    ds_read_b128 v[148:151], v1 offset:26624
    s_waitcnt lgkmcnt(8)
    v_mfma_f32_16x16x32_bf16 v[200:203], v[136:139], v[180:183], v[200:203]
    ds_read_b64_tr_b16 v[164:165], v4 offset:24576
    v_mfma_f32_16x16x32_bf16 v[204:207], v[140:143], v[180:183], v[204:207]
    ds_read_b64_tr_b16 v[166:167], v4 offset:25088
    s_waitcnt lgkmcnt(8)
    v_mfma_f32_16x16x32_bf16 v[208:211], v[136:139], v[184:187], v[208:211]
    ds_read_b64_tr_b16 v[168:169], v5 offset:24576
    v_mfma_f32_16x16x32_bf16 v[212:215], v[140:143], v[184:187], v[212:215]
    ds_read_b64_tr_b16 v[170:171], v5 offset:25088
    s_waitcnt lgkmcnt(8)
    v_mfma_f32_16x16x32_bf16 v[216:219], v[136:139], v[188:191], v[216:219]
    ds_read_b64_tr_b16 v[172:173], v6 offset:24576
    v_mfma_f32_16x16x32_bf16 v[220:223], v[140:143], v[188:191], v[220:223]
    ds_read_b64_tr_b16 v[174:175], v6 offset:25088
    s_waitcnt lgkmcnt(6)
    v_mfma_f32_16x16x32_bf16 v[192:195], v[144:147], v[160:163], v[192:195]
    ds_read_b64_tr_b16 v[176:177], v3 offset:28672
    ds_read_b64_tr_b16 v[178:179], v3 offset:29184
    v_mfma_f32_16x16x32_bf16 v[196:199], v[148:151], v[160:163], v[196:199]
    ds_read_b128 v[152:155], v2 offset:24576
    ds_read_b128 v[156:159], v2 offset:26624
    s_waitcnt lgkmcnt(8)
    v_mfma_f32_16x16x32_bf16 v[200:203], v[144:147], v[164:167], v[200:203]
    ds_read_b64_tr_b16 v[180:181], v4 offset:28672
    v_mfma_f32_16x16x32_bf16 v[204:207], v[148:151], v[164:167], v[204:207]
    ds_read_b64_tr_b16 v[182:183], v4 offset:29184
    s_waitcnt lgkmcnt(8)
    v_mfma_f32_16x16x32_bf16 v[208:211], v[144:147], v[168:171], v[208:211]
    ds_read_b64_tr_b16 v[184:185], v5 offset:28672
    v_mfma_f32_16x16x32_bf16 v[212:215], v[148:151], v[168:171], v[212:215]
    ds_read_b64_tr_b16 v[186:187], v5 offset:29184
    s_waitcnt lgkmcnt(8)
    v_mfma_f32_16x16x32_bf16 v[216:219], v[144:147], v[172:175], v[216:219]
    ds_read_b64_tr_b16 v[188:189], v6 offset:28672
    v_mfma_f32_16x16x32_bf16 v[220:223], v[148:151], v[172:175], v[220:223]
    ds_read_b64_tr_b16 v[190:191], v6 offset:29184
    s_waitcnt lgkmcnt(6)
    v_mfma_f32_16x16x32_bf16 v[192:195], v[152:155], v[176:179], v[192:195]
    v_mfma_f32_16x16x32_bf16 v[196:199], v[156:159], v[176:179], v[196:199]
    s_waitcnt lgkmcnt(4)
    v_mfma_f32_16x16x32_bf16 v[200:203], v[152:155], v[180:183], v[200:203]
    v_mfma_f32_16x16x32_bf16 v[204:207], v[156:159], v[180:183], v[204:207]
    s_waitcnt lgkmcnt(2)
    v_mfma_f32_16x16x32_bf16 v[208:211], v[152:155], v[184:187], v[208:211]
    v_mfma_f32_16x16x32_bf16 v[212:215], v[156:159], v[184:187], v[212:215]
    s_waitcnt lgkmcnt(0)
    v_mfma_f32_16x16x32_bf16 v[216:219], v[152:155], v[188:191], v[216:219]
    v_mfma_f32_16x16x32_bf16 v[220:223], v[156:159], v[188:191], v[220:223]
    s_cmp_ge_u32 s3, 27
    s_cbranch_scc0 A_vdel
    v_cvt_pk_bf16_f32 v192, v192, v196
    v_cvt_pk_bf16_f32 v193, v193, v197
    v_cvt_pk_bf16_f32 v194, v194, v198
    v_cvt_pk_bf16_f32 v195, v195, v199
    buffer_store_dwordx4 v[192:195], v7, s[16:19], s50 offen offset:0 sc1
    v_cvt_pk_bf16_f32 v200, v200, v204
    v_cvt_pk_bf16_f32 v201, v201, v205
    v_cvt_pk_bf16_f32 v202, v202, v206
    v_cvt_pk_bf16_f32 v203, v203, v207
    buffer_store_dwordx4 v[200:203], v7, s[16:19], s50 offen offset:256 sc1
    v_cvt_pk_bf16_f32 v208, v208, v212
    v_cvt_pk_bf16_f32 v209, v209, v213
    v_cvt_pk_bf16_f32 v210, v210, v214
    v_cvt_pk_bf16_f32 v211, v211, v215
    buffer_store_dwordx4 v[208:211], v7, s[16:19], s50 offen offset:512 sc1
    v_cvt_pk_bf16_f32 v216, v216, v220
    v_cvt_pk_bf16_f32 v217, v217, v221
    v_cvt_pk_bf16_f32 v218, v218, v222
    v_cvt_pk_bf16_f32 v219, v219, v223
    buffer_store_dwordx4 v[216:219], v7, s[16:19], s50 offen offset:768 sc1
A_vdel:
    v_add_u32 v3, 0xfffe4000, v3
    v_add_u32 v4, 0xfffe4000, v4
    v_add_u32 v5, 0xfffe4000, v5
    v_add_u32 v6, 0xfffe4000, v6
    s_cmp_ge_u32 s3, 27
    s_cbranch_scc1 A_single
    s_barrier
    s_setprio 2
    ds_read_b64_tr_b16 v[160:161], v3 offset:0
    ds_read_b64_tr_b16 v[162:163], v3 offset:512
    ds_read_b64_tr_b16 v[164:165], v4 offset:0
    ds_read_b64_tr_b16 v[166:167], v4 offset:512
    ds_read_b64_tr_b16 v[168:169], v5 offset:0
    ds_read_b64_tr_b16 v[170:171], v5 offset:512
    ds_read_b64_tr_b16 v[172:173], v6 offset:0
    ds_read_b64_tr_b16 v[174:175], v6 offset:512
    s_waitcnt lgkmcnt(4)
    v_mfma_f32_16x16x32_bf16 v[224:227], v[16:19], v[160:163], 0
    ds_read_b64_tr_b16 v[176:177], v3 offset:4096
    v_mfma_f32_16x16x32_bf16 v[228:231], v[20:23], v[160:163], 0
    ds_read_b64_tr_b16 v[178:179], v3 offset:4608
    v_mfma_f32_16x16x32_bf16 v[232:235], v[16:19], v[164:167], 0
    ds_read_b64_tr_b16 v[180:181], v4 offset:4096
    v_mfma_f32_16x16x32_bf16 v[236:239], v[20:23], v[164:167], 0
    ds_read_b64_tr_b16 v[182:183], v4 offset:4608
    s_waitcnt lgkmcnt(4)
    v_mfma_f32_16x16x32_bf16 v[240:243], v[16:19], v[168:171], 0
    ds_read_b64_tr_b16 v[184:185], v5 offset:4096
    v_mfma_f32_16x16x32_bf16 v[244:247], v[20:23], v[168:171], 0
    ds_read_b64_tr_b16 v[186:187], v5 offset:4608
    v_mfma_f32_16x16x32_bf16 v[248:251], v[16:19], v[172:175], 0
    ds_read_b64_tr_b16 v[188:189], v6 offset:4096
    v_mfma_f32_16x16x32_bf16 v[252:255], v[20:23], v[172:175], 0
    ds_read_b64_tr_b16 v[190:191], v6 offset:4608
    s_waitcnt lgkmcnt(4)
    v_mfma_f32_16x16x32_bf16 v[224:227], v[24:27], v[176:179], v[224:227]
    ds_read_b64_tr_b16 v[160:161], v3 offset:8192
    v_mfma_f32_16x16x32_bf16 v[228:231], v[28:31], v[176:179], v[228:231]
    ds_read_b64_tr_b16 v[162:163], v3 offset:8704
    v_mfma_f32_16x16x32_bf16 v[232:235], v[24:27], v[180:183], v[232:235]
    ds_read_b64_tr_b16 v[164:165], v4 offset:8192
    v_mfma_f32_16x16x32_bf16 v[236:239], v[28:31], v[180:183], v[236:239]
    ds_read_b64_tr_b16 v[166:167], v4 offset:8704
    s_waitcnt lgkmcnt(4)
    v_mfma_f32_16x16x32_bf16 v[240:243], v[24:27], v[184:187], v[240:243]
    ds_read_b64_tr_b16 v[168:169], v5 offset:8192
    v_mfma_f32_16x16x32_bf16 v[244:247], v[28:31], v[184:187], v[244:247]
    ds_read_b64_tr_b16 v[170:171], v5 offset:8704
    v_mfma_f32_16x16x32_bf16 v[248:251], v[24:27], v[188:191], v[248:251]
    ds_read_b64_tr_b16 v[172:173], v6 offset:8192
    v_mfma_f32_16x16x32_bf16 v[252:255], v[28:31], v[188:191], v[252:255]
    ds_read_b64_tr_b16 v[174:175], v6 offset:8704
    s_waitcnt lgkmcnt(4)
    v_mfma_f32_16x16x32_bf16 v[224:227], v[32:35], v[160:163], v[224:227]
    ds_read_b64_tr_b16 v[176:177], v3 offset:12288
    v_mfma_f32_16x16x32_bf16 v[228:231], v[36:39], v[160:163], v[228:231]
    ds_read_b64_tr_b16 v[178:179], v3 offset:12800
    v_mfma_f32_16x16x32_bf16 v[232:235], v[32:35], v[164:167], v[232:235]
    ds_read_b64_tr_b16 v[180:181], v4 offset:12288
    v_mfma_f32_16x16x32_bf16 v[236:239], v[36:39], v[164:167], v[236:239]
    ds_read_b64_tr_b16 v[182:183], v4 offset:12800
    s_waitcnt lgkmcnt(4)
    v_mfma_f32_16x16x32_bf16 v[240:243], v[32:35], v[168:171], v[240:243]
    ds_read_b64_tr_b16 v[184:185], v5 offset:12288
    v_mfma_f32_16x16x32_bf16 v[244:247], v[36:39], v[168:171], v[244:247]
    ds_read_b64_tr_b16 v[186:187], v5 offset:12800
    v_mfma_f32_16x16x32_bf16 v[248:251], v[32:35], v[172:175], v[248:251]
    ds_read_b64_tr_b16 v[188:189], v6 offset:12288
    v_mfma_f32_16x16x32_bf16 v[252:255], v[36:39], v[172:175], v[252:255]
    ds_read_b64_tr_b16 v[190:191], v6 offset:12800
    s_waitcnt lgkmcnt(4)
    v_mfma_f32_16x16x32_bf16 v[224:227], v[40:43], v[176:179], v[224:227]
    ds_read_b64_tr_b16 v[160:161], v3 offset:16384
    v_mfma_f32_16x16x32_bf16 v[228:231], v[44:47], v[176:179], v[228:231]
    ds_read_b64_tr_b16 v[162:163], v3 offset:16896
    v_mfma_f32_16x16x32_bf16 v[232:235], v[40:43], v[180:183], v[232:235]
    ds_read_b64_tr_b16 v[164:165], v4 offset:16384
    v_mfma_f32_16x16x32_bf16 v[236:239], v[44:47], v[180:183], v[236:239]
    ds_read_b64_tr_b16 v[166:167], v4 offset:16896
    s_waitcnt lgkmcnt(4)
    v_mfma_f32_16x16x32_bf16 v[240:243], v[40:43], v[184:187], v[240:243]
    ds_read_b64_tr_b16 v[168:169], v5 offset:16384
    v_mfma_f32_16x16x32_bf16 v[244:247], v[44:47], v[184:187], v[244:247]
    ds_read_b64_tr_b16 v[170:171], v5 offset:16896
    v_mfma_f32_16x16x32_bf16 v[248:251], v[40:43], v[188:191], v[248:251]
    ds_read_b64_tr_b16 v[172:173], v6 offset:16384
    v_mfma_f32_16x16x32_bf16 v[252:255], v[44:47], v[188:191], v[252:255]
    ds_read_b64_tr_b16 v[174:175], v6 offset:16896
    s_waitcnt lgkmcnt(4)
    v_mfma_f32_16x16x32_bf16 v[224:227], v[48:51], v[160:163], v[224:227]
    ds_read_b64_tr_b16 v[176:177], v3 offset:20480
    v_mfma_f32_16x16x32_bf16 v[228:231], v[52:55], v[160:163], v[228:231]
    ds_read_b64_tr_b16 v[178:179], v3 offset:20992
    v_mfma_f32_16x16x32_bf16 v[232:235], v[48:51], v[164:167], v[232:235]
    ds_read_b64_tr_b16 v[180:181], v4 offset:20480
    v_mfma_f32_16x16x32_bf16 v[236:239], v[52:55], v[164:167], v[236:239]
    ds_read_b64_tr_b16 v[182:183], v4 offset:20992
    s_waitcnt lgkmcnt(4)
    v_mfma_f32_16x16x32_bf16 v[240:243], v[48:51], v[168:171], v[240:243]
    ds_read_b64_tr_b16 v[184:185], v5 offset:20480
    v_mfma_f32_16x16x32_bf16 v[244:247], v[52:55], v[168:171], v[244:247]
    ds_read_b64_tr_b16 v[186:187], v5 offset:20992
    v_mfma_f32_16x16x32_bf16 v[248:251], v[48:51], v[172:175], v[248:251]
    ds_read_b64_tr_b16 v[188:189], v6 offset:20480
    v_mfma_f32_16x16x32_bf16 v[252:255], v[52:55], v[172:175], v[252:255]
    ds_read_b64_tr_b16 v[190:191], v6 offset:20992
    s_sub_u32 s28, s13, 10
    s_cmp_ge_u32 s28, 4
    s_cbranch_scc1 A_vdel2
    v_cvt_pk_bf16_f32 v192, v192, v196
    v_cvt_pk_bf16_f32 v193, v193, v197
    v_cvt_pk_bf16_f32 v194, v194, v198
    v_cvt_pk_bf16_f32 v195, v195, v199
    buffer_store_dwordx4 v[192:195], v7, s[16:19], s50 offen offset:0 sc1
    v_cvt_pk_bf16_f32 v200, v200, v204
    v_cvt_pk_bf16_f32 v201, v201, v205
    v_cvt_pk_bf16_f32 v202, v202, v206
    v_cvt_pk_bf16_f32 v203, v203, v207
    buffer_store_dwordx4 v[200:203], v7, s[16:19], s50 offen offset:256 sc1
    v_cvt_pk_bf16_f32 v208, v208, v212
    v_cvt_pk_bf16_f32 v209, v209, v213
    v_cvt_pk_bf16_f32 v210, v210, v214
    v_cvt_pk_bf16_f32 v211, v211, v215
    buffer_store_dwordx4 v[208:211], v7, s[16:19], s50 offen offset:512 sc1
    v_cvt_pk_bf16_f32 v216, v216, v220
    v_cvt_pk_bf16_f32 v217, v217, v221
    v_cvt_pk_bf16_f32 v218, v218, v222
    v_cvt_pk_bf16_f32 v219, v219, v223
    buffer_store_dwordx4 v[216:219], v7, s[16:19], s50 offen offset:768 sc1
A_vdel2:
    s_barrier
    s_waitcnt lgkmcnt(4)
    v_mfma_f32_16x16x32_bf16 v[224:227], v[56:59], v[176:179], v[224:227]
    ds_read_b64_tr_b16 v[160:161], v3 offset:24576
    v_mfma_f32_16x16x32_bf16 v[228:231], v[60:63], v[176:179], v[228:231]
    ds_read_b64_tr_b16 v[162:163], v3 offset:25088
    v_mfma_f32_16x16x32_bf16 v[232:235], v[56:59], v[180:183], v[232:235]
    ds_read_b64_tr_b16 v[164:165], v4 offset:24576
    v_mfma_f32_16x16x32_bf16 v[236:239], v[60:63], v[180:183], v[236:239]
    ds_read_b64_tr_b16 v[166:167], v4 offset:25088
    s_waitcnt lgkmcnt(4)
    v_mfma_f32_16x16x32_bf16 v[240:243], v[56:59], v[184:187], v[240:243]
    ds_read_b64_tr_b16 v[168:169], v5 offset:24576
    v_mfma_f32_16x16x32_bf16 v[244:247], v[60:63], v[184:187], v[244:247]
    ds_read_b64_tr_b16 v[170:171], v5 offset:25088
    v_mfma_f32_16x16x32_bf16 v[248:251], v[56:59], v[188:191], v[248:251]
    ds_read_b64_tr_b16 v[172:173], v6 offset:24576
    v_mfma_f32_16x16x32_bf16 v[252:255], v[60:63], v[188:191], v[252:255]
    ds_read_b64_tr_b16 v[174:175], v6 offset:25088
    s_waitcnt lgkmcnt(4)
    v_mfma_f32_16x16x32_bf16 v[224:227], v[64:67], v[160:163], v[224:227]
    ds_read_b64_tr_b16 v[176:177], v3 offset:28672
    v_mfma_f32_16x16x32_bf16 v[228:231], v[68:71], v[160:163], v[228:231]
    ds_read_b64_tr_b16 v[178:179], v3 offset:29184
    v_mfma_f32_16x16x32_bf16 v[232:235], v[64:67], v[164:167], v[232:235]
    ds_read_b64_tr_b16 v[180:181], v4 offset:28672
    v_mfma_f32_16x16x32_bf16 v[236:239], v[68:71], v[164:167], v[236:239]
    ds_read_b64_tr_b16 v[182:183], v4 offset:29184
    s_waitcnt lgkmcnt(4)
    v_mfma_f32_16x16x32_bf16 v[240:243], v[64:67], v[168:171], v[240:243]
    ds_read_b64_tr_b16 v[184:185], v5 offset:28672
    v_mfma_f32_16x16x32_bf16 v[244:247], v[68:71], v[168:171], v[244:247]
    ds_read_b64_tr_b16 v[186:187], v5 offset:29184
    v_mfma_f32_16x16x32_bf16 v[248:251], v[64:67], v[172:175], v[248:251]
    ds_read_b64_tr_b16 v[188:189], v6 offset:28672
    v_mfma_f32_16x16x32_bf16 v[252:255], v[68:71], v[172:175], v[252:255]
    ds_read_b64_tr_b16 v[190:191], v6 offset:29184
    s_waitcnt lgkmcnt(4)
    v_mfma_f32_16x16x32_bf16 v[224:227], v[72:75], v[176:179], v[224:227]
    ds_read_b64_tr_b16 v[160:161], v3 offset:32768
    v_mfma_f32_16x16x32_bf16 v[228:231], v[76:79], v[176:179], v[228:231]
    ds_read_b64_tr_b16 v[162:163], v3 offset:33280
    v_mfma_f32_16x16x32_bf16 v[232:235], v[72:75], v[180:183], v[232:235]
    ds_read_b64_tr_b16 v[164:165], v4 offset:32768
    v_mfma_f32_16x16x32_bf16 v[236:239], v[76:79], v[180:183], v[236:239]
    ds_read_b64_tr_b16 v[166:167], v4 offset:33280
    s_waitcnt lgkmcnt(4)
    v_mfma_f32_16x16x32_bf16 v[240:243], v[72:75], v[184:187], v[240:243]
    ds_read_b64_tr_b16 v[168:169], v5 offset:32768
    v_mfma_f32_16x16x32_bf16 v[244:247], v[76:79], v[184:187], v[244:247]
    ds_read_b64_tr_b16 v[170:171], v5 offset:33280
    v_mfma_f32_16x16x32_bf16 v[248:251], v[72:75], v[188:191], v[248:251]
    ds_read_b64_tr_b16 v[172:173], v6 offset:32768
    v_mfma_f32_16x16x32_bf16 v[252:255], v[76:79], v[188:191], v[252:255]
    ds_read_b64_tr_b16 v[174:175], v6 offset:33280
    s_waitcnt lgkmcnt(4)
    v_mfma_f32_16x16x32_bf16 v[224:227], v[80:83], v[160:163], v[224:227]
    ds_read_b64_tr_b16 v[176:177], v3 offset:36864
    v_mfma_f32_16x16x32_bf16 v[228:231], v[84:87], v[160:163], v[228:231]
    ds_read_b64_tr_b16 v[178:179], v3 offset:37376
    v_mfma_f32_16x16x32_bf16 v[232:235], v[80:83], v[164:167], v[232:235]
    ds_read_b64_tr_b16 v[180:181], v4 offset:36864
    v_mfma_f32_16x16x32_bf16 v[236:239], v[84:87], v[164:167], v[236:239]
    ds_read_b64_tr_b16 v[182:183], v4 offset:37376
    s_waitcnt lgkmcnt(4)
    v_mfma_f32_16x16x32_bf16 v[240:243], v[80:83], v[168:171], v[240:243]
    ds_read_b64_tr_b16 v[184:185], v5 offset:36864
    v_mfma_f32_16x16x32_bf16 v[244:247], v[84:87], v[168:171], v[244:247]
    ds_read_b64_tr_b16 v[186:187], v5 offset:37376
    v_mfma_f32_16x16x32_bf16 v[248:251], v[80:83], v[172:175], v[248:251]
    ds_read_b64_tr_b16 v[188:189], v6 offset:36864
    v_mfma_f32_16x16x32_bf16 v[252:255], v[84:87], v[172:175], v[252:255]
    ds_read_b64_tr_b16 v[190:191], v6 offset:37376
    s_waitcnt lgkmcnt(4)
    v_mfma_f32_16x16x32_bf16 v[224:227], v[88:91], v[176:179], v[224:227]
    ds_read_b64_tr_b16 v[160:161], v3 offset:40960
    v_mfma_f32_16x16x32_bf16 v[228:231], v[92:95], v[176:179], v[228:231]
    ds_read_b64_tr_b16 v[162:163], v3 offset:41472
    v_mfma_f32_16x16x32_bf16 v[232:235], v[88:91], v[180:183], v[232:235]
    ds_read_b64_tr_b16 v[164:165], v4 offset:40960
    v_mfma_f32_16x16x32_bf16 v[236:239], v[92:95], v[180:183], v[236:239]
    ds_read_b64_tr_b16 v[166:167], v4 offset:41472
    s_waitcnt lgkmcnt(4)
    v_mfma_f32_16x16x32_bf16 v[240:243], v[88:91], v[184:187], v[240:243]
    ds_read_b64_tr_b16 v[168:169], v5 offset:40960
    v_mfma_f32_16x16x32_bf16 v[244:247], v[92:95], v[184:187], v[244:247]
    ds_read_b64_tr_b16 v[170:171], v5 offset:41472
    v_mfma_f32_16x16x32_bf16 v[248:251], v[88:91], v[188:191], v[248:251]
    ds_read_b64_tr_b16 v[172:173], v6 offset:40960
    v_mfma_f32_16x16x32_bf16 v[252:255], v[92:95], v[188:191], v[252:255]
    ds_read_b64_tr_b16 v[174:175], v6 offset:41472
    s_waitcnt lgkmcnt(4)
    v_mfma_f32_16x16x32_bf16 v[224:227], v[96:99], v[160:163], v[224:227]
    ds_read_b64_tr_b16 v[176:177], v3 offset:45056
    v_mfma_f32_16x16x32_bf16 v[228:231], v[100:103], v[160:163], v[228:231]
    ds_read_b64_tr_b16 v[178:179], v3 offset:45568
    v_mfma_f32_16x16x32_bf16 v[232:235], v[96:99], v[164:167], v[232:235]
    ds_read_b64_tr_b16 v[180:181], v4 offset:45056
    v_mfma_f32_16x16x32_bf16 v[236:239], v[100:103], v[164:167], v[236:239]
    ds_read_b64_tr_b16 v[182:183], v4 offset:45568
    s_waitcnt lgkmcnt(4)
    v_mfma_f32_16x16x32_bf16 v[240:243], v[96:99], v[168:171], v[240:243]
    ds_read_b64_tr_b16 v[184:185], v5 offset:45056
    v_mfma_f32_16x16x32_bf16 v[244:247], v[100:103], v[168:171], v[244:247]
    ds_read_b64_tr_b16 v[186:187], v5 offset:45568
    v_mfma_f32_16x16x32_bf16 v[248:251], v[96:99], v[172:175], v[248:251]
    ds_read_b64_tr_b16 v[188:189], v6 offset:45056
    v_mfma_f32_16x16x32_bf16 v[252:255], v[100:103], v[172:175], v[252:255]
    ds_read_b64_tr_b16 v[190:191], v6 offset:45568
    s_waitcnt lgkmcnt(4)
    v_mfma_f32_16x16x32_bf16 v[224:227], v[104:107], v[176:179], v[224:227]
    ds_read_b64_tr_b16 v[160:161], v3 offset:49152
    v_mfma_f32_16x16x32_bf16 v[228:231], v[108:111], v[176:179], v[228:231]
    ds_read_b64_tr_b16 v[162:163], v3 offset:49664
    v_mfma_f32_16x16x32_bf16 v[232:235], v[104:107], v[180:183], v[232:235]
    ds_read_b64_tr_b16 v[164:165], v4 offset:49152
    v_mfma_f32_16x16x32_bf16 v[236:239], v[108:111], v[180:183], v[236:239]
    ds_read_b64_tr_b16 v[166:167], v4 offset:49664
    s_waitcnt lgkmcnt(4)
    v_mfma_f32_16x16x32_bf16 v[240:243], v[104:107], v[184:187], v[240:243]
    ds_read_b64_tr_b16 v[168:169], v5 offset:49152
    v_mfma_f32_16x16x32_bf16 v[244:247], v[108:111], v[184:187], v[244:247]
    ds_read_b64_tr_b16 v[170:171], v5 offset:49664
    v_mfma_f32_16x16x32_bf16 v[248:251], v[104:107], v[188:191], v[248:251]
    ds_read_b64_tr_b16 v[172:173], v6 offset:49152
    v_mfma_f32_16x16x32_bf16 v[252:255], v[108:111], v[188:191], v[252:255]
    ds_read_b64_tr_b16 v[174:175], v6 offset:49664
    s_waitcnt lgkmcnt(4)
    v_mfma_f32_16x16x32_bf16 v[224:227], v[112:115], v[160:163], v[224:227]
    ds_read_b64_tr_b16 v[176:177], v3 offset:53248
    v_mfma_f32_16x16x32_bf16 v[228:231], v[116:119], v[160:163], v[228:231]
    ds_read_b64_tr_b16 v[178:179], v3 offset:53760
    v_mfma_f32_16x16x32_bf16 v[232:235], v[112:115], v[164:167], v[232:235]
    ds_read_b64_tr_b16 v[180:181], v4 offset:53248
    v_mfma_f32_16x16x32_bf16 v[236:239], v[116:119], v[164:167], v[236:239]
    ds_read_b64_tr_b16 v[182:183], v4 offset:53760
    s_waitcnt lgkmcnt(4)
    v_mfma_f32_16x16x32_bf16 v[240:243], v[112:115], v[168:171], v[240:243]
    ds_read_b64_tr_b16 v[184:185], v5 offset:53248
    v_mfma_f32_16x16x32_bf16 v[244:247], v[116:119], v[168:171], v[244:247]
    ds_read_b64_tr_b16 v[186:187], v5 offset:53760
    v_mfma_f32_16x16x32_bf16 v[248:251], v[112:115], v[172:175], v[248:251]
    ds_read_b64_tr_b16 v[188:189], v6 offset:53248
    v_mfma_f32_16x16x32_bf16 v[252:255], v[116:119], v[172:175], v[252:255]
    ds_read_b64_tr_b16 v[190:191], v6 offset:53760
    s_waitcnt lgkmcnt(4)
    v_mfma_f32_16x16x32_bf16 v[224:227], v[120:123], v[176:179], v[224:227]
    ds_read_b64_tr_b16 v[160:161], v3 offset:57344
    v_mfma_f32_16x16x32_bf16 v[228:231], v[124:127], v[176:179], v[228:231]
    ds_read_b64_tr_b16 v[162:163], v3 offset:57856
    v_mfma_f32_16x16x32_bf16 v[232:235], v[120:123], v[180:183], v[232:235]
    ds_read_b64_tr_b16 v[164:165], v4 offset:57344
    v_mfma_f32_16x16x32_bf16 v[236:239], v[124:127], v[180:183], v[236:239]
    ds_read_b64_tr_b16 v[166:167], v4 offset:57856
    s_waitcnt lgkmcnt(4)
    v_mfma_f32_16x16x32_bf16 v[240:243], v[120:123], v[184:187], v[240:243]
    ds_read_b64_tr_b16 v[168:169], v5 offset:57344
    v_mfma_f32_16x16x32_bf16 v[244:247], v[124:127], v[184:187], v[244:247]
    ds_read_b64_tr_b16 v[170:171], v5 offset:57856
    v_mfma_f32_16x16x32_bf16 v[248:251], v[120:123], v[188:191], v[248:251]
    ds_read_b64_tr_b16 v[172:173], v6 offset:57344
    v_mfma_f32_16x16x32_bf16 v[252:255], v[124:127], v[188:191], v[252:255]
    ds_read_b64_tr_b16 v[174:175], v6 offset:57856
    v_add_u32 v3, 0xf000, v3
    v_add_u32 v4, 0xf000, v4
    v_add_u32 v5, 0xf000, v5
    v_add_u32 v6, 0xf000, v6
    s_waitcnt lgkmcnt(4)
    v_mfma_f32_16x16x32_bf16 v[224:227], v[128:131], v[160:163], v[224:227]
    ds_read_b64_tr_b16 v[176:177], v3 offset:0
    v_mfma_f32_16x16x32_bf16 v[228:231], v[132:135], v[160:163], v[228:231]
    ds_read_b64_tr_b16 v[178:179], v3 offset:512
    v_mfma_f32_16x16x32_bf16 v[232:235], v[128:131], v[164:167], v[232:235]
    ds_read_b64_tr_b16 v[180:181], v4 offset:0
    v_mfma_f32_16x16x32_bf16 v[236:239], v[132:135], v[164:167], v[236:239]
    ds_read_b64_tr_b16 v[182:183], v4 offset:512
    s_waitcnt lgkmcnt(4)
    v_mfma_f32_16x16x32_bf16 v[240:243], v[128:131], v[168:171], v[240:243]
    ds_read_b64_tr_b16 v[184:185], v5 offset:0
    v_mfma_f32_16x16x32_bf16 v[244:247], v[132:135], v[168:171], v[244:247]
    ds_read_b64_tr_b16 v[186:187], v5 offset:512
    v_mfma_f32_16x16x32_bf16 v[248:251], v[128:131], v[172:175], v[248:251]
    ds_read_b64_tr_b16 v[188:189], v6 offset:0
I_p1_1:
    s_cbranch_execz I_p1_r
    v_mfma_f32_16x16x32_bf16 v[252:255], v[132:135], v[172:175], v[252:255]
    ds_read_b64_tr_b16 v[190:191], v6 offset:512
    s_waitcnt lgkmcnt(4)
    v_mfma_f32_16x16x32_bf16 v[224:227], v[136:139], v[176:179], v[224:227]
    ds_read_b64_tr_b16 v[160:161], v3 offset:4096
    v_mfma_f32_16x16x32_bf16 v[228:231], v[140:143], v[176:179], v[228:231]
    ds_read_b64_tr_b16 v[162:163], v3 offset:4608
    v_mfma_f32_16x16x32_bf16 v[232:235], v[136:139], v[180:183], v[232:235]
    ds_read_b64_tr_b16 v[164:165], v4 offset:4096
    v_mfma_f32_16x16x32_bf16 v[236:239], v[140:143], v[180:183], v[236:239]
    ds_read_b64_tr_b16 v[166:167], v4 offset:4608
    s_waitcnt lgkmcnt(4)
    v_mfma_f32_16x16x32_bf16 v[240:243], v[136:139], v[184:187], v[240:243]
    ds_read_b64_tr_b16 v[168:169], v5 offset:4096
    v_mfma_f32_16x16x32_bf16 v[244:247], v[140:143], v[184:187], v[244:247]
    ds_read_b64_tr_b16 v[170:171], v5 offset:4608
    v_mfma_f32_16x16x32_bf16 v[248:251], v[136:139], v[188:191], v[248:251]
    ds_read_b64_tr_b16 v[172:173], v6 offset:4096
    v_mfma_f32_16x16x32_bf16 v[252:255], v[140:143], v[188:191], v[252:255]
    ds_read_b64_tr_b16 v[174:175], v6 offset:4608
    s_waitcnt lgkmcnt(4)
    v_mfma_f32_16x16x32_bf16 v[224:227], v[144:147], v[160:163], v[224:227]
    ds_read_b64_tr_b16 v[176:177], v3 offset:8192
    v_mfma_f32_16x16x32_bf16 v[228:231], v[148:151], v[160:163], v[228:231]
    ds_read_b64_tr_b16 v[178:179], v3 offset:8704
    v_mfma_f32_16x16x32_bf16 v[232:235], v[144:147], v[164:167], v[232:235]
    ds_read_b64_tr_b16 v[180:181], v4 offset:8192
    v_mfma_f32_16x16x32_bf16 v[236:239], v[148:151], v[164:167], v[236:239]
    ds_read_b64_tr_b16 v[182:183], v4 offset:8704
    s_waitcnt lgkmcnt(4)
    v_mfma_f32_16x16x32_bf16 v[240:243], v[144:147], v[168:171], v[240:243]
    ds_read_b64_tr_b16 v[184:185], v5 offset:8192
    v_mfma_f32_16x16x32_bf16 v[244:247], v[148:151], v[168:171], v[244:247]
    ds_read_b64_tr_b16 v[186:187], v5 offset:8704
    v_mfma_f32_16x16x32_bf16 v[248:251], v[144:147], v[172:175], v[248:251]
    ds_read_b64_tr_b16 v[188:189], v6 offset:8192
    v_mfma_f32_16x16x32_bf16 v[252:255], v[148:151], v[172:175], v[252:255]
    ds_read_b64_tr_b16 v[190:191], v6 offset:8704
    s_waitcnt lgkmcnt(4)
    v_mfma_f32_16x16x32_bf16 v[224:227], v[152:155], v[176:179], v[224:227]
    v_mfma_f32_16x16x32_bf16 v[228:231], v[156:159], v[176:179], v[228:231]
    v_mfma_f32_16x16x32_bf16 v[232:235], v[152:155], v[180:183], v[232:235]
    v_mfma_f32_16x16x32_bf16 v[236:239], v[156:159], v[180:183], v[236:239]
    s_waitcnt lgkmcnt(0)
    v_mfma_f32_16x16x32_bf16 v[240:243], v[152:155], v[184:187], v[240:243]
    v_mfma_f32_16x16x32_bf16 v[244:247], v[156:159], v[184:187], v[244:247]
    v_mfma_f32_16x16x32_bf16 v[248:251], v[152:155], v[188:191], v[248:251]
    v_mfma_f32_16x16x32_bf16 v[252:255], v[156:159], v[188:191], v[252:255]
    s_setprio 3
    s_sub_u32 s28, s13, 10
    s_cmp_lt_u32 s28, 4
    s_cbranch_scc0 A_held1
    s_waitcnt vmcnt(0)
    buffer_atomic_add v9, v10, s[16:19], 0 offen sc1
    v_cvt_pk_bf16_f32 v224, v224, v228
    v_cvt_pk_bf16_f32 v225, v225, v229
    v_cvt_pk_bf16_f32 v226, v226, v230
    v_cvt_pk_bf16_f32 v227, v227, v231
    buffer_store_dwordx4 v[224:227], v7, s[16:19], s71 offen offset:0 sc1
    v_cvt_pk_bf16_f32 v232, v232, v236
    v_cvt_pk_bf16_f32 v233, v233, v237
    v_cvt_pk_bf16_f32 v234, v234, v238
    v_cvt_pk_bf16_f32 v235, v235, v239
    buffer_store_dwordx4 v[232:235], v7, s[16:19], s71 offen offset:256 sc1
    v_cvt_pk_bf16_f32 v240, v240, v244
    v_cvt_pk_bf16_f32 v241, v241, v245
    v_cvt_pk_bf16_f32 v242, v242, v246
    v_cvt_pk_bf16_f32 v243, v243, v247
    buffer_store_dwordx4 v[240:243], v7, s[16:19], s71 offen offset:512 sc1
    v_cvt_pk_bf16_f32 v248, v248, v252
    v_cvt_pk_bf16_f32 v249, v249, v253
    v_cvt_pk_bf16_f32 v250, v250, v254
    v_cvt_pk_bf16_f32 v251, v251, v255
    buffer_store_dwordx4 v[248:251], v7, s[16:19], s71 offen offset:768 sc1
    s_waitcnt vmcnt(0)
    buffer_atomic_add v14, v13, s[16:19], 0 offen sc1
    s_branch A_attn
A_held1:
    v_mov_b32 v22, v12
    v_mov_b32 v29, v13
    v_mov_b64 v[24:25], v[8:9]
    v_mov_b32 v26, v7
    v_mov_b32 v27, v10
    v_mov_b32 v28, v14
    ds_read_b128 v[0:3], v22 offset:0
    ds_read_b128 v[4:7], v22 offset:1024
    ds_read_b128 v[8:11], v22 offset:2048
    ds_read_b128 v[12:15], v22 offset:3072
    ds_read_b128 v[16:19], v22 offset:4096
    v_cvt_pk_bf16_f32 v192, v192, v196
    v_cvt_pk_bf16_f32 v193, v193, v197
    v_cvt_pk_bf16_f32 v194, v194, v198
    v_cvt_pk_bf16_f32 v195, v195, v199
    v_cvt_pk_bf16_f32 v200, v200, v204
    v_cvt_pk_bf16_f32 v201, v201, v205
    v_cvt_pk_bf16_f32 v202, v202, v206
    v_cvt_pk_bf16_f32 v203, v203, v207
    v_cvt_pk_bf16_f32 v208, v208, v212
    v_cvt_pk_bf16_f32 v209, v209, v213
    v_cvt_pk_bf16_f32 v210, v210, v214
    v_cvt_pk_bf16_f32 v211, v211, v215
    v_cvt_pk_bf16_f32 v216, v216, v220
    v_cvt_pk_bf16_f32 v217, v217, v221
    v_cvt_pk_bf16_f32 v218, v218, v222
    v_cvt_pk_bf16_f32 v219, v219, v223
    v_cvt_pk_bf16_f32 v224, v224, v228
    v_cvt_pk_bf16_f32 v225, v225, v229
    v_cvt_pk_bf16_f32 v226, v226, v230
    v_cvt_pk_bf16_f32 v227, v227, v231
    v_cvt_pk_bf16_f32 v232, v232, v236
    v_cvt_pk_bf16_f32 v233, v233, v237
    v_cvt_pk_bf16_f32 v234, v234, v238
    v_cvt_pk_bf16_f32 v235, v235, v239
    v_cvt_pk_bf16_f32 v240, v240, v244
    v_cvt_pk_bf16_f32 v241, v241, v245
    v_cvt_pk_bf16_f32 v242, v242, v246
    v_cvt_pk_bf16_f32 v243, v243, v247
    v_cvt_pk_bf16_f32 v248, v248, v252
    v_cvt_pk_bf16_f32 v249, v249, v253
    v_cvt_pk_bf16_f32 v250, v250, v254
    v_cvt_pk_bf16_f32 v251, v251, v255
    s_mov_b32 s12, 2
    s_waitcnt vmcnt(0)
    s_branch A_post
A_st1:
    buffer_store_dwordx4 v[192:195], v26, s[16:19], s50 offen offset:0 sc1
    buffer_store_dwordx4 v[200:203], v26, s[16:19], s50 offen offset:256 sc1
    buffer_store_dwordx4 v[208:211], v26, s[16:19], s50 offen offset:512 sc1
    buffer_store_dwordx4 v[216:219], v26, s[16:19], s50 offen offset:768 sc1
    buffer_store_dwordx4 v[224:227], v26, s[16:19], s71 offen offset:0 sc1
    buffer_store_dwordx4 v[232:235], v26, s[16:19], s71 offen offset:256 sc1
    buffer_store_dwordx4 v[240:243], v26, s[16:19], s71 offen offset:512 sc1
    buffer_store_dwordx4 v[248:251], v26, s[16:19], s71 offen offset:768 sc1
    s_waitcnt vmcnt(0)
    buffer_atomic_add v25, v27, s[16:19], 0 offen sc1
    buffer_atomic_add v28, v29, s[16:19], 0 offen sc1
    s_branch A_post3
A_nan:
    s_cbranch_scc1 A_ok
    v_mov_b32 v15, 0
    s_mov_b32 exec_lo, 0x1
    s_mov_b32 exec_hi, 0x0
    s_mov_b32 s29, 0
A_poll3:
    buffer_atomic_umax v15, v19, s[16:19], s48 offen offset:0 sc0 sc1
    s_add_u32 s29, s29, 1
    s_cmp_ge_u32 s29, 262144
    s_cbranch_scc1 L_end
    s_waitcnt vmcnt(0)
    v_cmp_gt_u32 vcc, 32, v15
    s_cbranch_vccnz A_poll3
    s_mov_b64 exec, -1
    ds_read_b64_tr_b16 v[96:97], v10 offset:0
    ds_read_b64_tr_b16 v[98:99], v10 offset:144
    ds_read_b64_tr_b16 v[100:101], v10 offset:32
    ds_read_b64_tr_b16 v[102:103], v10 offset:176
    ds_read_b64_tr_b16 v[104:105], v10 offset:64
    ds_read_b64_tr_b16 v[106:107], v10 offset:208
    ds_read_b64_tr_b16 v[108:109], v10 offset:96
    ds_read_b64_tr_b16 v[110:111], v10 offset:240
    ds_read_b64_tr_b16 v[112:113], v10 offset:128
    ds_read_b64_tr_b16 v[114:115], v10 offset:272
    ds_read_b64_tr_b16 v[116:117], v10 offset:5184
    ds_read_b64_tr_b16 v[118:119], v10 offset:5328
    ds_read_b64_tr_b16 v[120:121], v10 offset:5216
    ds_read_b64_tr_b16 v[122:123], v10 offset:5360
    ds_read_b64_tr_b16 v[124:125], v10 offset:5248
    ds_read_b64_tr_b16 v[126:127], v10 offset:5392
    ds_read_b64_tr_b16 v[128:129], v10 offset:5280
    ds_read_b64_tr_b16 v[130:131], v10 offset:5424
    ds_read_b64_tr_b16 v[132:133], v10 offset:5312
    ds_read_b64_tr_b16 v[134:135], v10 offset:5456
    ds_read_b64_tr_b16 v[136:137], v10 offset:10368
    ds_read_b64_tr_b16 v[138:139], v10 offset:10512
    ds_read_b64_tr_b16 v[140:141], v10 offset:10400
    ds_read_b64_tr_b16 v[142:143], v10 offset:10544
    ds_read_b64_tr_b16 v[144:145], v10 offset:10432
    ds_read_b64_tr_b16 v[146:147], v10 offset:10576
    ds_read_b64_tr_b16 v[148:149], v10 offset:10464
    ds_read_b64_tr_b16 v[150:151], v10 offset:10608
    ds_read_b64_tr_b16 v[152:153], v10 offset:10496
    ds_read_b64_tr_b16 v[154:155], v10 offset:10640
    ds_read_b64_tr_b16 v[156:157], v10 offset:15552
    ds_read_b64_tr_b16 v[158:159], v10 offset:15696
    ds_read_b64_tr_b16 v[160:161], v10 offset:15584
    ds_read_b64_tr_b16 v[162:163], v10 offset:15728
    ds_read_b64_tr_b16 v[164:165], v10 offset:15616
    ds_read_b64_tr_b16 v[166:167], v10 offset:15760
    ds_read_b64_tr_b16 v[168:169], v10 offset:15648
    ds_read_b64_tr_b16 v[170:171], v10 offset:15792
    ds_read_b64_tr_b16 v[172:173], v10 offset:15680
    ds_read_b64_tr_b16 v[174:175], v10 offset:15824
    ds_read_b64_tr_b16 v[176:177], v10 offset:20736
    ds_read_b64_tr_b16 v[178:179], v10 offset:20880
    ds_read_b64_tr_b16 v[180:181], v10 offset:20768
    ds_read_b64_tr_b16 v[182:183], v10 offset:20912
    ds_read_b64_tr_b16 v[184:185], v10 offset:20800
    ds_read_b64_tr_b16 v[186:187], v10 offset:20944
    ds_read_b64_tr_b16 v[188:189], v10 offset:20832
    ds_read_b64_tr_b16 v[190:191], v10 offset:20976
    ds_read_b64_tr_b16 v[192:193], v10 offset:20864
    ds_read_b64_tr_b16 v[194:195], v10 offset:21008
    s_add_u32 s47, s47, 1
    s_branch A_proj
A_single:
    s_setprio 3
    v_lshlrev_b32 v9, 2, v9
    s_lshl_b32 s28, s11, 1
    s_lshl_b32 s28, 0x03030303, s28
    s_mov_b32 exec_lo, s28
    s_mov_b32 exec_hi, s28
    s_waitcnt vmcnt(0)
    s_barrier
    buffer_atomic_add v9, v10, s[16:19], 0 offen sc1
    s_mov_b64 exec, -1
A_attn:
    s_mov_b32 s12, 0
    v_mov_b32 v20, v12
    ds_read_b128 v[0:3], v20 offset:0
    ds_read_b128 v[4:7], v20 offset:1024
    ds_read_b128 v[8:11], v20 offset:2048
    ds_read_b128 v[12:15], v20 offset:3072
    ds_read_b128 v[16:19], v20 offset:4096
A_post:
    s_waitcnt lgkmcnt(0)
    v_mov_b32 v15, 0
    v_mov_b32 v20, 163776
    v_mov_b32 v21, 1
    v_mov_b64 v[30:31], -1
    v_mov_b64 v[32:33], -1
    v_lshlrev_b32 v34, 4, v0
    s_mov_b32 exec_lo, 0x20
    s_mov_b32 exec_hi, 0x0
    s_mov_b32 s29, 0
A_poll0:
    buffer_atomic_umax v15, v6, s[16:19], s44 offen offset:0 sc0 sc1
    s_add_u32 s29, s29, 1
    s_cmp_ge_u32 s29, 262144
    s_cbranch_scc1 L_end
    s_waitcnt vmcnt(0)
    v_cmp_gt_u32 vcc, 0x98, v15
    s_cbranch_vccnz A_poll0
    s_mov_b64 exec, -1
    s_add_u32 m0, s43, 97280
    s_add_u32 s28, s42, 4423680
    buffer_load_dwordx4 v1, s[16:19], s28 offen offset:0 sc1 lds
    buffer_load_dwordx4 v2, s[16:19], s28 offen offset:1024 sc1 lds
    buffer_load_dwordx4 v3, s[16:19], s28 offen offset:2048 sc1 lds
    buffer_load_dwordx4 v4, s[16:19], s28 offen offset:3072 sc1 lds
    buffer_load_dwordx4 v5, s[16:19], s28 offen offset:3840 sc1 lds
    s_mov_b64 exec, 0
    s_branch I_b_0
I_b_r:
    s_mov_b64 exec, -1
    s_waitcnt vmcnt(0)
    s_mov_b64 exec, 1
    ds_add_u32 v20, v21 offset:8
    s_mov_b32 exec_lo, 0x40
    s_mov_b32 exec_hi, 0x0
    s_mov_b32 s29, 0
A_poll1:
    buffer_atomic_umax v15, v6, s[16:19], s44 offen offset:0 sc0 sc1
    s_add_u32 s29, s29, 1
    s_cmp_ge_u32 s29, 262144
    s_cbranch_scc1 L_end
    s_waitcnt vmcnt(0)
    v_cmp_gt_u32 vcc, 0x98, v15
    s_cbranch_vccnz A_poll1
    s_mov_b64 exec, 1
    s_mov_b32 s29, 0
A_free:
    ds_read_b64 v[22:23], v20 offset:8
    s_add_u32 s29, s29, 1
    s_cmp_ge_u32 s29, 2097152
    s_cbranch_scc1 L_end
    s_waitcnt lgkmcnt(0)
    v_min_u32 v22, v22, v23
    v_cmp_gt_u32 vcc, 4, v22
    s_cbranch_vccnz A_free
    s_mov_b64 exec, -1
    s_add_u32 m0, s43, 116736
    s_add_u32 s28, s42, 5308416
    buffer_load_dwordx4 v1, s[16:19], s28 offen offset:0 sc1 lds
    buffer_load_dwordx4 v2, s[16:19], s28 offen offset:1024 sc1 lds
    buffer_load_dwordx4 v3, s[16:19], s28 offen offset:2048 sc1 lds
    buffer_load_dwordx4 v4, s[16:19], s28 offen offset:3072 sc1 lds
    buffer_load_dwordx4 v5, s[16:19], s28 offen offset:3840 sc1 lds
    s_waitcnt vmcnt(0)
    s_mov_b64 exec, 1
    ds_add_u32 v20, v21 offset:16
    s_mov_b64 exec, -1
    s_cmp_eq_u32 s12, 1
    s_cbranch_scc1 A_st0
    s_cmp_eq_u32 s12, 2
    s_cbranch_scc1 A_st1
A_post3:
    s_mov_b32 exec_lo, 0x80
    s_mov_b32 exec_hi, 0x0
    s_mov_b32 s29, 0
A_poll1b:
    buffer_atomic_umax v15, v6, s[16:19], s44 offen offset:0 sc0 sc1
    s_add_u32 s29, s29, 1
    s_cmp_ge_u32 s29, 262144
    s_cbranch_scc1 L_end
    s_waitcnt vmcnt(0)
    v_cmp_gt_u32 vcc, 0x98, v15
    s_cbranch_vccnz A_poll1b
    s_mov_b64 exec, -1
    s_add_u32 m0, s43, 136192
    s_add_u32 s28, s42, 6193152
    buffer_load_dwordx4 v1, s[16:19], s28 offen offset:0 sc1 lds
    buffer_load_dwordx4 v2, s[16:19], s28 offen offset:1024 sc1 lds
    buffer_load_dwordx4 v3, s[16:19], s28 offen offset:2048 sc1 lds
    buffer_load_dwordx4 v4, s[16:19], s28 offen offset:3072 sc1 lds
    buffer_load_dwordx4 v5, s[16:19], s28 offen offset:3840 sc1 lds
    s_waitcnt vmcnt(0)
    s_mov_b64 exec, 1
    ds_add_u32 v20, v21 offset:20
    s_mov_b32 exec_lo, 0xf
    s_mov_b32 exec_hi, 0x0
    s_mov_b32 s29, 0
A_poll1c:
    buffer_atomic_umax v15, v6, s[16:19], s44 offen offset:0 sc0 sc1
    s_add_u32 s29, s29, 1
    s_cmp_ge_u32 s29, 262144
    s_cbranch_scc1 L_end
    s_waitcnt vmcnt(0)
    v_cmp_gt_u32 vcc, 0x98, v15
    s_cbranch_vccnz A_poll1c
    s_mov_b64 exec, -1
    s_add_u32 m0, s43, 0
    s_add_u32 s28, s42, 0
    buffer_load_dwordx4 v1, s[16:19], s28 offen offset:0 sc1 lds
    buffer_load_dwordx4 v2, s[16:19], s28 offen offset:1024 sc1 lds
    buffer_load_dwordx4 v3, s[16:19], s28 offen offset:2048 sc1 lds
    buffer_load_dwordx4 v4, s[16:19], s28 offen offset:3072 sc1 lds
    buffer_load_dwordx4 v5, s[16:19], s28 offen offset:3840 sc1 lds
    s_add_u32 m0, s43, 19456
    s_add_u32 s28, s42, 884736
    buffer_load_dwordx4 v1, s[16:19], s28 offen offset:0 sc1 lds
    buffer_load_dwordx4 v2, s[16:19], s28 offen offset:1024 sc1 lds
    buffer_load_dwordx4 v3, s[16:19], s28 offen offset:2048 sc1 lds
    buffer_load_dwordx4 v4, s[16:19], s28 offen offset:3072 sc1 lds
    buffer_load_dwordx4 v5, s[16:19], s28 offen offset:3840 sc1 lds
    s_add_u32 m0, s43, 38912
    s_add_u32 s28, s42, 1769472
    buffer_load_dwordx4 v1, s[16:19], s28 offen offset:0 sc1 lds
    buffer_load_dwordx4 v2, s[16:19], s28 offen offset:1024 sc1 lds
    buffer_load_dwordx4 v3, s[16:19], s28 offen offset:2048 sc1 lds
    buffer_load_dwordx4 v4, s[16:19], s28 offen offset:3072 sc1 lds
    buffer_load_dwordx4 v5, s[16:19], s28 offen offset:3840 sc1 lds
    s_waitcnt vmcnt(5)
    s_mov_b64 exec, 1
    ds_add_u32 v20, v21 offset:24
    s_mov_b64 exec, -1
    s_add_u32 m0, s43, 58368
    s_add_u32 s28, s42, 2654208
    buffer_load_dwordx4 v1, s[16:19], s28 offen offset:0 sc1 lds
    buffer_load_dwordx4 v2, s[16:19], s28 offen offset:1024 sc1 lds
    buffer_load_dwordx4 v3, s[16:19], s28 offen offset:2048 sc1 lds
    buffer_load_dwordx4 v4, s[16:19], s28 offen offset:3072 sc1 lds
    buffer_load_dwordx4 v5, s[16:19], s28 offen offset:3840 sc1 lds
    s_mov_b32 s20, s52
    s_mov_b32 s21, s53
    s_mov_b32 s22, 663552
    s_mov_b32 s23, 0x00020000
    s_mov_b32 s24, s54
    s_mov_b32 s25, s55
    s_mov_b32 s26, 2359296
    s_mov_b32 s27, 0x00020000
    v_add_u32 v13, s70, v13
    v_add_u32 v14, s70, v14
    s_mov_b32 exec_lo, 0x1
    s_mov_b32 exec_hi, 0x0
    s_mov_b32 s29, 0
A_pollgo2:
    buffer_load_dword v15, v19, s[60:63], 0 offen offset:128 sc1
    s_add_u32 s29, s29, 1
    s_cmp_ge_u32 s29, 262144
    s_cbranch_scc1 L_end
    s_waitcnt vmcnt(0)
    v_cmp_eq_u32 vcc, 0, v15
    s_cbranch_vccnz A_pollgo2
    s_mov_b64 exec, 1
    ds_add_u32 v20, v21 offset:56
    s_mov_b64 exec, -1
    s_mov_b64 exec, 1
    s_mov_b32 s29, 0
A_top0:
    ds_read2_b32 v[22:23], v20 offset0:14 offset1:12
    s_add_u32 s29, s29, 1
    s_cmp_ge_u32 s29, 2097152
    s_cbranch_scc1 L_end
    s_waitcnt lgkmcnt(0)
    v_min_u32 v22, v22, v23
    v_cmp_gt_u32 vcc, 4, v22
    s_cbranch_vccnz A_top0
    s_mov_b64 exec, -1
    s_mov_b32 s29, 0
A_wo0:
    s_mov_b32 m0, s46
    s_add_u32 s29, s29, 1
    buffer_load_dwordx4 v7, s[20:23], s45 offen lds
    s_add_u32 s45, s45, 32256
    s_add_u32 s46, s46, 4032
    s_cmp_lt_u32 s29, 14
    s_cbranch_scc1 A_wo0
    s_bfe_u32 s28, s2, 0x30003
    s_lshl2_add_u32 s28, s28, s11
    s_lshl_b32 s28, s28, 5
    s_add_u32 s28, s28, s15
    s_mul_i32 s28, s28, 2304
    s_add_u32 s28, s28, 7077888
    buffer_store_dwordx4 v[30:33], v34, s[16:19], s28 offen offset:0 sc1
    buffer_store_dwordx4 v[30:33], v34, s[16:19], s28 offen offset:1024 sc1
    buffer_store_dwordx4 v[30:33], v34, s[16:19], s28 offen offset:1280 sc1
    s_waitcnt vmcnt(0)
    s_mov_b64 exec, 1
    ds_add_u32 v20, v21 offset:28
    s_mov_b64 exec, 1
    s_mov_b32 s29, 0
A_top1:
    ds_read_b32 v22, v20 offset:52
    s_add_u32 s29, s29, 1
    s_cmp_ge_u32 s29, 2097152
    s_cbranch_scc1 L_end
    s_waitcnt lgkmcnt(0)
    v_cmp_gt_u32 vcc, 4, v22
    s_cbranch_vccnz A_top1
    s_mov_b64 exec, -1
    s_mov_b32 s29, 0
A_wo1:
    s_mov_b32 m0, s46
    s_add_u32 s29, s29, 1
    buffer_load_dwordx4 v7, s[20:23], s45 offen lds
    s_add_u32 s45, s45, 32256
    s_add_u32 s46, s46, 4032
    s_cmp_lt_u32 s29, 7
    s_cbranch_scc1 A_wo1
    s_waitcnt vmcnt(0)
    s_lshl_b32 s75, s11, 11
    s_add_u32 s75, s75, 32768
    v_lshrrev_b32 v7, 4, v0
    v_lshlrev_b32 v7, 8, v7
    v_and_b32 v6, 15, v0
    v_lshl_add_u32 v7, v6, 2, v7
    v_add_u32 v7, s75, v7
    v_add_u32 v6, 0x400, v7
    v_mov_b32 v3, 0x207
    s_mov_b32 s47, 0
    s_and_b32 s48, s69, 0xfffffc00
    s_add_u32 s48, s48, 32768
    s_mov_b64 exec, 0
    s_branch I_t_0
I_t_r:
    s_mov_b64 exec, -1
    s_barrier
    ds_read_b64_tr_b16 v[96:97], v10 offset:0
    ds_read_b64_tr_b16 v[98:99], v10 offset:144
    ds_read_b64_tr_b16 v[100:101], v10 offset:32
    ds_read_b64_tr_b16 v[102:103], v10 offset:176
    ds_read_b64_tr_b16 v[104:105], v10 offset:64
    ds_read_b64_tr_b16 v[106:107], v10 offset:208
    ds_read_b64_tr_b16 v[108:109], v10 offset:96
    ds_read_b64_tr_b16 v[110:111], v10 offset:240
    ds_read_b64_tr_b16 v[112:113], v10 offset:128
    ds_read_b64_tr_b16 v[114:115], v10 offset:272
    ds_read_b64_tr_b16 v[116:117], v10 offset:5184
    ds_read_b64_tr_b16 v[118:119], v10 offset:5328
    ds_read_b64_tr_b16 v[120:121], v10 offset:5216
    ds_read_b64_tr_b16 v[122:123], v10 offset:5360
    ds_read_b64_tr_b16 v[124:125], v10 offset:5248
    ds_read_b64_tr_b16 v[126:127], v10 offset:5392
    ds_read_b64_tr_b16 v[128:129], v10 offset:5280
    ds_read_b64_tr_b16 v[130:131], v10 offset:5424
    ds_read_b64_tr_b16 v[132:133], v10 offset:5312
    ds_read_b64_tr_b16 v[134:135], v10 offset:5456
    s_cmp_lg_u32 s11, 0
    s_cbranch_scc1 A_poll2f
    s_mov_b64 exec, 1
    s_mov_b32 s29, 0
    v_mov_b32 v1, 0
    buffer_atomic_add v1, v19, s[16:19], s69 offen sc0 sc1
    s_mov_b64 exec, -1
A_poll2f:
    ds_read_b64_tr_b16 v[136:137], v10 offset:10368
    ds_read_b64_tr_b16 v[138:139], v10 offset:10512
    ds_read_b64_tr_b16 v[140:141], v10 offset:10400
    ds_read_b64_tr_b16 v[142:143], v10 offset:10544
    ds_read_b64_tr_b16 v[144:145], v10 offset:10432
    ds_read_b64_tr_b16 v[146:147], v10 offset:10576
    ds_read_b64_tr_b16 v[148:149], v10 offset:10464
    ds_read_b64_tr_b16 v[150:151], v10 offset:10608
    ds_read_b64_tr_b16 v[152:153], v10 offset:10496
    ds_read_b64_tr_b16 v[154:155], v10 offset:10640
    ds_read_b64_tr_b16 v[156:157], v10 offset:15552
    ds_read_b64_tr_b16 v[158:159], v10 offset:15696
    ds_read_b64_tr_b16 v[160:161], v10 offset:15584
    ds_read_b64_tr_b16 v[162:163], v10 offset:15728
    ds_read_b64_tr_b16 v[164:165], v10 offset:15616
    ds_read_b64_tr_b16 v[166:167], v10 offset:15760
    ds_read_b64_tr_b16 v[168:169], v10 offset:15648
    ds_read_b64_tr_b16 v[170:171], v10 offset:15792
    ds_read_b64_tr_b16 v[172:173], v10 offset:15680
    ds_read_b64_tr_b16 v[174:175], v10 offset:15824
    ds_read_b64_tr_b16 v[176:177], v10 offset:20736
    ds_read_b64_tr_b16 v[178:179], v10 offset:20880
    ds_read_b64_tr_b16 v[180:181], v10 offset:20768
    ds_read_b64_tr_b16 v[182:183], v10 offset:20912
    ds_read_b64_tr_b16 v[184:185], v10 offset:20800
    ds_read_b64_tr_b16 v[186:187], v10 offset:20944
    ds_read_b64_tr_b16 v[188:189], v10 offset:20832
    ds_read_b64_tr_b16 v[190:191], v10 offset:20976
    ds_read_b64_tr_b16 v[192:193], v10 offset:20864
    ds_read_b64_tr_b16 v[194:195], v10 offset:21008
    s_cbranch_scc1 A_got2
    s_mov_b64 exec, 1
A_poll2:
    v_mov_b32 v2, 0
    buffer_atomic_add v2, v19, s[16:19], s69 offen sc0 sc1
    s_waitcnt vmcnt(1)
    v_cmp_gt_u32 vcc, 32, v1
    s_cbranch_vccz A_poll2d
    v_mov_b32 v1, 0
    buffer_atomic_add v1, v19, s[16:19], s69 offen sc0 sc1
    s_waitcnt vmcnt(1)
    v_cmp_gt_u32 vcc, 32, v2
    s_cbranch_vccz A_poll2d
    s_add_u32 s29, s29, 1
    s_cmp_lt_u32 s29, 262144
    s_cbranch_scc1 A_poll2
    s_branch L_end
A_poll2d:
    s_mov_b64 exec, -1
A_got2:
    s_barrier
A_proj:
    s_add_u32 s33, s66, 0
    buffer_load_dwordx4 v[40:43], v8, s[16:19], s33 offen sc1
    ds_read_b64_tr_b16 v[196:197], v10 offset:25920
    ds_read_b64_tr_b16 v[198:199], v10 offset:26064
    ds_read_b64_tr_b16 v[200:201], v10 offset:25952
    ds_read_b64_tr_b16 v[202:203], v10 offset:26096
    s_add_u32 s33, s66, 4608
    buffer_load_dwordx4 v[44:47], v8, s[16:19], s33 offen sc1
    ds_read_b64_tr_b16 v[204:205], v10 offset:25984
    ds_read_b64_tr_b16 v[206:207], v10 offset:26128
    ds_read_b64_tr_b16 v[208:209], v10 offset:26016
    ds_read_b64_tr_b16 v[210:211], v10 offset:26160
    s_add_u32 s33, s66, 9216
    buffer_load_dwordx4 v[48:51], v8, s[16:19], s33 offen sc1
    ds_read_b64_tr_b16 v[212:213], v10 offset:26048
    ds_read_b64_tr_b16 v[214:215], v10 offset:26192
    ds_read_b64_tr_b16 v[216:217], v10 offset:31104
    ds_read_b64_tr_b16 v[218:219], v10 offset:31248
    s_add_u32 s33, s66, 13824
    buffer_load_dwordx4 v[52:55], v8, s[16:19], s33 offen sc1
    ds_read_b64_tr_b16 v[220:221], v10 offset:31136
    ds_read_b64_tr_b16 v[222:223], v10 offset:31280
    ds_read_b64_tr_b16 v[224:225], v10 offset:31168
    s_add_u32 s33, s66, 18432
    buffer_load_dwordx4 v[56:59], v8, s[16:19], s33 offen sc1
    ds_read_b64_tr_b16 v[226:227], v10 offset:31312
    ds_read_b64_tr_b16 v[228:229], v10 offset:31200
    ds_read_b64_tr_b16 v[230:231], v10 offset:31344
    s_add_u32 s33, s66, 23040
    buffer_load_dwordx4 v[60:63], v8, s[16:19], s33 offen sc1
    ds_read_b64_tr_b16 v[232:233], v10 offset:31232
    ds_read_b64_tr_b16 v[234:235], v10 offset:31376
    ds_read_b64_tr_b16 v[236:237], v10 offset:36288
    s_add_u32 s33, s66, 27648
    buffer_load_dwordx4 v[64:67], v8, s[16:19], s33 offen sc1
    ds_read_b64_tr_b16 v[238:239], v10 offset:36432
    ds_read_b64_tr_b16 v[240:241], v10 offset:36320
    ds_read_b64_tr_b16 v[242:243], v10 offset:36464
    s_add_u32 s33, s66, 32256
    buffer_load_dwordx4 v[68:71], v8, s[16:19], s33 offen sc1
    ds_read_b64_tr_b16 v[244:245], v10 offset:36352
    ds_read_b64_tr_b16 v[246:247], v10 offset:36496
    ds_read_b64_tr_b16 v[248:249], v10 offset:36384
    s_add_u32 s33, s66, 36864
    buffer_load_dwordx4 v[72:75], v8, s[16:19], s33 offen sc1
    ds_read_b64_tr_b16 v[250:251], v10 offset:36528
    ds_read_b64_tr_b16 v[252:253], v10 offset:36416
    ds_read_b64_tr_b16 v[254:255], v10 offset:36560
    s_add_u32 s33, s66, 41472
    buffer_load_dwordx4 v[76:79], v8, s[16:19], s33 offen sc1
    s_waitcnt vmcnt(9) lgkmcnt(0)
    v_mfma_f32_16x16x32_bf16 v[20:23], v[96:99], v[40:43], 0
    ds_read_b64_tr_b16 v[96:97], v11 offset:0
    v_mfma_f32_16x16x32_bf16 v[24:27], v[100:103], v[40:43], 0
    ds_read_b64_tr_b16 v[98:99], v11 offset:144
    v_mfma_f32_16x16x32_bf16 v[28:31], v[104:107], v[40:43], 0
    ds_read_b64_tr_b16 v[100:101], v11 offset:32
    v_mfma_f32_16x16x32_bf16 v[32:35], v[108:111], v[40:43], 0
    ds_read_b64_tr_b16 v[102:103], v11 offset:176
    v_mfma_f32_16x16x32_bf16 v[36:39], v[112:115], v[40:43], 0
    ds_read_b64_tr_b16 v[104:105], v11 offset:64
    ds_read_b64_tr_b16 v[106:107], v11 offset:208
    ds_read_b64_tr_b16 v[108:109], v11 offset:96
    s_add_u32 s33, s66, 46080
    buffer_load_dwordx4 v[80:83], v8, s[16:19], s33 offen sc1
    s_waitcnt vmcnt(9)
    v_mfma_f32_16x16x32_bf16 v[20:23], v[116:119], v[44:47], v[20:23]
    ds_read_b64_tr_b16 v[110:111], v11 offset:240
    v_mfma_f32_16x16x32_bf16 v[24:27], v[120:123], v[44:47], v[24:27]
    ds_read_b64_tr_b16 v[112:113], v11 offset:128
    v_mfma_f32_16x16x32_bf16 v[28:31], v[124:127], v[44:47], v[28:31]
    ds_read_b64_tr_b16 v[114:115], v11 offset:272
    v_mfma_f32_16x16x32_bf16 v[32:35], v[128:131], v[44:47], v[32:35]
    ds_read_b64_tr_b16 v[116:117], v11 offset:5184
    v_mfma_f32_16x16x32_bf16 v[36:39], v[132:135], v[44:47], v[36:39]
    ds_read_b64_tr_b16 v[118:119], v11 offset:5328
    ds_read_b64_tr_b16 v[120:121], v11 offset:5216
    ds_read_b64_tr_b16 v[122:123], v11 offset:5360
    s_add_u32 s33, s66, 50688
    buffer_load_dwordx4 v[84:87], v8, s[16:19], s33 offen sc1
    s_waitcnt vmcnt(9)
    v_mfma_f32_16x16x32_bf16 v[20:23], v[136:139], v[48:51], v[20:23]
    ds_read_b64_tr_b16 v[124:125], v11 offset:5248
    v_mfma_f32_16x16x32_bf16 v[24:27], v[140:143], v[48:51], v[24:27]
    ds_read_b64_tr_b16 v[126:127], v11 offset:5392
    v_mfma_f32_16x16x32_bf16 v[28:31], v[144:147], v[48:51], v[28:31]
    ds_read_b64_tr_b16 v[128:129], v11 offset:5280
    v_mfma_f32_16x16x32_bf16 v[32:35], v[148:151], v[48:51], v[32:35]
    ds_read_b64_tr_b16 v[130:131], v11 offset:5424
    v_mfma_f32_16x16x32_bf16 v[36:39], v[152:155], v[48:51], v[36:39]
    ds_read_b64_tr_b16 v[132:133], v11 offset:5312
    ds_read_b64_tr_b16 v[134:135], v11 offset:5456
    ds_read_b64_tr_b16 v[136:137], v11 offset:10368
    s_add_u32 s33, s66, 55296
    buffer_load_dwordx4 v[40:43], v8, s[16:19], s33 offen sc1
    s_waitcnt vmcnt(9)
    v_mfma_f32_16x16x32_bf16 v[20:23], v[156:159], v[52:55], v[20:23]
    ds_read_b64_tr_b16 v[138:139], v11 offset:10512
I_t_0:
    s_cbranch_execz I_t_r
    v_mfma_f32_16x16x32_bf16 v[24:27], v[160:163], v[52:55], v[24:27]
    ds_read_b64_tr_b16 v[140:141], v11 offset:10400
    v_mfma_f32_16x16x32_bf16 v[28:31], v[164:167], v[52:55], v[28:31]
    ds_read_b64_tr_b16 v[142:143], v11 offset:10544
    v_mfma_f32_16x16x32_bf16 v[32:35], v[168:171], v[52:55], v[32:35]
    ds_read_b64_tr_b16 v[144:145], v11 offset:10432
    v_mfma_f32_16x16x32_bf16 v[36:39], v[172:175], v[52:55], v[36:39]
    ds_read_b64_tr_b16 v[146:147], v11 offset:10576
    ds_read_b64_tr_b16 v[148:149], v11 offset:10464
    ds_read_b64_tr_b16 v[150:151], v11 offset:10608
    s_add_u32 s33, s66, 59904
    buffer_load_dwordx4 v[44:47], v8, s[16:19], s33 offen sc1
    s_waitcnt vmcnt(9)
    v_mfma_f32_16x16x32_bf16 v[20:23], v[176:179], v[56:59], v[20:23]
    ds_read_b64_tr_b16 v[152:153], v11 offset:10496
    v_mfma_f32_16x16x32_bf16 v[24:27], v[180:183], v[56:59], v[24:27]
    ds_read_b64_tr_b16 v[154:155], v11 offset:10640
    v_mfma_f32_16x16x32_bf16 v[28:31], v[184:187], v[56:59], v[28:31]
    ds_read_b64_tr_b16 v[156:157], v11 offset:15552
    v_mfma_f32_16x16x32_bf16 v[32:35], v[188:191], v[56:59], v[32:35]
    ds_read_b64_tr_b16 v[158:159], v11 offset:15696
    v_mfma_f32_16x16x32_bf16 v[36:39], v[192:195], v[56:59], v[36:39]
    ds_read_b64_tr_b16 v[160:161], v11 offset:15584
    ds_read_b64_tr_b16 v[162:163], v11 offset:15728
    ds_read_b64_tr_b16 v[164:165], v11 offset:15616
    s_add_u32 s33, s66, 64512
    buffer_load_dwordx4 v[48:51], v8, s[16:19], s33 offen sc1
    s_waitcnt vmcnt(9)
    v_mfma_f32_16x16x32_bf16 v[20:23], v[196:199], v[60:63], v[20:23]
    ds_read_b64_tr_b16 v[166:167], v11 offset:15760
    v_mfma_f32_16x16x32_bf16 v[24:27], v[200:203], v[60:63], v[24:27]
    ds_read_b64_tr_b16 v[168:169], v11 offset:15648
    v_mfma_f32_16x16x32_bf16 v[28:31], v[204:207], v[60:63], v[28:31]
    ds_read_b64_tr_b16 v[170:171], v11 offset:15792
    v_mfma_f32_16x16x32_bf16 v[32:35], v[208:211], v[60:63], v[32:35]
    ds_read_b64_tr_b16 v[172:173], v11 offset:15680
    v_mfma_f32_16x16x32_bf16 v[36:39], v[212:215], v[60:63], v[36:39]
    ds_read_b64_tr_b16 v[174:175], v11 offset:15824
    ds_read_b64_tr_b16 v[176:177], v11 offset:20736
    ds_read_b64_tr_b16 v[178:179], v11 offset:20880
    s_add_u32 s33, s66, 69120
    buffer_load_dwordx4 v[52:55], v8, s[16:19], s33 offen sc1
    s_waitcnt vmcnt(9)
    v_mfma_f32_16x16x32_bf16 v[20:23], v[216:219], v[64:67], v[20:23]
    ds_read_b64_tr_b16 v[180:181], v11 offset:20768
    v_mfma_f32_16x16x32_bf16 v[24:27], v[220:223], v[64:67], v[24:27]
    ds_read_b64_tr_b16 v[182:183], v11 offset:20912
    v_mfma_f32_16x16x32_bf16 v[28:31], v[224:227], v[64:67], v[28:31]
    ds_read_b64_tr_b16 v[184:185], v11 offset:20800
    v_mfma_f32_16x16x32_bf16 v[32:35], v[228:231], v[64:67], v[32:35]
    ds_read_b64_tr_b16 v[186:187], v11 offset:20944
    v_mfma_f32_16x16x32_bf16 v[36:39], v[232:235], v[64:67], v[36:39]
    ds_read_b64_tr_b16 v[188:189], v11 offset:20832
    ds_read_b64_tr_b16 v[190:191], v11 offset:20976
    ds_read_b64_tr_b16 v[192:193], v11 offset:20864
    s_add_u32 m0, s75, 0
    s_add_u32 s33, s67, 0
    buffer_load_dwordx4 v9, s[16:19], s33 offen sc1 lds
    s_waitcnt vmcnt(9)
    v_mfma_f32_16x16x32_bf16 v[20:23], v[236:239], v[68:71], v[20:23]
    ds_read_b64_tr_b16 v[194:195], v11 offset:21008
    v_mfma_f32_16x16x32_bf16 v[24:27], v[240:243], v[68:71], v[24:27]
    ds_read_b64_tr_b16 v[196:197], v11 offset:25920
    v_mfma_f32_16x16x32_bf16 v[28:31], v[244:247], v[68:71], v[28:31]
    ds_read_b64_tr_b16 v[198:199], v11 offset:26064
    v_mfma_f32_16x16x32_bf16 v[32:35], v[248:251], v[68:71], v[32:35]
    ds_read_b64_tr_b16 v[200:201], v11 offset:25952
    v_mfma_f32_16x16x32_bf16 v[36:39], v[252:255], v[68:71], v[36:39]
    ds_read_b64_tr_b16 v[202:203], v11 offset:26096
    ds_read_b64_tr_b16 v[204:205], v11 offset:25984
    ds_read_b64_tr_b16 v[206:207], v11 offset:26128
    s_add_u32 m0, s75, 1024
    s_add_u32 s33, s67, 36864
    buffer_load_dwordx4 v9, s[16:19], s33 offen sc1 lds
    s_waitcnt vmcnt(9) lgkmcnt(14)
    v_mfma_f32_16x16x32_bf16 v[20:23], v[96:99], v[72:75], v[20:23]
    ds_read_b64_tr_b16 v[208:209], v11 offset:26016
    v_mfma_f32_16x16x32_bf16 v[24:27], v[100:103], v[72:75], v[24:27]
    ds_read_b64_tr_b16 v[210:211], v11 offset:26160
    v_mfma_f32_16x16x32_bf16 v[28:31], v[104:107], v[72:75], v[28:31]
    ds_read_b64_tr_b16 v[212:213], v11 offset:26048
    v_mfma_f32_16x16x32_bf16 v[32:35], v[108:111], v[72:75], v[32:35]
    ds_read_b64_tr_b16 v[214:215], v11 offset:26192
    v_mfma_f32_16x16x32_bf16 v[36:39], v[112:115], v[72:75], v[36:39]
    ds_read_b64_tr_b16 v[216:217], v11 offset:31104
    ds_read_b64_tr_b16 v[218:219], v11 offset:31248
    ds_read_b64_tr_b16 v[220:221], v11 offset:31136
    s_waitcnt vmcnt(8) lgkmcnt(14)
    v_mfma_f32_16x16x32_bf16 v[20:23], v[116:119], v[76:79], v[20:23]
    ds_read_b64_tr_b16 v[222:223], v11 offset:31280
    v_mfma_f32_16x16x32_bf16 v[24:27], v[120:123], v[76:79], v[24:27]
    ds_read_b64_tr_b16 v[224:225], v11 offset:31168
    v_mfma_f32_16x16x32_bf16 v[28:31], v[124:127], v[76:79], v[28:31]
    ds_read_b64_tr_b16 v[226:227], v11 offset:31312
    v_mfma_f32_16x16x32_bf16 v[32:35], v[128:131], v[76:79], v[32:35]
    ds_read_b64_tr_b16 v[228:229], v11 offset:31200
    v_mfma_f32_16x16x32_bf16 v[36:39], v[132:135], v[76:79], v[36:39]
    ds_read_b64_tr_b16 v[230:231], v11 offset:31344
    ds_read_b64_tr_b16 v[232:233], v11 offset:31232
    ds_read_b64_tr_b16 v[234:235], v11 offset:31376
    s_waitcnt vmcnt(7) lgkmcnt(14)
    v_mfma_f32_16x16x32_bf16 v[20:23], v[136:139], v[80:83], v[20:23]
    ds_read_b64_tr_b16 v[236:237], v11 offset:36288
    v_mfma_f32_16x16x32_bf16 v[24:27], v[140:143], v[80:83], v[24:27]
    ds_read_b64_tr_b16 v[238:239], v11 offset:36432
    v_mfma_f32_16x16x32_bf16 v[28:31], v[144:147], v[80:83], v[28:31]
    ds_read_b64_tr_b16 v[240:241], v11 offset:36320
    v_mfma_f32_16x16x32_bf16 v[32:35], v[148:151], v[80:83], v[32:35]
    ds_read_b64_tr_b16 v[242:243], v11 offset:36464
    v_mfma_f32_16x16x32_bf16 v[36:39], v[152:155], v[80:83], v[36:39]
    ds_read_b64_tr_b16 v[244:245], v11 offset:36352
    ds_read_b64_tr_b16 v[246:247], v11 offset:36496
    ds_read_b64_tr_b16 v[248:249], v11 offset:36384
    s_waitcnt vmcnt(6) lgkmcnt(14)
    v_mfma_f32_16x16x32_bf16 v[20:23], v[156:159], v[84:87], v[20:23]
    ds_read_b64_tr_b16 v[250:251], v11 offset:36528
    v_mfma_f32_16x16x32_bf16 v[24:27], v[160:163], v[84:87], v[24:27]
    ds_read_b64_tr_b16 v[252:253], v11 offset:36416
    v_mfma_f32_16x16x32_bf16 v[28:31], v[164:167], v[84:87], v[28:31]
    ds_read_b64_tr_b16 v[254:255], v11 offset:36560
    v_mfma_f32_16x16x32_bf16 v[32:35], v[168:171], v[84:87], v[32:35]
    ds_read_b64_tr_b16 v[96:97], v12 offset:0
    v_mfma_f32_16x16x32_bf16 v[36:39], v[172:175], v[84:87], v[36:39]
    ds_read_b64_tr_b16 v[98:99], v12 offset:5184
    ds_read_b64_tr_b16 v[100:101], v12 offset:32
    ds_read_b64_tr_b16 v[102:103], v12 offset:5216
    s_waitcnt vmcnt(5) lgkmcnt(14)
    v_mfma_f32_16x16x32_bf16 v[20:23], v[176:179], v[40:43], v[20:23]
    ds_read_b64_tr_b16 v[104:105], v12 offset:64
    v_mfma_f32_16x16x32_bf16 v[24:27], v[180:183], v[40:43], v[24:27]
    ds_read_b64_tr_b16 v[106:107], v12 offset:5248
    v_mfma_f32_16x16x32_bf16 v[28:31], v[184:187], v[40:43], v[28:31]
    ds_read_b64_tr_b16 v[108:109], v12 offset:96
    v_mfma_f32_16x16x32_bf16 v[32:35], v[188:191], v[40:43], v[32:35]
    ds_read_b64_tr_b16 v[110:111], v12 offset:5280
    v_mfma_f32_16x16x32_bf16 v[36:39], v[192:195], v[40:43], v[36:39]
    ds_read_b64_tr_b16 v[112:113], v12 offset:128
    ds_read_b64_tr_b16 v[114:115], v12 offset:5312
    ds_read_b64_tr_b16 v[116:117], v12 offset:41472
    s_waitcnt vmcnt(4) lgkmcnt(14)
    v_mfma_f32_16x16x32_bf16 v[20:23], v[196:199], v[44:47], v[20:23]
    ds_read_b64_tr_b16 v[118:119], v12 offset:46656
    v_mfma_f32_16x16x32_bf16 v[24:27], v[200:203], v[44:47], v[24:27]
    ds_read_b64_tr_b16 v[120:121], v12 offset:41504
    v_mfma_f32_16x16x32_bf16 v[28:31], v[204:207], v[44:47], v[28:31]
    ds_read_b64_tr_b16 v[122:123], v12 offset:46688
    v_mfma_f32_16x16x32_bf16 v[32:35], v[208:211], v[44:47], v[32:35]
    ds_read_b64_tr_b16 v[124:125], v12 offset:41536
    v_mfma_f32_16x16x32_bf16 v[36:39], v[212:215], v[44:47], v[36:39]
    ds_read_b64_tr_b16 v[126:127], v12 offset:46720
    ds_read_b64_tr_b16 v[128:129], v12 offset:41568
    ds_read_b64_tr_b16 v[130:131], v12 offset:46752
    s_waitcnt vmcnt(3) lgkmcnt(14)
    v_mfma_f32_16x16x32_bf16 v[20:23], v[216:219], v[48:51], v[20:23]
    ds_read_b64_tr_b16 v[132:133], v12 offset:41600
    v_mfma_f32_16x16x32_bf16 v[24:27], v[220:223], v[48:51], v[24:27]
    ds_read_b64_tr_b16 v[134:135], v12 offset:46784
    v_mfma_f32_16x16x32_bf16 v[28:31], v[224:227], v[48:51], v[28:31]
    v_mfma_f32_16x16x32_bf16 v[32:35], v[228:231], v[48:51], v[32:35]
    v_mfma_f32_16x16x32_bf16 v[36:39], v[232:235], v[48:51], v[36:39]
    s_waitcnt vmcnt(0) lgkmcnt(14)
    v_mfma_f32_16x16x32_bf16 v[20:23], v[236:239], v[52:55], v[20:23]
    ds_read2_b32 v[88:89], v7 offset0:0 offset1:16
    v_mfma_f32_16x16x32_bf16 v[24:27], v[240:243], v[52:55], v[24:27]
    ds_read2_b32 v[90:91], v7 offset0:32 offset1:48
    v_mfma_f32_16x16x32_bf16 v[28:31], v[244:247], v[52:55], v[28:31]
    ds_read2_b32 v[92:93], v6 offset0:0 offset1:16
    v_mfma_f32_16x16x32_bf16 v[32:35], v[248:251], v[52:55], v[32:35]
    ds_read2_b32 v[94:95], v6 offset0:32 offset1:48
    v_mfma_f32_16x16x32_bf16 v[36:39], v[252:255], v[52:55], v[36:39]
    s_waitcnt lgkmcnt(2)
    v_mfma_f32_16x16x32_bf16 v[20:23], v[96:99], v[88:91], v[20:23]
    v_mfma_f32_16x16x32_bf16 v[24:27], v[100:103], v[88:91], v[24:27]
    s_waitcnt lgkmcnt(0)
    v_mfma_f32_16x16x32_bf16 v[20:23], v[116:119], v[92:95], v[20:23]
    v_mfma_f32_16x16x32_bf16 v[24:27], v[120:123], v[92:95], v[24:27]
    v_mfma_f32_16x16x32_bf16 v[28:31], v[104:107], v[88:91], v[28:31]
    v_mfma_f32_16x16x32_bf16 v[28:31], v[124:127], v[92:95], v[28:31]
    v_mfma_f32_16x16x32_bf16 v[32:35], v[108:111], v[88:91], v[32:35]
    v_mfma_f32_16x16x32_bf16 v[32:35], v[128:131], v[92:95], v[32:35]
    v_mfma_f32_16x16x32_bf16 v[36:39], v[112:115], v[88:91], v[36:39]
    v_mfma_f32_16x16x32_bf16 v[36:39], v[132:135], v[92:95], v[36:39]
    s_cmp_ge_u32 s47, 3
    v_cmp_class_f32 vcc, v20, v3
    s_cbranch_vccnz A_nan
A_ok:
    v_cvt_pk_bf16_f32 v40, v20, v21
    v_cvt_pk_bf16_f32 v41, v22, v23
    ds_write_b64 v13, v[40:41] offset:0
    v_cvt_pk_bf16_f32 v42, v24, v25
    v_cvt_pk_bf16_f32 v43, v26, v27
    ds_write_b64 v13, v[42:43] offset:32
    v_cvt_pk_bf16_f32 v44, v28, v29
    v_cvt_pk_bf16_f32 v45, v30, v31
    ds_write_b64 v13, v[44:45] offset:64
    v_cvt_pk_bf16_f32 v46, v32, v33
    v_cvt_pk_bf16_f32 v47, v34, v35
    ds_write_b64 v13, v[46:47] offset:96
    v_cvt_pk_bf16_f32 v48, v36, v37
    v_cvt_pk_bf16_f32 v49, v38, v39
    ds_write_b64 v13, v[48:49] offset:128
    ds_read_b128 v[20:23], v14 offset:0
    ds_read_b128 v[24:27], v14 offset:1120
    ds_read_b128 v[28:31], v14 offset:2240
    s_waitcnt lgkmcnt(2)
    buffer_store_dwordx4 v[20:23], v16, s[24:27], s68 offen
    s_waitcnt lgkmcnt(1)
    buffer_store_dwordx4 v[24:27], v17, s[24:27], s68 offen
    s_mov_b32 exec_lo, 0x3ffff
    s_mov_b32 exec_hi, 0
    s_waitcnt lgkmcnt(0)
    buffer_store_dwordx4 v[28:31], v18, s[24:27], s68 offen
L_end:
L_exit:
    s_endpgm
.section .rodata,"a"
.p2align 6
.amdhsa_kernel standalone__mha_block__prompt_kernel
  .amdhsa_next_free_vgpr 256
  .amdhsa_next_free_sgpr 102
  .amdhsa_accum_offset 256
  .amdhsa_group_segment_fixed_size 0
  .amdhsa_kernarg_size 48
  .amdhsa_user_sgpr_count 2
  .amdhsa_user_sgpr_kernarg_segment_ptr 1
  .amdhsa_system_sgpr_workgroup_id_x 1
.end_amdhsa_kernel
```
